```python
import torch

def _softmax(x, axis=-1):
    return torch.softmax(x, dim=axis)
def _gelu(x):
    return torch.nn.functional.gelu(x, approximate="tanh")
def _silu(x):
    return torch.nn.functional.silu(x)
def _sigmoid(x):
    return torch.sigmoid(x)
def _layernorm(x, axis=-1, eps=1e-5):
    m = x.mean(dim=axis, keepdim=True)
    v = x.var(dim=axis, keepdim=True, unbiased=False)
    return (x - m) / torch.sqrt(v + eps)
def _scatter_add(tgt, idx, src, axis=0):
    return tgt.clone().index_add_(axis, idx, src)
def _segment_sum(src, seg, n):
    out = torch.zeros((n,) + src.shape[1:], dtype=src.dtype)
    return out.index_add_(0, seg, src)
def _pad(x, pw):
    flat = tuple(v for pair in reversed(pw) for v in pair)
    return torch.nn.functional.pad(x, flat)

kernel_name = 'gated_mix__mha_block__dense_activation_squared_relu__prompt'

def setup_inputs():

    _w = (lambda a: (lambda t: t.to(torch.bfloat16) if t.is_floating_point() else t)(torch.as_tensor(a)))
    def _A_setup():
        B, S, D, H = 1, 2048, 640, 32
        return {
            "x": _w((lambda *s: torch.randn(*s, dtype=torch.bfloat16) * 0.05)(B, S, D)),
            "wqkv": _w((lambda *s: torch.randn(*s, dtype=torch.bfloat16) * 0.8)(D, 3 * D)),
            "wo": _w((lambda *s: torch.randn(*s, dtype=torch.bfloat16) * 0.1)(D, D)),
        }
    _A_in = _A_setup()

    def _B_setup():
        B, S, D, F = 1, 2048, 640, 1728
        return {
            "x": _w((lambda *s: torch.randn(*s, dtype=torch.bfloat16) * 0.05)(B, S, D)),
            "w1": _w((lambda *s: torch.randn(*s, dtype=torch.bfloat16) * 0.1)(D, F)),
            "b1": _w((lambda *s: torch.randn(*s, dtype=torch.bfloat16) * 0.1)(F)),
            "w2": _w((lambda *s: torch.randn(*s, dtype=torch.bfloat16) * 0.1)(F, D)),
            "b2": _w((lambda *s: torch.randn(*s, dtype=torch.bfloat16) * 0.05)(D)),
        }
    _B_in = _B_setup()

    return {
        "A_x": _A_in["x"],
        "A_wqkv": _A_in["wqkv"],
        "A_wo": _A_in["wo"],
        "B_x": _B_in["x"],
        "B_w1": _B_in["w1"],
        "B_b1": _B_in["b1"],
        "B_w2": _B_in["w2"],
        "B_b2": _B_in["b2"],
        "gate_w": _w((lambda *s: torch.randn(*s, dtype=torch.bfloat16) * 0.05)(640) * 16.0),
    }

def reference(A_x, A_wqkv, A_wo, B_x, B_w1, B_b1, B_w2, B_b2, gate_w):
    def _A_ref(x, wqkv, wo):
        B, S, D = x.shape
        H = 32
        Dh = D // H
        qkv = (lambda x, *d: x.permute(*d))((x @ wqkv).reshape(B, S, 3, H, Dh), 2, 0, 3, 1, 4)
        q, k, v = qkv[0], qkv[1], qkv[2]
        scores = torch.einsum("bhqd,bhkd->bhqk", q, k) * (Dh ** -0.5)
        p = _softmax(scores, axis=-1)
        o = torch.einsum("bhqk,bhkd->bhqd", p, v)
        return (lambda x, *d: x.permute(*d))(o, 0, 2, 1, 3).reshape(B, S, D) @ wo

    def _B_ref(x, w1, b1, w2, b2):
        h = torch.einsum("bsd,df->bsf", x, w1) + b1
        zero = torch.zeros_like(h)
        r = torch.where(h > zero, h, zero)
        h = r * r
        out = torch.einsum("bsf,fd->bsd", h, w2) + b2
        return out

    x = A_x
    g = _sigmoid((x * gate_w).sum(-1, keepdims=True))
    a = _A_ref(x, A_wqkv, A_wo)
    b = _B_ref(x, B_w1, B_b1, B_w2, B_b2)
    return g * a + (1 - g) * b
```

```asm
; @launch grid=(256,1,1) block=(512,1,1) lds=163840
.amdgcn_target "amdgcn-amd-amdhsa--gfx950"
.text
.globl gated_mix__mha_block__dense_activation_squared_relu__prompt_kernel
.p2align 12
.p2align 8
.type gated_mix__mha_block__dense_activation_squared_relu__prompt_kernel,@function
gated_mix__mha_block__dense_activation_squared_relu__prompt_kernel:
    s_load_dwordx2 s[8:9], s[0:1], 0
    s_load_dwordx2 s[12:13], s[0:1], 8
    s_cmp_ge_u32 s2, 256
    s_cbranch_scc1 Lend
    v_lshrrev_b32 v3, 3, v0
    s_bfe_u32 s59, s2, 0x30003
    s_getpc_b64 s[52:53]
Lpc0:
    s_mov_b32 s54, Lcode_end-Lpc0
    s_mov_b32 s55, 0x20000
    s_lshl_b32 s68, s59, 13
    v_lshlrev_b32 v1, 7, v3
    buffer_load_dword v127, v1, s[52:55], s68 offen
    v_readfirstlane_b32 s3, v0
    v_lshrrev_b32 v2, 4, v0
    s_lshr_b32 s67, s2, 6
    v_xor_b32 v7, v2, v0
    s_add_u32 s57, s59, s67
    v_and_b32 v7, 7, v7
    s_and_b32 s57, s57, 3
    v_mul_u32_u24 v4, 1280, v3
    s_and_b32 s58, s59, 4
    v_lshl_add_u32 v4, v7, 4, v4
    s_add_u32 s57, s57, s58
    s_lshl_b32 s64, s57, 2
    s_lshr_b32 s57, 1716850944, s64
    s_and_b32 s71, s57, 15
    s_and_b32 s4, s2, 4
    s_lshl1_add_u32 s4, s4, s59
    s_mul_i32 s58, s4, 1280
    s_add_u32 s57, s58, s71
    s_lshl_b32 s57, s57, 7
    s_mov_b32 s10, 2621440
    s_mov_b32 s11, 0x20000
    s_lshl_b32 m0, s3, 4
    s_andn2_b32 s68, 0xc3, s2
    s_waitcnt lgkmcnt(0)
    s_cbranch_scc0 Lno0
    buffer_load_dwordx4 v4, s[8:11], s57 offen lds
    s_add_u32 m0, m0, 8192
    s_add_u32 s57, s57, 81920
    buffer_load_dwordx4 v4, s[8:11], s57 offen lds
Lno0:
    v_and_b32 v7, 3, v2
    v_and_b32 v8, 8, v2
    s_and_b32 s5, s2, 3
    v_lshl_or_b32 v7, v7, 1, v8
    s_lshl2_add_u32 s5, s67, s5
    v_xor_b32 v7, v7, v0
    s_lshl_b32 s69, s5, 8
    v_and_b32 v7, 15, v7
    s_mul_i32 s57, s71, 245760
    v_lshl_add_u32 v7, v7, 4, s69
    s_mov_b32 s14, 2457600
    v_mul_u32_u24 v5, 3840, v2
    s_mov_b32 s15, 0x20000
    v_add_u32 v5, v5, v7
    s_add_u32 m0, m0, 8192
    s_cmp_eq_u32 s5, 15
    s_cbranch_scc1 Lno1
    buffer_load_dwordx4 v5, s[12:15], s57 offen lds
    s_add_u32 m0, m0, 8192
    s_add_u32 s57, s57, 122880
    buffer_load_dwordx4 v5, s[12:15], s57 offen lds
Lno1:
    s_load_dwordx2 s[36:37], s[0:1], 40
    s_lshr_b32 s3, s3, 6
    s_and_b32 s62, s3, 3
    s_lshr_b32 s63, s3, 2
    s_lshl_b32 s56, s62, 10
    v_and_b32 v0, 63, v0
    v_and_b32 v2, 15, v2
    v_lshrrev_b32 v3, 4, v0
    s_lshl_b32 s58, s58, 7
    s_mul_i32 s57, s63, 40960
    s_sub_u32 s58, s58, s57
    v_add_u32 v4, s58, v4
    s_mul_i32 s57, s63, 61440
    v_subrev_u32 v5, s57, v5
    s_mov_b32 s38, 3456
    s_mov_b32 s39, 0x20000
    v_lshlrev_b32 v9, 2, v0
    s_mov_b32 s94, 2018588192
    s_movk_i32 s95, 148
    s_cmp_eq_u32 s64, 4
    s_cmov_b32 s94, 2490523952
    s_cmovk_i32 s95, 88
    s_cmp_eq_u32 s64, 8
    s_cmov_b32 s94, 1666730241
    s_cmovk_i32 s95, 39
    s_cmp_eq_u32 s64, 12
    s_cmov_b32 s94, 1687364865
    s_cmovk_i32 s95, 135
    s_cmp_eq_u32 s64, 16
    s_cmov_b32 s94, 587628917
    s_cmovk_i32 s95, 73
    s_cmp_eq_u32 s64, 20
    s_cmov_b32 s94, 1227298437
    s_cmovk_i32 s95, 3
    s_cmp_eq_u32 s64, 24
    s_cmov_b32 s94, 402887766
    s_cmovk_i32 s95, 114
    s_cmp_eq_u32 s64, 28
    s_cmov_b32 s94, 424177750
    s_cmovk_i32 s95, 50
    s_bfe_u32 s70, s94, 262148
    s_mul_i32 s70, s70, 128
    s_bfe_u32 s71, s94, 262148
    s_mul_i32 s71, s71, 245760
    s_bfe_u32 s72, s94, 262152
    s_mul_i32 s72, s72, 221184
    s_waitcnt lgkmcnt(0)
    s_cmp_eq_u32 s5, 15
    s_cbranch_scc1 Lgate
    s_cmp_lt_u32 s3, 4
    s_cbranch_scc1 La1
    s_setprio 2
    buffer_load_dword v10, v9, s[36:39], s69 offen
    s_load_dwordx2 s[16:17], s[0:1], 32
    s_load_dwordx2 s[20:21], s[0:1], 88
    s_load_dwordx2 s[44:45], s[0:1], 64
    s_load_dwordx2 s[48:49], s[0:1], 80
    s_load_dwordx2 s[24:25], s[0:1], 48
    s_load_dwordx2 s[28:29], s[0:1], 16
    s_load_dwordx2 s[32:33], s[0:1], 72
    s_load_dwordx2 s[40:41], s[0:1], 56
    s_mov_b32 s18, 2211840
    s_mov_b32 s19, 0x20000
    s_mov_b32 s22, 22544384
    s_mov_b32 s23, 0x20000
    s_mov_b32 s46, 1280
    s_mov_b32 s47, 0x20000
    s_mov_b32 s50, 256
    s_mov_b32 s51, 0x20000
    s_mov_b32 s26, 2211840
    s_mov_b32 s27, 0x20000
    s_mov_b32 s30, 819200
    s_mov_b32 s31, 0x20000
    s_mov_b32 s34, 2621440
    s_mov_b32 s35, 0x20000
    s_mov_b32 s42, 1280
    s_mov_b32 s43, 0x20000
    v_mul_u32_u24 v6, 3456, v2
    v_add_u32 v6, v6, v7
    s_cmp_ge_u32 s5, 14
    s_cselect_b32 s57, 2130706432, 0
    v_add_u32 v6, s57, v6
    s_lshr_b32 s6, s2, 5
    s_lshr_b32 s58, s2, 3
    s_and_b32 s58, s58, 3
    s_and_b32 s57, s2, 7
    s_lshl_b32 s7, s57, 2
    s_add_u32 s7, s7, s58
    s_mov_b32 s61, s6
    s_mov_b32 s60, s7
    s_waitcnt lgkmcnt(0)
    s_lshl_b32 s57, s62, 5
    v_lshrrev_b32 v3, 4, v0
    v_and_b32 v2, 15, v0
    v_add_u32 v7, s57, v2
    v_lshlrev_b32 v7, 7, v7
    v_lshrrev_b32 v20, 1, v2
    v_xor_b32 v20, v20, v3
    v_xor_b32 v21, 4, v20
    v_lshl_add_u32 v8, v21, 4, v7
    v_lshl_add_u32 v7, v20, 4, v7
    v_lshlrev_b32 v9, 3, v3
    s_and_b32 s74, s6, 7
    s_lshl_b32 s74, s74, 2
    s_add_u32 s74, s74, s62
    s_add_u32 s74, s74, 4
    s_and_b32 s74, s74, 31
    s_mul_i32 s73, s7, 163840
    s_add_u32 s73, s73, 4194304
    s_mul_i32 s75, s62, 6144
    s_mul_i32 s57, s7, 20
    s_add_u32 s58, s57, 19
    s_lshr_b32 s57, s57, 6
    s_lshr_b32 s58, s58, 6
    s_sub_u32 s58, s58, s57
    v_and_b32 v30, 1, v0
    v_mul_u32_u24 v30, s58, v30
    v_add_u32 v31, s57, v30
    v_bfe_u32 v28, v0, 1, 1
    v_mul_u32_u24 v28, 10, v28
    v_add3_u32 v30, v31, v28, 10
    v_lshrrev_b32 v28, 2, v0
    v_min_u32 v28, 6, v28
    v_lshlrev_b32 v28, 2, v28
    v_add_u32 v28, s74, v28
    v_and_b32 v28, 31, v28
    v_lshl_add_u32 v28, v30, 5, v28
    v_lshlrev_b32 v11, 7, v28
    v_mul_u32_u24 v28, 26, v0
    v_lshrrev_b32 v28, 8, v28
    v_mul_u32_u24 v28, 1120, v28
    v_lshl_add_u32 v3, v0, 4, v28
    s_add_u32 s50, s62, s61
    s_and_b32 s50, s50, 3
    s_add_u32 s57, s50, 1
    s_and_b32 s57, s57, 3
    s_lshl_b32 s58, s60, 2
    s_add_u32 s76, s57, s58
    s_add_u32 s57, s50, 2
    s_and_b32 s57, s57, 3
    s_lshl_b32 s58, s60, 2
    s_add_u32 s77, s57, s58
    s_add_u32 s57, s50, 3
    s_and_b32 s57, s57, 3
    s_lshl_b32 s58, s60, 2
    s_add_u32 s78, s57, s58
    s_add_u32 s57, s50, 4
    s_and_b32 s57, s57, 3
    s_lshl_b32 s58, s60, 2
    s_add_u32 s79, s57, s58
    s_lshl_b32 s57, s5, 4
    s_add_u32 s57, s57, s4
    s_lshl_b32 s51, s57, 2
    s_add_u32 s51, s51, s62
    s_lshl_b32 s51, s51, 7
    s_add_u32 s51, s51, 131072
    s_sub_u32 s57, 255, s57
    s_lshr_b32 s58, s57, 1
    s_and_b32 s57, s57, 1
    s_lshl_b32 s57, s57, 2
    s_add_u32 s57, s57, s62
    s_mul_i32 s48, s58, 40960
    s_mul_i32 s59, s57, 5120
    s_add_u32 s48, s48, s59
    s_add_u32 s48, s48, 19398656
    s_mul_i32 s49, s57, 160
    s_mov_b32 s55, 0x20000
    s_cmp_lt_u32 s58, 54
    s_cbranch_scc1 Lpw2_1
    s_mov_b64 s[52:53], s[28:29]
    s_mov_b32 s54, 819200
    s_cmp_ge_u32 s58, 74
    s_cselect_b32 s48, 2130706432, s48
    s_sub_u32 s58, s58, 54
    s_mul_i32 s59, s58, 205
    s_lshr_b32 s59, s59, 10
    s_mul_i32 s67, s59, 5
    s_sub_u32 s67, s58, s67
    s_mul_i32 s59, s59, 160
    s_mul_i32 s68, s67, 40
    s_cmp_eq_u32 s67, 4
    s_cselect_b32 s68, 16, s68
    s_cselect_b32 s96, 20, 8
    s_cselect_b32 s97, 80, 20
    s_cselect_b32 s98, 40, 4
    s_add_u32 s99, s59, s68
    s_branch Lpj_2
Lpw2_1:
    s_mov_b64 s[52:53], s[24:25]
    s_mov_b32 s54, 2211840
    s_mov_b32 s96, 16
    s_mov_b32 s97, 8
    s_mov_b32 s98, 4
    s_lshl_b32 s99, s58, 5
Lpj_2:
    s_mul_i32 s96, s96, 1280
    s_mul_i32 s97, s97, 1280
    s_mul_i32 s98, s98, 1280
    s_mul_i32 s99, s99, 1280
    s_add_u32 s99, s99, s49
    s_lshl_b32 s57, s4, 3
    s_lshl_b32 s58, s62, 1
    s_add_u32 s57, s57, s58
    s_mul_i32 s57, s57, 54
    s_lshl_b32 s58, s5, 2
    s_add_u32 s57, s57, s58
    s_lshl_b32 s57, s57, 10
    s_add_u32 s57, s57, 9437184
    s_cmp_ge_u32 s5, 14
    s_cselect_b32 s66, 2130706432, s57
    s_cmp_ge_u32 s5, 13
    s_cselect_b32 s65, 2130706432, s57
    s_add_u32 m0, s56, 32768
    s_add_u32 s57, s70, 0
    buffer_load_dwordx4 v4, s[8:11], s57 offen  lds
    s_add_u32 m0, s56, 36864
    s_add_u32 s57, s70, 40960
    buffer_load_dwordx4 v4, s[8:11], s57 offen  lds
    s_add_u32 m0, s56, 40960
    s_add_u32 s57, s70, 81920
    buffer_load_dwordx4 v4, s[8:11], s57 offen  lds
    s_add_u32 m0, s56, 45056
    s_add_u32 s57, s70, 122880
    buffer_load_dwordx4 v4, s[8:11], s57 offen  lds
    s_bfe_u32 s70, s94, 262152
    s_mul_i32 s70, s70, 128
    s_add_u32 m0, s56, 49152
    s_add_u32 s57, s71, 0
    buffer_load_dwordx4 v5, s[12:15], s57 offen  lds
    s_add_u32 m0, s56, 53248
    s_add_u32 s57, s71, 61440
    buffer_load_dwordx4 v5, s[12:15], s57 offen  lds
    s_add_u32 m0, s56, 57344
    s_add_u32 s57, s71, 122880
    buffer_load_dwordx4 v5, s[12:15], s57 offen  lds
    s_add_u32 m0, s56, 61440
    s_add_u32 s57, s71, 184320
    buffer_load_dwordx4 v5, s[12:15], s57 offen  lds
    s_bfe_u32 s71, s94, 262152
    s_mul_i32 s71, s71, 245760
    s_waitcnt vmcnt(9)
    s_barrier
    ds_read_b128 v[96:99], v7 offset:0
    ds_read_b128 v[104:107], v8 offset:0
    ds_read_b128 v[100:103], v7 offset:2048
    ds_read_b128 v[108:111], v8 offset:2048
    s_add_u32 m0, s56, 65536
    s_add_u32 s57, s70, 0
    buffer_load_dwordx4 v4, s[8:11], s57 offen  lds
    s_add_u32 m0, s56, 69632
    s_add_u32 s57, s70, 40960
    buffer_load_dwordx4 v4, s[8:11], s57 offen  lds
    s_add_u32 m0, s56, 73728
    s_add_u32 s57, s70, 81920
    buffer_load_dwordx4 v4, s[8:11], s57 offen  lds
    s_add_u32 m0, s56, 77824
    s_add_u32 s57, s70, 122880
    buffer_load_dwordx4 v4, s[8:11], s57 offen  lds
    s_bfe_u32 s70, s94, 262156
    s_mul_i32 s70, s70, 128
    s_add_u32 m0, s56, 81920
    s_add_u32 s57, s71, 0
    buffer_load_dwordx4 v5, s[12:15], s57 offen  lds
    s_add_u32 m0, s56, 86016
    s_add_u32 s57, s71, 61440
    buffer_load_dwordx4 v5, s[12:15], s57 offen  lds
    s_add_u32 m0, s56, 90112
    s_add_u32 s57, s71, 122880
    buffer_load_dwordx4 v5, s[12:15], s57 offen  lds
    s_add_u32 m0, s56, 94208
    s_add_u32 s57, s71, 184320
    buffer_load_dwordx4 v5, s[12:15], s57 offen  lds
    s_bfe_u32 s71, s94, 262156
    s_mul_i32 s71, s71, 245760
    s_waitcnt vmcnt(16)
    ds_bpermute_b32 v12, v9, v10 offset:0
    ds_bpermute_b32 v13, v9, v10 offset:4
    ds_bpermute_b32 v14, v9, v10 offset:32
    ds_bpermute_b32 v15, v9, v10 offset:36
    ds_bpermute_b32 v16, v9, v10 offset:64
    ds_bpermute_b32 v17, v9, v10 offset:68
    ds_bpermute_b32 v18, v9, v10 offset:96
    ds_bpermute_b32 v19, v9, v10 offset:100
    ds_bpermute_b32 v20, v9, v10 offset:128
    ds_bpermute_b32 v21, v9, v10 offset:132
    ds_bpermute_b32 v22, v9, v10 offset:160
    ds_bpermute_b32 v23, v9, v10 offset:164
    ds_bpermute_b32 v24, v9, v10 offset:192
    ds_bpermute_b32 v25, v9, v10 offset:196
    ds_bpermute_b32 v26, v9, v10 offset:224
    ds_bpermute_b32 v27, v9, v10 offset:228
    s_waitcnt lgkmcnt(14)
    v_lshlrev_b32 v32, 16, v12
    v_and_b32 v33, 0xffff0000, v12
    v_lshlrev_b32 v34, 16, v13
    v_and_b32 v35, 0xffff0000, v13
    s_waitcnt lgkmcnt(12)
    v_lshlrev_b32 v36, 16, v14
    v_and_b32 v37, 0xffff0000, v14
    v_lshlrev_b32 v38, 16, v15
    v_and_b32 v39, 0xffff0000, v15
    s_waitcnt lgkmcnt(10)
    v_lshlrev_b32 v48, 16, v16
    v_and_b32 v49, 0xffff0000, v16
    v_lshlrev_b32 v50, 16, v17
    v_and_b32 v51, 0xffff0000, v17
    s_waitcnt lgkmcnt(8)
    v_lshlrev_b32 v52, 16, v18
    v_and_b32 v53, 0xffff0000, v18
    v_lshlrev_b32 v54, 16, v19
    v_and_b32 v55, 0xffff0000, v19
    s_waitcnt lgkmcnt(6)
    v_lshlrev_b32 v64, 16, v20
    v_and_b32 v65, 0xffff0000, v20
    v_lshlrev_b32 v66, 16, v21
    v_and_b32 v67, 0xffff0000, v21
    s_waitcnt lgkmcnt(4)
    v_lshlrev_b32 v68, 16, v22
    v_and_b32 v69, 0xffff0000, v22
    v_lshlrev_b32 v70, 16, v23
    v_and_b32 v71, 0xffff0000, v23
    s_waitcnt lgkmcnt(2)
    v_lshlrev_b32 v80, 16, v24
    v_and_b32 v81, 0xffff0000, v24
    v_lshlrev_b32 v82, 16, v25
    v_and_b32 v83, 0xffff0000, v25
    s_waitcnt lgkmcnt(0)
    v_lshlrev_b32 v84, 16, v26
    v_and_b32 v85, 0xffff0000, v26
    v_lshlrev_b32 v86, 16, v27
    v_and_b32 v87, 0xffff0000, v27
    s_waitcnt vmcnt(8)
    s_barrier
    ds_read_b128 v[112:115], v7 offset:32768
    ds_read_b128 v[120:123], v8 offset:32768
    ds_read_b128 v[116:119], v7 offset:34816
    ds_read_b128 v[124:127], v8 offset:34816
    s_add_u32 m0, s56, 98304
    s_add_u32 s57, s70, 0
    buffer_load_dwordx4 v4, s[8:11], s57 offen  lds
    s_add_u32 m0, s56, 102400
    s_add_u32 s57, s70, 40960
    buffer_load_dwordx4 v4, s[8:11], s57 offen  lds
    s_add_u32 m0, s56, 106496
    s_add_u32 s57, s70, 81920
    buffer_load_dwordx4 v4, s[8:11], s57 offen  lds
    s_add_u32 m0, s56, 110592
    s_add_u32 s57, s70, 122880
    buffer_load_dwordx4 v4, s[8:11], s57 offen  lds
    s_bfe_u32 s70, s94, 262160
    s_mul_i32 s70, s70, 128
    s_add_u32 m0, s56, 114688
    s_add_u32 s57, s71, 0
    buffer_load_dwordx4 v5, s[12:15], s57 offen  lds
    s_add_u32 m0, s56, 118784
    s_add_u32 s57, s71, 61440
    buffer_load_dwordx4 v5, s[12:15], s57 offen  lds
    s_add_u32 m0, s56, 122880
    s_add_u32 s57, s71, 122880
    buffer_load_dwordx4 v5, s[12:15], s57 offen  lds
    s_add_u32 m0, s56, 126976
    s_add_u32 s57, s71, 184320
    buffer_load_dwordx4 v5, s[12:15], s57 offen  lds
    s_bfe_u32 s71, s94, 262160
    s_mul_i32 s71, s71, 245760
    s_waitcnt vmcnt(8) lgkmcnt(0)
    s_barrier
    v_add_u32 v7, 65536, v7
    ds_read_b128 v[128:131], v7 offset:0
    v_add_u32 v8, 65536, v8
    ds_read_b128 v[136:139], v8 offset:0
    ds_read_b128 v[132:135], v7 offset:2048
    ds_read_b128 v[140:143], v8 offset:2048
    s_add_u32 m0, s56, 131072
    s_add_u32 s57, s70, 0
    buffer_load_dwordx4 v4, s[8:11], s57 offen  lds
    s_add_u32 m0, s56, 135168
    s_add_u32 s57, s70, 40960
    buffer_load_dwordx4 v4, s[8:11], s57 offen  lds
    s_add_u32 m0, s56, 139264
    s_add_u32 s57, s70, 81920
    buffer_load_dwordx4 v4, s[8:11], s57 offen  lds
    s_add_u32 m0, s56, 143360
    s_add_u32 s57, s70, 122880
    buffer_load_dwordx4 v4, s[8:11], s57 offen  lds
    s_bfe_u32 s70, s94, 262164
    s_mul_i32 s70, s70, 128
    s_add_u32 m0, s56, 147456
    s_add_u32 s57, s71, 0
    buffer_load_dwordx4 v5, s[12:15], s57 offen  lds
    s_add_u32 m0, s56, 151552
    s_add_u32 s57, s71, 61440
    buffer_load_dwordx4 v5, s[12:15], s57 offen  lds
    s_add_u32 m0, s56, 155648
    s_add_u32 s57, s71, 122880
    buffer_load_dwordx4 v5, s[12:15], s57 offen  lds
    s_add_u32 m0, s56, 159744
    s_add_u32 s57, s71, 184320
    buffer_load_dwordx4 v5, s[12:15], s57 offen  lds
    s_bfe_u32 s71, s94, 262164
    s_mul_i32 s71, s71, 245760
    s_waitcnt vmcnt(8) lgkmcnt(0)
    s_barrier
    ds_read_b128 v[144:147], v7 offset:32768
    ds_read_b128 v[152:155], v8 offset:32768
    ds_read_b128 v[148:151], v7 offset:34816
    ds_read_b128 v[156:159], v8 offset:34816
    s_add_u32 m0, s56, 0
    s_add_u32 s57, s70, 0
    buffer_load_dwordx4 v4, s[8:11], s57 offen  lds
    s_add_u32 m0, s56, 4096
    s_add_u32 s57, s70, 40960
    buffer_load_dwordx4 v4, s[8:11], s57 offen  lds
    s_add_u32 m0, s56, 8192
    s_add_u32 s57, s70, 81920
    buffer_load_dwordx4 v4, s[8:11], s57 offen  lds
    s_add_u32 m0, s56, 12288
    s_add_u32 s57, s70, 122880
    buffer_load_dwordx4 v4, s[8:11], s57 offen  lds
    s_bfe_u32 s70, s94, 262168
    s_mul_i32 s70, s70, 128
    s_add_u32 m0, s56, 16384
    s_add_u32 s57, s71, 0
    buffer_load_dwordx4 v5, s[12:15], s57 offen  lds
    s_add_u32 m0, s56, 20480
    s_add_u32 s57, s71, 61440
    buffer_load_dwordx4 v5, s[12:15], s57 offen  lds
    s_add_u32 m0, s56, 24576
    s_add_u32 s57, s71, 122880
    buffer_load_dwordx4 v5, s[12:15], s57 offen  lds
    s_add_u32 m0, s56, 28672
    s_add_u32 s57, s71, 184320
    buffer_load_dwordx4 v5, s[12:15], s57 offen  lds
    s_bfe_u32 s71, s94, 262168
    s_mul_i32 s71, s71, 245760
    s_waitcnt vmcnt(8) lgkmcnt(0)
    s_barrier
    v_add_u32 v7, 32768, v7
    ds_read_b128 v[160:163], v7 offset:32768
    v_add_u32 v8, 32768, v8
    ds_read_b128 v[168:171], v8 offset:32768
    ds_read_b128 v[164:167], v7 offset:34816
    ds_read_b128 v[172:175], v8 offset:34816
    s_add_u32 m0, s56, 32768
    s_add_u32 s57, s70, 0
    buffer_load_dwordx4 v4, s[8:11], s57 offen  lds
    s_add_u32 m0, s56, 36864
    s_add_u32 s57, s70, 40960
    buffer_load_dwordx4 v4, s[8:11], s57 offen  lds
    s_add_u32 m0, s56, 40960
    s_add_u32 s57, s70, 81920
    buffer_load_dwordx4 v4, s[8:11], s57 offen  lds
    s_add_u32 m0, s56, 45056
    s_add_u32 s57, s70, 122880
    buffer_load_dwordx4 v4, s[8:11], s57 offen  lds
    s_bfe_u32 s70, s94, 262172
    s_mul_i32 s70, s70, 128
    s_add_u32 m0, s56, 49152
    s_add_u32 s57, s71, 0
    buffer_load_dwordx4 v5, s[12:15], s57 offen  lds
    s_add_u32 m0, s56, 53248
    s_add_u32 s57, s71, 61440
    buffer_load_dwordx4 v5, s[12:15], s57 offen  lds
    s_add_u32 m0, s56, 57344
    s_add_u32 s57, s71, 122880
    buffer_load_dwordx4 v5, s[12:15], s57 offen  lds
    s_add_u32 m0, s56, 61440
    s_add_u32 s57, s71, 184320
    buffer_load_dwordx4 v5, s[12:15], s57 offen  lds
    s_bfe_u32 s71, s94, 262172
    s_mul_i32 s71, s71, 245760
    s_cmp_eq_u32 0, 0
    s_branch Lpad_gb_0
Lwarm_gb:
    s_waitcnt vmcnt(8) lgkmcnt(0)
    s_barrier
    v_add_u32 v7, 4294868992, v7
    ds_read_b128 v[176:179], v7 offset:0
    v_add_u32 v8, 4294868992, v8
    ds_read_b128 v[184:187], v8 offset:0
    ds_read_b128 v[180:183], v7 offset:2048
    ds_read_b128 v[188:191], v8 offset:2048
    s_add_u32 m0, s56, 65536
    s_add_u32 s57, s70, 0
    buffer_load_dwordx4 v4, s[8:11], s57 offen  lds
    s_add_u32 m0, s56, 69632
    s_add_u32 s57, s70, 40960
    buffer_load_dwordx4 v4, s[8:11], s57 offen  lds
    s_add_u32 m0, s56, 73728
    s_add_u32 s57, s70, 81920
    buffer_load_dwordx4 v4, s[8:11], s57 offen  lds
    s_add_u32 m0, s56, 77824
    s_add_u32 s57, s70, 122880
    buffer_load_dwordx4 v4, s[8:11], s57 offen  lds
    s_bfe_u32 s70, s95, 262144
    s_mul_i32 s70, s70, 128
    s_add_u32 m0, s56, 81920
    s_add_u32 s57, s71, 0
    buffer_load_dwordx4 v5, s[12:15], s57 offen  lds
    s_add_u32 m0, s56, 86016
    s_add_u32 s57, s71, 61440
    buffer_load_dwordx4 v5, s[12:15], s57 offen  lds
    s_add_u32 m0, s56, 90112
    s_add_u32 s57, s71, 122880
    buffer_load_dwordx4 v5, s[12:15], s57 offen  lds
    s_add_u32 m0, s56, 94208
    s_add_u32 s57, s71, 184320
    buffer_load_dwordx4 v5, s[12:15], s57 offen  lds
    s_bfe_u32 s71, s95, 262144
    s_mul_i32 s71, s71, 245760
    s_waitcnt vmcnt(8) lgkmcnt(0)
    s_barrier
    ds_read_b128 v[192:195], v7 offset:32768
    ds_read_b128 v[200:203], v8 offset:32768
    ds_read_b128 v[196:199], v7 offset:34816
    ds_read_b128 v[204:207], v8 offset:34816
    s_add_u32 m0, s56, 98304
    s_add_u32 s57, s70, 0
    buffer_load_dwordx4 v4, s[8:11], s57 offen  lds
    s_add_u32 m0, s56, 102400
    s_add_u32 s57, s70, 40960
    buffer_load_dwordx4 v4, s[8:11], s57 offen  lds
    s_add_u32 m0, s56, 106496
    s_add_u32 s57, s70, 81920
    buffer_load_dwordx4 v4, s[8:11], s57 offen  lds
    s_add_u32 m0, s56, 110592
    s_add_u32 s57, s70, 122880
    buffer_load_dwordx4 v4, s[8:11], s57 offen  lds
    s_bfe_u32 s70, s95, 262148
    s_mul_i32 s70, s70, 128
    s_add_u32 m0, s56, 114688
    s_add_u32 s57, s71, 0
    buffer_load_dwordx4 v5, s[12:15], s57 offen  lds
    s_add_u32 m0, s56, 118784
    s_add_u32 s57, s71, 61440
    buffer_load_dwordx4 v5, s[12:15], s57 offen  lds
    s_add_u32 m0, s56, 122880
    s_add_u32 s57, s71, 122880
    buffer_load_dwordx4 v5, s[12:15], s57 offen  lds
    s_add_u32 m0, s56, 126976
    s_add_u32 s57, s71, 184320
    buffer_load_dwordx4 v5, s[12:15], s57 offen  lds
    s_bfe_u32 s71, s95, 262148
    s_mul_i32 s71, s71, 245760
    s_waitcnt vmcnt(8) lgkmcnt(0)
    s_barrier
    v_add_u32 v7, 65536, v7
    ds_read_b128 v[208:211], v7 offset:0
    v_add_u32 v8, 65536, v8
    ds_read_b128 v[216:219], v8 offset:0
    ds_read_b128 v[212:215], v7 offset:2048
    ds_read_b128 v[220:223], v8 offset:2048
    s_add_u32 m0, s56, 131072
    s_add_u32 s57, s70, 0
    buffer_load_dwordx4 v4, s[8:11], s57 offen  lds
    s_add_u32 m0, s56, 135168
    s_add_u32 s57, s70, 40960
    buffer_load_dwordx4 v4, s[8:11], s57 offen  lds
    s_add_u32 m0, s56, 139264
    s_add_u32 s57, s70, 81920
    buffer_load_dwordx4 v4, s[8:11], s57 offen  lds
    s_add_u32 m0, s56, 143360
    s_add_u32 s57, s70, 122880
    buffer_load_dwordx4 v4, s[8:11], s57 offen  lds
    s_add_u32 m0, s56, 147456
    s_add_u32 s57, s71, 0
    buffer_load_dwordx4 v5, s[12:15], s57 offen  lds
    s_add_u32 m0, s56, 151552
    s_add_u32 s57, s71, 61440
    buffer_load_dwordx4 v5, s[12:15], s57 offen  lds
    s_add_u32 m0, s56, 155648
    s_add_u32 s57, s71, 122880
    buffer_load_dwordx4 v5, s[12:15], s57 offen  lds
    s_add_u32 m0, s56, 159744
    s_add_u32 s57, s71, 184320
    buffer_load_dwordx4 v5, s[12:15], s57 offen  lds
    s_waitcnt vmcnt(8) lgkmcnt(0)
    s_barrier
    ds_read_b128 v[224:227], v7 offset:32768
    ds_read_b128 v[232:235], v8 offset:32768
    ds_read_b128 v[228:231], v7 offset:34816
    ds_read_b128 v[236:239], v8 offset:34816
    s_add_u32 m0, s56, 0
    s_add_u32 s57, s72, 0
    buffer_load_dwordx4 v6, s[16:19], s57 offen  lds
    s_add_u32 m0, s56, 4096
    s_add_u32 s57, s72, 55296
    buffer_load_dwordx4 v6, s[16:19], s57 offen  lds
    s_add_u32 m0, s56, 8192
    s_add_u32 s57, s72, 110592
    buffer_load_dwordx4 v6, s[16:19], s57 offen  lds
    s_add_u32 m0, s56, 12288
    s_add_u32 s57, s72, 165888
    buffer_load_dwordx4 v6, s[16:19], s57 offen  lds
    s_bfe_u32 s72, s94, 262156
    s_mul_i32 s72, s72, 221184
    s_add_u32 m0, s56, 16384
    s_add_u32 s57, s72, 0
    buffer_load_dwordx4 v6, s[16:19], s57 offen  lds
    s_add_u32 m0, s56, 20480
    s_add_u32 s57, s72, 55296
    buffer_load_dwordx4 v6, s[16:19], s57 offen  lds
    s_add_u32 m0, s56, 24576
    s_add_u32 s57, s72, 110592
    buffer_load_dwordx4 v6, s[16:19], s57 offen  lds
    s_add_u32 m0, s56, 28672
    s_add_u32 s57, s72, 165888
    buffer_load_dwordx4 v6, s[16:19], s57 offen  lds
    s_bfe_u32 s72, s94, 262144
    s_mul_i32 s72, s72, 221184
    s_waitcnt vmcnt(8) lgkmcnt(0)
    s_barrier
    v_add_u32 v7, 32768, v7
    ds_read_b128 v[240:243], v7 offset:32768
    v_add_u32 v8, 32768, v8
    ds_read_b128 v[248:251], v8 offset:32768
    ds_read_b128 v[244:247], v7 offset:34816
    ds_read_b128 v[252:255], v8 offset:34816
    s_add_u32 m0, s56, 32768
    s_add_u32 s57, s72, 0
    buffer_load_dwordx4 v6, s[16:19], s57 offen  lds
    s_add_u32 m0, s56, 36864
    s_add_u32 s57, s72, 55296
    buffer_load_dwordx4 v6, s[16:19], s57 offen  lds
    s_add_u32 m0, s56, 40960
    s_add_u32 s57, s72, 110592
    buffer_load_dwordx4 v6, s[16:19], s57 offen  lds
    s_add_u32 m0, s56, 45056
    s_add_u32 s57, s72, 165888
    buffer_load_dwordx4 v6, s[16:19], s57 offen  lds
    s_bfe_u32 s72, s94, 262148
    s_mul_i32 s72, s72, 221184
    s_add_u32 m0, s56, 49152
    s_add_u32 s57, s72, 0
    buffer_load_dwordx4 v6, s[16:19], s57 offen  lds
    s_add_u32 m0, s56, 53248
    s_add_u32 s57, s72, 55296
    buffer_load_dwordx4 v6, s[16:19], s57 offen  lds
    s_add_u32 m0, s56, 57344
    s_add_u32 s57, s72, 110592
    buffer_load_dwordx4 v6, s[16:19], s57 offen  lds
    s_add_u32 m0, s56, 61440
    s_add_u32 s57, s72, 165888
    buffer_load_dwordx4 v6, s[16:19], s57 offen  lds
    s_bfe_u32 s72, s94, 262160
    s_mul_i32 s72, s72, 221184
    v_lshrrev_b32 v12, 4, v0
    v_bfe_u32 v13, v0, 2, 2
    v_and_b32 v14, 3, v0
    v_lshl_add_u32 v15, v12, 3, v13
    v_lshlrev_b32 v15, 8, v15
    v_lshl_add_u32 v15, v14, 3, v15
    v_and_b32 v12, 1, v12
    v_lshl_add_u32 v12, v12, 2, v13
    v_xor_b32 v13, 0, v12
    v_lshl_add_u32 v1, v13, 5, v15
    v_xor_b32 v13, 1, v12
    v_lshl_add_u32 v2, v13, 5, v15
    v_xor_b32 v13, 2, v12
    v_lshl_add_u32 v4, v13, 5, v15
    v_xor_b32 v13, 3, v12
    v_lshl_add_u32 v5, v13, 5, v15
    v_xor_b32 v13, 4, v12
    v_lshl_add_u32 v7, v13, 5, v15
    v_xor_b32 v13, 5, v12
    v_lshl_add_u32 v8, v13, 5, v15
    v_xor_b32 v13, 6, v12
    v_lshl_add_u32 v9, v13, 5, v15
    v_xor_b32 v13, 7, v12
    v_lshl_add_u32 v10, v13, 5, v15
    s_branch Lpb
.p2align 12
Lgate:
    s_lshl3_add_u32 s70, s4, s3
    v_and_b32 v10, 15, v0
    v_lshlrev_b32 v11, 2, v3
    s_bitcmp1_b32 s4, 2
    s_cselect_b32 s71, 5, 0
    s_mov_b32 s57, 18789
    v_bfe_u32 v12, s57, v11, 4
    v_add_u32 v12, s71, v12
    v_subrev_u32 v13, 10, v12
    v_min_u32 v12, v12, v13
    v_mul_u32_u24 v13, 1280, v10
    v_lshl_add_u32 v12, v12, 7, v13
    s_mul_i32 s58, s70, 20480
    buffer_load_dword v127, v12, s[8:11], s58 offen
    s_barrier
    s_load_dwordx2 s[16:17], s[0:1], 32
    s_load_dwordx2 s[20:21], s[0:1], 88
    s_load_dwordx2 s[44:45], s[0:1], 64
    s_load_dwordx2 s[48:49], s[0:1], 80
    s_load_dwordx2 s[24:25], s[0:1], 48
    s_load_dwordx2 s[28:29], s[0:1], 16
    s_load_dwordx2 s[32:33], s[0:1], 72
    s_load_dwordx2 s[40:41], s[0:1], 56
    s_mov_b32 s18, 2211840
    s_mov_b32 s19, 0x20000
    s_mov_b32 s22, 22544384
    s_mov_b32 s23, 0x20000
    s_mov_b32 s46, 1280
    s_mov_b32 s47, 0x20000
    s_mov_b32 s50, 256
    s_mov_b32 s51, 0x20000
    s_mov_b32 s26, 2211840
    s_mov_b32 s27, 0x20000
    s_mov_b32 s30, 819200
    s_mov_b32 s31, 0x20000
    s_mov_b32 s34, 2621440
    s_mov_b32 s35, 0x20000
    s_mov_b32 s42, 1280
    s_mov_b32 s43, 0x20000
    v_mul_u32_u24 v6, 3456, v2
    v_add_u32 v6, v6, v7
    s_cmp_ge_u32 s5, 14
    s_cselect_b32 s57, 2130706432, 0
    v_add_u32 v6, s57, v6
    s_lshr_b32 s6, s2, 5
    s_lshr_b32 s58, s2, 3
    s_and_b32 s58, s58, 3
    s_and_b32 s57, s2, 7
    s_lshl_b32 s7, s57, 2
    s_add_u32 s7, s7, s58
    s_mov_b32 s61, s6
    s_mov_b32 s60, s7
    s_waitcnt lgkmcnt(0)
    s_mul_i32 s57, s70, 3072
    v_lshlrev_b32 v12, 4, v0
    v_mov_b32 v64, 0
    v_mov_b32 v65, 0
    v_mov_b32 v66, 0
    v_mov_b32 v67, 0
    buffer_store_dwordx4 v[64:67], v12, s[20:23], s57 offen offset:0 sc1
    buffer_store_dwordx4 v[64:67], v12, s[20:23], s57 offen offset:1024 sc1
    buffer_store_dwordx4 v[64:67], v12, s[20:23], s57 offen offset:2048 sc1
    s_mov_b32 s57, 30840
    v_bfe_u32 v12, s57, v11, 4
    v_add_u32 v12, s71, v12
    v_subrev_u32 v13, 10, v12
    v_min_u32 v12, v12, v13
    v_mul_u32_u24 v13, 1280, v10
    v_lshl_add_u32 v12, v12, 7, v13
    s_mul_i32 s58, s70, 20480
    buffer_load_dword v127, v12, s[8:11], s58 offen
    s_waitcnt vmcnt(1)
    s_barrier
    s_lshl_b32 s58, s4, 2
    s_cmp_lg_u32 s3, 0
    s_cselect_b32 s58, 2130706432, s58
    v_mov_b32 v12, 1
    s_mov_b64 exec, 1
    buffer_store_dword v12, v64, s[48:51], s58 offen sc1
    s_mov_b64 exec, -1
    v_lshlrev_b32 v12, 7, v0
    s_lshl_b32 s58, s70, 13
    s_add_u32 s58, s58, 0
    buffer_load_dword v127, v12, s[16:19], s58 offen
    v_lshlrev_b32 v12, 7, v0
    s_lshl_b32 s58, s70, 13
    s_add_u32 s58, s58, 1048576
    buffer_load_dword v127, v12, s[16:19], s58 offen
    v_lshlrev_b32 v12, 7, v0
    s_lshl_b32 s58, s70, 13
    s_add_u32 s58, s58, 2097152
    buffer_load_dword v127, v12, s[16:19], s58 offen
    s_cmp_ge_u32 s3, 4
    s_cbranch_scc1 Lgate_g
    s_and_b32 s79, s6, 7
    s_lshl_b32 s79, s79, 2
    s_add_u32 s79, s79, s62
    s_add_u32 s79, s79, 0
    s_and_b32 s79, s79, 31
    s_mul_i32 s78, s7, 163840
    s_add_u32 s78, s78, 4194304
    s_mul_i32 s96, s62, 6144
    s_mul_i32 s57, s7, 20
    s_add_u32 s58, s57, 19
    s_lshr_b32 s57, s57, 6
    s_lshr_b32 s58, s58, 6
    s_sub_u32 s58, s58, s57
    v_and_b32 v64, 1, v0
    v_mul_u32_u24 v64, s58, v64
    v_add_u32 v65, s57, v64
    v_bfe_u32 v3, v0, 1, 1
    v_mul_u32_u24 v3, 10, v3
    v_add3_u32 v64, v65, v3, 10
    v_cmp_gt_u32 vcc, 4, v0
    v_lshlrev_b32 v22, 4, v0
    v_lshrrev_b32 v66, 5, v0
    s_lshl_b32 s59, s6, 2
    s_add_u32 s59, s59, s62
    v_lshl_add_u32 v64, v64, 5, s79
    v_lshl_add_u32 v65, v65, 5, s59
    v_cndmask_b32 v2, v65, v64, vcc
    v_lshlrev_b32 v18, 7, v2
    v_and_b32 v67, 15, v0
    v_bfe_u32 v68, v0, 4, 1
    v_mul_u32_u24 v2, 1280, v68
    v_lshl_add_u32 v20, v67, 4, v2
    v_lshl_add_u32 v19, v66, 8, v20
    v_lshlrev_b32 v2, 7, v68
    v_lshl_add_u32 v21, v67, 2, v2
    s_lshl_b32 s57, s7, 6
    s_lshl_b32 s58, s6, 3
    s_lshl_b32 s59, s3, 1
    s_add_u32 s58, s58, s59
    s_add_u32 s57, s57, s58
    s_mul_i32 s76, s57, 1280
    s_add_u32 s76, s76, 1048576
    s_lshl_b32 s77, s58, 7
    s_add_u32 s77, s77, 393216
    v_and_b32 v69, 31, v0
    v_mul_u32_u24 v2, 40960, v68
    v_lshl_add_u32 v5, v67, 3, v2
    v_lshl_add_u32 v2, v67, 4, v2
    v_lshl_add_u32 v4, v66, 8, v2
    s_lshr_b32 s57, s7, 1
    s_and_b32 s57, s57, 3
    s_and_b32 s58, s7, 1
    s_lshl_b32 s67, s57, 10
    s_lshl_b32 s68, s58, 9
    s_add_u32 s67, s67, s68
    v_add_u32 v4, s67, v4
    s_lshl_b32 s67, s57, 7
    s_add_u32 s67, s67, s68
    s_add_u32 s67, s67, 4096
    v_add_u32 v5, s67, v5
    s_lshl_b32 s59, s6, 2
    s_add_u32 s59, s59, s3
    s_mul_i32 s67, s59, 81920
    s_lshr_b32 s68, s7, 3
    s_mul_i32 s68, s68, 5120
    s_add_u32 s67, s67, s68
    s_add_u32 s97, s67, 16777216
    s_add_u32 s52, s97, 20480
    s_lshl_b32 s58, s59, 5
    s_add_u32 s58, s58, s7
    s_lshl_b32 s58, s58, 7
    s_add_u32 s53, s58, 262144
    v_and_b32 v26, 31, v0
    v_lshrrev_b32 v27, 5, v0
    s_lshl_b32 s57, s62, 1
    v_add_u32 v27, s57, v27
    v_mul_u32_u24 v27, 3072, v27
    v_lshl_add_u32 v23, v26, 4, v27
    v_and_b32 v27, 23, v26
    v_cmp_eq_u32 vcc, 16, v27
    v_mov_b32 v27, 0x3f803f80
    v_mov_b32 v24, 0x3f80
    v_cndmask_b32 v25, 0, v27, vcc
    v_cmp_eq_u32 vcc, 20, v26
    v_mov_b32 v26, v25
    v_mov_b32 v27, v25
    v_cndmask_b32 v24, v25, v24, vcc
    v_bfe_u32 v3, v0, 3, 2
    v_and_b32 v70, 3, v0
    v_lshl_add_u32 v3, v3, 2, v70
    v_bfe_u32 v70, v0, 2, 1
    v_lshlrev_b32 v70, 3, v70
    v_lshl_add_u32 v2, v3, 4, v70
    v_lshl_add_u32 v28, v66, 8, v2
    v_cmp_gt_u32 vcc, 32, v0
    v_add_u32 v2, 1024, v2
    v_mov_b32 v3, 2880
    v_cndmask_b32 v29, v3, v2, vcc
    v_mov_b32 v17, 0xdddddddd
    v_add_u32 v2, 0, v66
    v_mul_u32_u24 v3, 320, v2
    v_lshl_add_u32 v3, v69, 4, v3
    v_add_u32 v3, 1280, v3
    v_lshlrev_b32 v2, 2, v2
    v_add_u32 v2, 12, v2
    v_and_b32 v2, 15, v2
    v_lshlrev_b32 v2, 4, v2
    v_add_u32 v2, 2560, v2
    v_cmp_gt_u32 vcc, 28, v69
    v_mov_b32 v70, 2704
    v_mov_b32 v71, 2944
    v_cndmask_b32 v2, v2, v70, vcc
    v_cmp_eq_u32 vcc, 20, v69
    s_nop 1
    v_cndmask_b32 v2, v2, v71, vcc
    v_cmp_gt_u32 vcc, 20, v69
    s_nop 1
    v_cndmask_b32 v30, v2, v3, vcc
    v_add_u32 v2, 2, v66
    v_mul_u32_u24 v3, 320, v2
    v_lshl_add_u32 v3, v69, 4, v3
    v_add_u32 v3, 1280, v3
    v_lshlrev_b32 v2, 2, v2
    v_add_u32 v2, 12, v2
    v_and_b32 v2, 15, v2
    v_lshlrev_b32 v2, 4, v2
    v_add_u32 v2, 2560, v2
    v_cmp_gt_u32 vcc, 28, v69
    v_mov_b32 v70, 2576
    v_mov_b32 v71, 2816
    v_cndmask_b32 v2, v2, v70, vcc
    v_cmp_eq_u32 vcc, 20, v69
    s_nop 1
    v_cndmask_b32 v2, v2, v71, vcc
    v_cmp_gt_u32 vcc, 20, v69
    s_nop 1
    v_cndmask_b32 v31, v2, v3, vcc
    v_mov_b32 v32, 0
    v_mov_b32 v33, 0
    v_mov_b32 v34, 0
    v_mov_b32 v35, 0
    v_mov_b32 v36, 0
    v_mov_b32 v37, 0
    v_mov_b32 v38, 0
    v_mov_b32 v39, 0
    v_mov_b32 v48, 0
    v_mov_b32 v49, 0
    v_mov_b32 v50, 0
    v_mov_b32 v51, 0
    v_mov_b32 v52, 0
    v_mov_b32 v53, 0
    v_mov_b32 v54, 0
    v_mov_b32 v55, 0
    v_mov_b32 v56, 0
    v_mov_b32 v57, 0
    v_mov_b32 v58, 0
    v_mov_b32 v59, 0
    v_mov_b32 v60, 0
    v_mov_b32 v61, 0
    v_mov_b32 v62, 0
    v_mov_b32 v63, 0
    s_lshl_b32 s57, s60, 1
    v_lshrrev_b32 v2, 1, v0
    v_min_u32 v2, 14, v2
    v_and_b32 v3, 1, v0
    v_lshl_add_u32 v2, v2, 6, v3
    v_add_u32 v2, s57, v2
    s_lshl_b32 s57, s6, 3
    s_add_u32 s57, s57, 896
    v_cmp_gt_u32 vcc, 32, v0
    v_and_b32 v3, 7, v0
    v_add_u32 v3, s57, v3
    v_cndmask_b32 v2, v3, v2, vcc
    v_subrev_u32 v3, 40, v0
    v_lshlrev_b32 v3, 2, v3
    v_add_u32 v3, s62, v3
    s_mul_i32 s57, s62, 5
    v_min_u32 v1, 58, v0
    v_cmp_gt_u32 vcc, 54, v0
    v_add_u32 v1, s57, v1
    s_lshr_b32 s57, s61, 2
    v_cndmask_b32 v3, v1, v3, vcc
    s_sub_u32 s57, 255, s57
    s_lshl_b32 s57, s57, 2
    s_and_b32 s58, s61, 3
    s_add_u32 s57, s57, s58
    v_lshlrev_b32 v3, 3, v3
    v_cmp_gt_u32 vcc, 40, v0
    v_sub_u32 v3, s57, v3
    s_nop 0
    v_cndmask_b32 v2, v3, v2, vcc
    v_lshlrev_b32 v2, 7, v2
    v_add_u32 v44, 131072, v2
    v_lshrrev_b32 v2, 2, v0
    v_mul_u32_u24 v2, 160, v2
    v_and_b32 v3, 3, v0
    v_lshl_add_u32 v2, v3, 3, v2
    s_add_u32 s57, s96, 122880
    v_add_u32 v45, s57, v2
    s_add_u32 s58, s62, s61
    s_and_b32 s58, s58, 3
    s_lshl_b32 s58, s58, 4
    s_lshl_b32 s57, s60, 6
    s_add_u32 s57, s57, s58
    v_and_b32 v2, 15, v0
    v_add_u32 v2, s57, v2
    v_mul_u32_u24 v2, 1280, v2
    v_lshrrev_b32 v3, 4, v0
    v_lshl_add_u32 v2, v3, 3, v2
    s_mul_i32 s57, s61, 160
    v_add_u32 v47, s57, v2
    s_mul_i32 s57, s62, 20480
    s_add_u32 s57, s57, 49152
    v_add_u32 v46, s57, v22
    s_lshl_b32 s57, s60, 5
    s_lshl_b32 s58, s62, 3
    s_add_u32 s57, s57, s58
    s_add_u32 s57, s57, 2048
    v_and_b32 v2, 7, v0
    v_add_u32 v2, s57, v2
    v_lshlrev_b32 v40, 7, v2
    s_add_u32 s57, s62, 3
    s_and_b32 s57, s57, 3
    s_mul_i32 s57, s57, 20480
    s_add_u32 s57, s57, 49152
    v_add_u32 v41, s57, v22
    s_add_u32 s57, s62, 2
    s_and_b32 s57, s57, 3
    s_mul_i32 s57, s57, 20480
    s_add_u32 s57, s57, 54272
    v_add_u32 v42, s57, v22
    s_add_u32 s57, s62, 1
    s_and_b32 s57, s57, 3
    s_mul_i32 s57, s57, 20480
    s_add_u32 s57, s57, 59392
    v_add_u32 v43, s57, v22
    s_lshl_b32 s57, s62, 11
    s_add_u32 s57, s57, 147456
    v_add_u32 v1, s57, v22
    v_mov_b32 v13, 2130706432
    v_mov_b32 v14, 2130706432
    v_mov_b32 v15, 2130706432
    v_mov_b32 v16, 2130706432
    v_and_b32 v2, 15, v0
    v_lshlrev_b32 v2, 2, v2
    s_mov_b32 s64, 524288
Lpoll_11:
    buffer_load_dword v3, v2, s[48:51], 0 offen sc1
    s_sub_u32 s64, s64, 1
    s_cbranch_scc1 Lpolld_12
    s_waitcnt vmcnt(0)
    v_cmp_ne_u32 vcc, 1, v3
    s_cbranch_vccz Lpolld_12
    s_sleep 32
    s_branch Lpoll_11
Lpolld_12:
    s_waitcnt vmcnt(0)
    s_mov_b32 s64, 524288
Lpoll_13:
    buffer_load_dword v3, v18, s[20:23], 0 offen sc1
    s_sub_u32 s64, s64, 1
    s_cbranch_scc1 Lpolld_14
    s_waitcnt vmcnt(0)
    v_cmp_ne_u32 vcc, 1, v3
    s_cbranch_vccz Lpolld_14
    s_sleep 8
    s_branch Lpoll_13
Lpolld_14:
    s_waitcnt vmcnt(0)
    s_branch Lattn
Lgate_g:
    s_and_b32 s74, s6, 7
    s_lshl_b32 s74, s74, 2
    s_add_u32 s74, s74, s62
    s_add_u32 s74, s74, 4
    s_and_b32 s74, s74, 31
    s_mul_i32 s73, s7, 163840
    s_add_u32 s73, s73, 4194304
    s_mul_i32 s75, s62, 6144
    s_mul_i32 s57, s7, 20
    s_add_u32 s58, s57, 19
    s_lshr_b32 s57, s57, 6
    s_lshr_b32 s58, s58, 6
    s_sub_u32 s58, s58, s57
    v_and_b32 v30, 1, v0
    v_mul_u32_u24 v30, s58, v30
    v_add_u32 v31, s57, v30
    v_bfe_u32 v28, v0, 1, 1
    v_mul_u32_u24 v28, 10, v28
    v_add3_u32 v30, v31, v28, 10
    v_lshrrev_b32 v28, 2, v0
    v_min_u32 v28, 6, v28
    v_lshlrev_b32 v28, 2, v28
    v_add_u32 v28, s74, v28
    v_and_b32 v28, 31, v28
    v_lshl_add_u32 v28, v30, 5, v28
    v_lshlrev_b32 v11, 7, v28
    v_mul_u32_u24 v28, 26, v0
    v_lshrrev_b32 v28, 8, v28
    v_mul_u32_u24 v28, 1120, v28
    v_lshl_add_u32 v3, v0, 4, v28
    s_add_u32 s50, s62, s61
    s_and_b32 s50, s50, 3
    s_add_u32 s57, s50, 1
    s_and_b32 s57, s57, 3
    s_lshl_b32 s58, s60, 2
    s_add_u32 s76, s57, s58
    s_add_u32 s57, s50, 2
    s_and_b32 s57, s57, 3
    s_lshl_b32 s58, s60, 2
    s_add_u32 s77, s57, s58
    s_add_u32 s57, s50, 3
    s_and_b32 s57, s57, 3
    s_lshl_b32 s58, s60, 2
    s_add_u32 s78, s57, s58
    s_add_u32 s57, s50, 4
    s_and_b32 s57, s57, 3
    s_lshl_b32 s58, s60, 2
    s_add_u32 s79, s57, s58
    s_lshl_b32 s57, s5, 4
    s_add_u32 s57, s57, s4
    s_lshl_b32 s51, s57, 2
    s_add_u32 s51, s51, s62
    s_lshl_b32 s51, s51, 7
    s_add_u32 s51, s51, 131072
    s_sub_u32 s57, 255, s57
    s_lshr_b32 s58, s57, 1
    s_and_b32 s57, s57, 1
    s_lshl_b32 s57, s57, 2
    s_add_u32 s57, s57, s62
    s_mul_i32 s48, s58, 40960
    s_mul_i32 s59, s57, 5120
    s_add_u32 s48, s48, s59
    s_add_u32 s48, s48, 19398656
    s_mul_i32 s49, s57, 160
    s_mov_b32 s55, 0x20000
    s_cmp_lt_u32 s58, 54
    s_cbranch_scc1 Lpw2_15
    s_mov_b64 s[52:53], s[28:29]
    s_mov_b32 s54, 819200
    s_cmp_ge_u32 s58, 74
    s_cselect_b32 s48, 2130706432, s48
    s_sub_u32 s58, s58, 54
    s_mul_i32 s59, s58, 205
    s_lshr_b32 s59, s59, 10
    s_mul_i32 s67, s59, 5
    s_sub_u32 s67, s58, s67
    s_mul_i32 s59, s59, 160
    s_mul_i32 s68, s67, 40
    s_cmp_eq_u32 s67, 4
    s_cselect_b32 s68, 16, s68
    s_cselect_b32 s96, 20, 8
    s_cselect_b32 s97, 80, 20
    s_cselect_b32 s98, 40, 4
    s_add_u32 s99, s59, s68
    s_branch Lpj_16
Lpw2_15:
    s_mov_b64 s[52:53], s[24:25]
    s_mov_b32 s54, 2211840
    s_mov_b32 s96, 16
    s_mov_b32 s97, 8
    s_mov_b32 s98, 4
    s_lshl_b32 s99, s58, 5
Lpj_16:
    s_mul_i32 s96, s96, 1280
    s_mul_i32 s97, s97, 1280
    s_mul_i32 s98, s98, 1280
    s_mul_i32 s99, s99, 1280
    s_add_u32 s99, s99, s49
    s_lshl_b32 s57, s4, 3
    s_lshl_b32 s58, s62, 1
    s_add_u32 s57, s57, s58
    s_mul_i32 s57, s57, 54
    s_lshl_b32 s58, s5, 2
    s_add_u32 s57, s57, s58
    s_lshl_b32 s57, s57, 10
    s_add_u32 s57, s57, 9437184
    s_cmp_ge_u32 s5, 14
    s_cselect_b32 s66, 2130706432, s57
    s_cmp_ge_u32 s5, 13
    s_cselect_b32 s65, 2130706432, s57
    v_mov_b32 v6, 0
    s_waitcnt vmcnt(0)
    s_branch Lgemm
Lfallback:
    v_bfe_u32 v2, v0, 3, 2
    v_and_b32 v3, 3, v0
    v_lshl_add_u32 v2, v2, 2, v3
    v_bfe_u32 v3, v0, 2, 1
    v_lshlrev_b32 v3, 3, v3
    v_lshl_add_u32 v24, v2, 4, v3
    v_lshrrev_b32 v6, 5, v0
    v_and_b32 v13, 31, v0
    v_lshl_add_u32 v25, v6, 8, v24
    v_mul_u32_u24 v26, 320, v6
    v_lshl_add_u32 v26, v13, 4, v26
    v_cmp_gt_u32 vcc, 20, v13
    s_mov_b64 s[74:75], vcc
    v_cmp_eq_u32 vcc, 20, v13
    v_mov_b32 v2, 0x3f803f80
    v_mov_b32 v20, 0xff800000
    v_mov_b32 v22, 0xff800000
    v_cndmask_b32 v160, 0, v2, vcc
    v_cndmask_b32 v161, 0, v2, vcc
    v_cndmask_b32 v162, 0, v2, vcc
    v_cndmask_b32 v163, 0, v2, vcc
    v_cndmask_b32 v164, 0, v2, vcc
    v_cndmask_b32 v165, 0, v2, vcc
    v_cndmask_b32 v166, 0, v2, vcc
    v_cndmask_b32 v167, 0, v2, vcc
    s_mov_b32 exec_lo, 0
    v_mov_b32 v136, 0
    v_mov_b32 v137, 0
    v_mov_b32 v138, 0
    v_mov_b32 v139, 0
    s_mov_b32 exec_lo, -1
    v_mov_b32 v32, 0
    v_mov_b32 v33, 0
    v_mov_b32 v34, 0
    v_mov_b32 v35, 0
    v_mov_b32 v36, 0
    v_mov_b32 v37, 0
    v_mov_b32 v38, 0
    v_mov_b32 v39, 0
    v_mov_b32 v40, 0
    v_mov_b32 v41, 0
    v_mov_b32 v42, 0
    v_mov_b32 v43, 0
    v_mov_b32 v44, 0
    v_mov_b32 v45, 0
    v_mov_b32 v46, 0
    v_mov_b32 v47, 0
    v_mov_b32 v48, 0
    v_mov_b32 v49, 0
    v_mov_b32 v50, 0
    v_mov_b32 v51, 0
    v_mov_b32 v52, 0
    v_mov_b32 v53, 0
    v_mov_b32 v54, 0
    v_mov_b32 v55, 0
    v_mov_b32 v56, 0
    v_mov_b32 v57, 0
    v_mov_b32 v58, 0
    v_mov_b32 v59, 0
    v_mov_b32 v60, 0
    v_mov_b32 v61, 0
    v_mov_b32 v62, 0
    v_mov_b32 v63, 0
    s_mul_i32 s70, s7, 163840
    s_add_u32 s70, s70, 4194304
    s_mov_b32 s71, 64
Lfb_20:
    buffer_load_dwordx2 v[140:141], v25, s[20:23], s70 offen offset:0 sc1
    buffer_load_dwordx2 v[142:143], v25, s[20:23], s70 offen offset:512 sc1
    buffer_load_dwordx2 v[148:149], v24, s[20:23], s70 offen offset:1024 sc1
    s_waitcnt vmcnt(0)
    v_mfma_f32_32x32x8_bf16 v[64:79], v[148:149], v[136:137], 0
    v_mfma_f32_32x32x8_bf16 v[80:95], v[148:149], v[138:139], 0
    v_mfma_f32_32x32x16_bf16 v[64:79], v[140:143], v[128:131], v[64:79]
    v_mfma_f32_32x32x16_bf16 v[80:95], v[140:143], v[132:135], v[80:95]
    s_nop 11
    v_max3_f32 v2, v64, v65, v66
    v_max3_f32 v2, v2, v67, v68
    v_max3_f32 v2, v2, v69, v70
    v_max3_f32 v2, v2, v71, v72
    v_max3_f32 v2, v2, v73, v74
    v_max3_f32 v2, v2, v75, v76
    v_max3_f32 v2, v2, v77, v78
    v_max_f32 v2, v2, v79
    v_max_f32 v20, v20, v2
    v_max3_f32 v2, v80, v81, v82
    v_max3_f32 v2, v2, v83, v84
    v_max3_f32 v2, v2, v85, v86
    v_max3_f32 v2, v2, v87, v88
    v_max3_f32 v2, v2, v89, v90
    v_max3_f32 v2, v2, v91, v92
    v_max3_f32 v2, v2, v93, v94
    v_max_f32 v2, v2, v95
    v_max_f32 v22, v22, v2
    s_add_u32 s70, s70, 2560
    s_sub_u32 s71, s71, 1
    s_cmp_lg_u32 s71, 0
    s_cbranch_scc1 Lfb_20
    v_mov_b32 v21, v20
    s_nop 1
    v_permlane32_swap_b32 v20, v21
    v_max_f32 v20, v20, v21
    v_mov_b32 v23, v22
    s_nop 1
    v_permlane32_swap_b32 v22, v23
    v_max_f32 v22, v22, v23
    s_mul_i32 s70, s7, 163840
    s_add_u32 s70, s70, 4194304
    s_mov_b32 s71, 64
Lfb_21:
    buffer_load_dwordx2 v[140:141], v25, s[20:23], s70 offen offset:0 sc1
    buffer_load_dwordx2 v[142:143], v25, s[20:23], s70 offen offset:512 sc1
    buffer_load_dwordx2 v[148:149], v24, s[20:23], s70 offen offset:1024 sc1
    s_mov_b64 exec, s[74:75]
    buffer_load_dwordx4 v[160:163], v26, s[20:23], s70 offen offset:1280 sc1
    buffer_load_dwordx4 v[164:167], v26, s[20:23], s70 offen offset:1920 sc1
    s_mov_b64 exec, -1
    s_waitcnt vmcnt(0)
    v_mfma_f32_32x32x8_bf16 v[64:79], v[148:149], v[136:137], 0
    v_mfma_f32_32x32x8_bf16 v[80:95], v[148:149], v[138:139], 0
    v_mfma_f32_32x32x16_bf16 v[64:79], v[140:143], v[128:131], v[64:79]
    v_mfma_f32_32x32x16_bf16 v[80:95], v[140:143], v[132:135], v[80:95]
    s_nop 11
    v_sub_f32 v64, v64, v20
    v_sub_f32 v65, v65, v20
    v_sub_f32 v66, v66, v20
    v_sub_f32 v67, v67, v20
    v_sub_f32 v68, v68, v20
    v_sub_f32 v69, v69, v20
    v_sub_f32 v70, v70, v20
    v_sub_f32 v71, v71, v20
    v_sub_f32 v72, v72, v20
    v_sub_f32 v73, v73, v20
    v_sub_f32 v74, v74, v20
    v_sub_f32 v75, v75, v20
    v_sub_f32 v76, v76, v20
    v_sub_f32 v77, v77, v20
    v_sub_f32 v78, v78, v20
    v_sub_f32 v79, v79, v20
    v_exp_f32 v64, v64
    v_exp_f32 v65, v65
    v_exp_f32 v66, v66
    v_exp_f32 v67, v67
    v_exp_f32 v68, v68
    v_exp_f32 v69, v69
    v_exp_f32 v70, v70
    v_exp_f32 v71, v71
    v_exp_f32 v72, v72
    v_exp_f32 v73, v73
    v_exp_f32 v74, v74
    v_exp_f32 v75, v75
    v_exp_f32 v76, v76
    v_exp_f32 v77, v77
    v_exp_f32 v78, v78
    v_exp_f32 v79, v79
    s_nop 1
    v_smfmac_f32_32x32x32_bf16 v[32:47], v[160:163], v[64:71], v17
    v_smfmac_f32_32x32x32_bf16 v[32:47], v[164:167], v[72:79], v17
    v_sub_f32 v80, v80, v22
    v_sub_f32 v81, v81, v22
    v_sub_f32 v82, v82, v22
    v_sub_f32 v83, v83, v22
    v_sub_f32 v84, v84, v22
    v_sub_f32 v85, v85, v22
    v_sub_f32 v86, v86, v22
    v_sub_f32 v87, v87, v22
    v_sub_f32 v88, v88, v22
    v_sub_f32 v89, v89, v22
    v_sub_f32 v90, v90, v22
    v_sub_f32 v91, v91, v22
    v_sub_f32 v92, v92, v22
    v_sub_f32 v93, v93, v22
    v_sub_f32 v94, v94, v22
    v_sub_f32 v95, v95, v22
    v_exp_f32 v80, v80
    v_exp_f32 v81, v81
    v_exp_f32 v82, v82
    v_exp_f32 v83, v83
    v_exp_f32 v84, v84
    v_exp_f32 v85, v85
    v_exp_f32 v86, v86
    v_exp_f32 v87, v87
    v_exp_f32 v88, v88
    v_exp_f32 v89, v89
    v_exp_f32 v90, v90
    v_exp_f32 v91, v91
    v_exp_f32 v92, v92
    v_exp_f32 v93, v93
    v_exp_f32 v94, v94
    v_exp_f32 v95, v95
    s_nop 1
    v_smfmac_f32_32x32x32_bf16 v[48:63], v[160:163], v[80:87], v17
    v_smfmac_f32_32x32x32_bf16 v[48:63], v[164:167], v[88:95], v17
    s_add_u32 s70, s70, 2560
    s_sub_u32 s71, s71, 1
    s_cmp_lg_u32 s71, 0
    s_cbranch_scc1 Lfb_21
    s_nop 11
    v_mov_b32 v12, v40
    v_mov_b32 v13, v40
    s_nop 0
    s_nop 0
    v_permlane32_swap_b32 v12, v13
    s_nop 0
    v_rcp_f32 v12, v13
    s_nop 0
    s_nop 0
    s_nop 0
    v_mul_f32 v12, v12, v10
    v_pk_mul_f32 v[32:33], v[32:33], v[12:13] op_sel_hi:[1,0]
    v_pk_mul_f32 v[34:35], v[34:35], v[12:13] op_sel_hi:[1,0]
    v_pk_mul_f32 v[36:37], v[36:37], v[12:13] op_sel_hi:[1,0]
    v_pk_mul_f32 v[38:39], v[38:39], v[12:13] op_sel_hi:[1,0]
    v_pk_mul_f32 v[40:41], v[40:41], v[12:13] op_sel_hi:[1,0]
    v_pk_mul_f32 v[42:43], v[42:43], v[12:13] op_sel_hi:[1,0]
    v_cvt_pk_bf16_f32 v32, v32, v33
    v_cvt_pk_bf16_f32 v33, v34, v35
    v_cvt_pk_bf16_f32 v34, v36, v37
    v_cvt_pk_bf16_f32 v35, v38, v39
    v_cvt_pk_bf16_f32 v36, v40, v41
    v_cvt_pk_bf16_f32 v37, v42, v43
    v_mov_b32 v14, v56
    v_mov_b32 v15, v56
    s_nop 0
    s_nop 0
    v_permlane32_swap_b32 v14, v15
    s_nop 0
    v_rcp_f32 v14, v15
    s_nop 0
    s_nop 0
    s_nop 0
    v_mul_f32 v14, v14, v11
    s_branch Lnorm
Lend:
    s_endpgm
.fill 20, 4, 0xbf800000
La1:
    s_load_dwordx2 s[16:17], s[0:1], 32
    s_load_dwordx2 s[20:21], s[0:1], 88
    s_load_dwordx2 s[44:45], s[0:1], 64
    s_load_dwordx2 s[48:49], s[0:1], 80
    s_load_dwordx2 s[24:25], s[0:1], 48
    s_load_dwordx2 s[28:29], s[0:1], 16
    s_load_dwordx2 s[32:33], s[0:1], 72
    s_load_dwordx2 s[40:41], s[0:1], 56
    s_mov_b32 s18, 2211840
    s_mov_b32 s19, 0x20000
    s_mov_b32 s22, 22544384
    s_mov_b32 s23, 0x20000
    s_mov_b32 s46, 1280
    s_mov_b32 s47, 0x20000
    s_mov_b32 s50, 256
    s_mov_b32 s51, 0x20000
    s_mov_b32 s26, 2211840
    s_mov_b32 s27, 0x20000
    s_mov_b32 s30, 819200
    s_mov_b32 s31, 0x20000
    s_mov_b32 s34, 2621440
    s_mov_b32 s35, 0x20000
    s_mov_b32 s42, 1280
    s_mov_b32 s43, 0x20000
    v_mul_u32_u24 v6, 3456, v2
    v_add_u32 v6, v6, v7
    s_cmp_ge_u32 s5, 14
    s_cselect_b32 s57, 2130706432, 0
    v_add_u32 v6, s57, v6
    s_lshr_b32 s6, s2, 5
    s_lshr_b32 s58, s2, 3
    s_and_b32 s58, s58, 3
    s_and_b32 s57, s2, 7
    s_lshl_b32 s7, s57, 2
    s_add_u32 s7, s7, s58
    s_mov_b32 s61, s6
    s_mov_b32 s60, s7
    s_waitcnt lgkmcnt(0)
    v_mov_b32 v125, v4
    v_mov_b32 v126, v5
    s_and_b32 s73, s3, 1
    s_lshr_b32 s74, s3, 1
    s_lshl_b32 s57, s73, 6
    v_lshrrev_b32 v3, 4, v0
    v_and_b32 v2, 15, v0
    v_add_u32 v7, s57, v2
    v_lshlrev_b32 v7, 7, v7
    v_lshrrev_b32 v20, 1, v2
    v_xor_b32 v20, v20, v3
    v_xor_b32 v21, 4, v20
    v_lshl_add_u32 v8, v21, 4, v7
    v_lshl_add_u32 v7, v20, 4, v7
    s_lshl_b32 s57, s74, 2
    v_lshrrev_b32 v20, 4, v0
    v_bfe_u32 v21, v0, 2, 2
    v_and_b32 v22, 3, v0
    v_lshl_add_u32 v23, v20, 3, v21
    v_lshlrev_b32 v23, 8, v23
    v_lshl_add_u32 v23, v22, 3, v23
    v_and_b32 v20, 1, v20
    v_lshl_add_u32 v20, v20, 2, v21
    v_xor_b32 v20, s57, v20
    v_xor_b32 v21, 0, v20
    v_lshl_add_u32 v9, v21, 5, v23
    v_xor_b32 v21, 1, v20
    v_lshl_add_u32 v10, v21, 5, v23
    v_xor_b32 v21, 2, v20
    v_lshl_add_u32 v11, v21, 5, v23
    v_xor_b32 v21, 3, v20
    v_lshl_add_u32 v12, v21, 5, v23
    s_mul_i32 s57, s5, 205
    s_lshr_b32 s57, s57, 10
    s_mul_i32 s58, s57, 5
    s_sub_u32 s58, s5, s58
    s_lshl_b32 s59, s4, 1
    s_add_u32 s59, s59, s73
    s_lshl_b32 s59, s59, 1
    s_cmp_eq_u32 s57, 0
    s_mov_b32 s75, 2560
    s_cselect_b32 s75, 1280, s75
    s_mov_b32 s68, 4194304
    s_cselect_b32 s68, 1048576, s68
    s_mul_i32 s59, s59, s75
    s_add_u32 s68, s68, s59
    s_lshl_b32 s67, s75, 6
    s_cmp_eq_u32 s57, 2
    s_cbranch_scc1 Lstv_3
    s_lshl_b32 s58, s58, 5
    s_lshl_b32 s59, s74, 4
    s_add_u32 s58, s58, s59
    v_add_u32 v22, s58, v3
    v_lshlrev_b32 v17, 4, v2
    v_add_u32 v17, s68, v17
    v_add_u32 v18, 0, v22
    v_mul_u32_u24 v19, 205, v18
    v_lshrrev_b32 v19, 10, v19
    v_mul_u32_u24 v20, 5, v19
    v_sub_u32 v20, v18, v20
    v_mul_lo_u32 v19, v19, s67
    v_lshl_add_u32 v19, v20, 8, v19
    v_add_u32 v13, v19, v17
    v_add_u32 v18, 4, v22
    v_mul_u32_u24 v19, 205, v18
    v_lshrrev_b32 v19, 10, v19
    v_mul_u32_u24 v20, 5, v19
    v_sub_u32 v20, v18, v20
    v_mul_lo_u32 v19, v19, s67
    v_lshl_add_u32 v19, v20, 8, v19
    v_add_u32 v14, v19, v17
    v_add_u32 v18, 8, v22
    v_mul_u32_u24 v19, 205, v18
    v_lshrrev_b32 v19, 10, v19
    v_mul_u32_u24 v20, 5, v19
    v_sub_u32 v20, v18, v20
    v_mul_lo_u32 v19, v19, s67
    v_lshl_add_u32 v19, v20, 8, v19
    v_add_u32 v15, v19, v17
    v_add_u32 v18, 12, v22
    v_mul_u32_u24 v19, 205, v18
    v_lshrrev_b32 v19, 10, v19
    v_mul_u32_u24 v20, 5, v19
    v_sub_u32 v20, v18, v20
    v_mul_lo_u32 v19, v19, s67
    v_lshl_add_u32 v19, v20, 8, v19
    v_add_u32 v16, v19, v17
    s_branch Lstd_4
Lstv_3:
    s_lshl_b32 s58, s58, 7
    s_lshl_b32 s59, s74, 6
    s_add_u32 s58, s58, s59
    v_add_u32 v22, s58, v2
    v_mul_u32_u24 v17, 320, v3
    s_add_u32 s68, s68, 1280
    v_add_u32 v17, s68, v17
    v_add_u32 v18, 0, v22
    v_mul_u32_u24 v19, 3277, v18
    v_lshrrev_b32 v19, 16, v19
    v_mul_u32_u24 v20, 20, v19
    v_sub_u32 v20, v18, v20
    v_mul_lo_u32 v19, v19, s67
    v_lshl_add_u32 v19, v20, 4, v19
    v_add_u32 v13, v19, v17
    v_add_u32 v18, 16, v22
    v_mul_u32_u24 v19, 3277, v18
    v_lshrrev_b32 v19, 16, v19
    v_mul_u32_u24 v20, 20, v19
    v_sub_u32 v20, v18, v20
    v_mul_lo_u32 v19, v19, s67
    v_lshl_add_u32 v19, v20, 4, v19
    v_add_u32 v14, v19, v17
    v_add_u32 v18, 32, v22
    v_mul_u32_u24 v19, 3277, v18
    v_lshrrev_b32 v19, 16, v19
    v_mul_u32_u24 v20, 20, v19
    v_sub_u32 v20, v18, v20
    v_mul_lo_u32 v19, v19, s67
    v_lshl_add_u32 v19, v20, 4, v19
    v_add_u32 v15, v19, v17
    v_add_u32 v18, 48, v22
    v_mul_u32_u24 v19, 3277, v18
    v_lshrrev_b32 v19, 16, v19
    v_mul_u32_u24 v20, 20, v19
    v_sub_u32 v20, v18, v20
    v_mul_lo_u32 v19, v19, s67
    v_lshl_add_u32 v19, v20, 4, v19
    v_add_u32 v16, v19, v17
Lstd_4:
    s_bfe_u32 s72, s94, 262160
    s_mul_i32 s72, s72, 221184
    s_cmp_lt_u32 s5, 5
    s_cselect_b32 s65, 0x3ea52b5c, 1.0
    s_cselect_b32 s69, 0, s4
    s_and_b32 s69, s69, 0
    s_lshl_b32 s58, s5, 1
    s_add_u32 s58, s58, s74
    s_lshl_b32 s58, s58, 5
    s_lshl_b32 s59, s4, 1
    s_add_u32 s58, s58, s59
    s_add_u32 s58, s58, s73
    s_lshl_b32 s66, s58, 7
    s_and_b32 s79, s6, 7
    s_lshl_b32 s79, s79, 2
    s_add_u32 s79, s79, s62
    s_add_u32 s79, s79, 0
    s_and_b32 s79, s79, 31
    s_mul_i32 s78, s7, 163840
    s_add_u32 s78, s78, 4194304
    s_mul_i32 s96, s62, 6144
    s_mul_i32 s57, s7, 20
    s_add_u32 s58, s57, 19
    s_lshr_b32 s57, s57, 6
    s_lshr_b32 s58, s58, 6
    s_sub_u32 s58, s58, s57
    v_and_b32 v64, 1, v0
    v_mul_u32_u24 v64, s58, v64
    v_add_u32 v65, s57, v64
    v_bfe_u32 v3, v0, 1, 1
    v_mul_u32_u24 v3, 10, v3
    v_add3_u32 v64, v65, v3, 10
    v_cmp_gt_u32 vcc, 4, v0
    v_lshlrev_b32 v22, 4, v0
    v_lshrrev_b32 v66, 5, v0
    s_lshl_b32 s59, s6, 2
    s_add_u32 s59, s59, s62
    v_lshl_add_u32 v64, v64, 5, s79
    v_lshl_add_u32 v65, v65, 5, s59
    v_cndmask_b32 v2, v65, v64, vcc
    v_lshlrev_b32 v18, 7, v2
    v_and_b32 v67, 15, v0
    v_bfe_u32 v68, v0, 4, 1
    v_mul_u32_u24 v2, 1280, v68
    v_lshl_add_u32 v20, v67, 4, v2
    v_lshl_add_u32 v19, v66, 8, v20
    v_lshlrev_b32 v2, 7, v68
    v_lshl_add_u32 v21, v67, 2, v2
    s_lshl_b32 s57, s7, 6
    s_lshl_b32 s58, s6, 3
    s_lshl_b32 s59, s3, 1
    s_add_u32 s58, s58, s59
    s_add_u32 s57, s57, s58
    s_mul_i32 s76, s57, 1280
    s_add_u32 s76, s76, 1048576
    s_lshl_b32 s77, s58, 7
    s_add_u32 s77, s77, 393216
    v_and_b32 v69, 31, v0
    v_mul_u32_u24 v2, 40960, v68
    v_lshl_add_u32 v5, v67, 3, v2
    v_lshl_add_u32 v2, v67, 4, v2
    v_lshl_add_u32 v4, v66, 8, v2
    s_lshr_b32 s57, s7, 1
    s_and_b32 s57, s57, 3
    s_and_b32 s58, s7, 1
    s_lshl_b32 s67, s57, 10
    s_lshl_b32 s68, s58, 9
    s_add_u32 s67, s67, s68
    v_add_u32 v4, s67, v4
    s_lshl_b32 s67, s57, 7
    s_add_u32 s67, s67, s68
    s_add_u32 s67, s67, 4096
    v_add_u32 v5, s67, v5
    s_lshl_b32 s59, s6, 2
    s_add_u32 s59, s59, s3
    s_mul_i32 s67, s59, 81920
    s_lshr_b32 s68, s7, 3
    s_mul_i32 s68, s68, 5120
    s_add_u32 s67, s67, s68
    s_add_u32 s97, s67, 16777216
    s_add_u32 s52, s97, 20480
    s_lshl_b32 s58, s59, 5
    s_add_u32 s58, s58, s7
    s_lshl_b32 s58, s58, 7
    s_add_u32 s53, s58, 262144
    v_and_b32 v26, 31, v0
    v_lshrrev_b32 v27, 5, v0
    s_lshl_b32 s57, s62, 1
    v_add_u32 v27, s57, v27
    v_mul_u32_u24 v27, 3072, v27
    v_lshl_add_u32 v23, v26, 4, v27
    v_and_b32 v27, 23, v26
    v_cmp_eq_u32 vcc, 16, v27
    v_mov_b32 v27, 0x3f803f80
    v_mov_b32 v24, 0x3f80
    v_cndmask_b32 v25, 0, v27, vcc
    v_cmp_eq_u32 vcc, 20, v26
    v_mov_b32 v26, v25
    v_mov_b32 v27, v25
    v_cndmask_b32 v24, v25, v24, vcc
    v_bfe_u32 v3, v0, 3, 2
    v_and_b32 v70, 3, v0
    v_lshl_add_u32 v3, v3, 2, v70
    v_bfe_u32 v70, v0, 2, 1
    v_lshlrev_b32 v70, 3, v70
    v_lshl_add_u32 v2, v3, 4, v70
    v_lshl_add_u32 v28, v66, 8, v2
    v_cmp_gt_u32 vcc, 32, v0
    v_add_u32 v2, 1024, v2
    v_mov_b32 v3, 2880
    v_cndmask_b32 v29, v3, v2, vcc
    v_mov_b32 v17, 0xdddddddd
    v_add_u32 v2, 0, v66
    v_mul_u32_u24 v3, 320, v2
    v_lshl_add_u32 v3, v69, 4, v3
    v_add_u32 v3, 1280, v3
    v_lshlrev_b32 v2, 2, v2
    v_add_u32 v2, 12, v2
    v_and_b32 v2, 15, v2
    v_lshlrev_b32 v2, 4, v2
    v_add_u32 v2, 2560, v2
    v_cmp_gt_u32 vcc, 28, v69
    v_mov_b32 v70, 2704
    v_mov_b32 v71, 2944
    v_cndmask_b32 v2, v2, v70, vcc
    v_cmp_eq_u32 vcc, 20, v69
    s_nop 1
    v_cndmask_b32 v2, v2, v71, vcc
    v_cmp_gt_u32 vcc, 20, v69
    s_nop 1
    v_cndmask_b32 v30, v2, v3, vcc
    v_add_u32 v2, 2, v66
    v_mul_u32_u24 v3, 320, v2
    v_lshl_add_u32 v3, v69, 4, v3
    v_add_u32 v3, 1280, v3
    v_lshlrev_b32 v2, 2, v2
    v_add_u32 v2, 12, v2
    v_and_b32 v2, 15, v2
    v_lshlrev_b32 v2, 4, v2
    v_add_u32 v2, 2560, v2
    v_cmp_gt_u32 vcc, 28, v69
    v_mov_b32 v70, 2576
    v_mov_b32 v71, 2816
    v_cndmask_b32 v2, v2, v70, vcc
    v_cmp_eq_u32 vcc, 20, v69
    s_nop 1
    v_cndmask_b32 v2, v2, v71, vcc
    v_cmp_gt_u32 vcc, 20, v69
    s_nop 1
    v_cndmask_b32 v31, v2, v3, vcc
    v_mov_b32 v32, 0
    v_mov_b32 v33, 0
    v_mov_b32 v34, 0
    v_mov_b32 v35, 0
    v_mov_b32 v36, 0
    v_mov_b32 v37, 0
    v_mov_b32 v38, 0
    v_mov_b32 v39, 0
    v_mov_b32 v48, 0
    v_mov_b32 v49, 0
    v_mov_b32 v50, 0
    v_mov_b32 v51, 0
    v_mov_b32 v52, 0
    v_mov_b32 v53, 0
    v_mov_b32 v54, 0
    v_mov_b32 v55, 0
    v_mov_b32 v56, 0
    v_mov_b32 v57, 0
    v_mov_b32 v58, 0
    v_mov_b32 v59, 0
    v_mov_b32 v60, 0
    v_mov_b32 v61, 0
    v_mov_b32 v62, 0
    v_mov_b32 v63, 0
    s_lshl_b32 s57, s60, 1
    v_lshrrev_b32 v2, 1, v0
    v_min_u32 v2, 14, v2
    v_and_b32 v3, 1, v0
    v_lshl_add_u32 v2, v2, 6, v3
    v_add_u32 v2, s57, v2
    s_lshl_b32 s57, s6, 3
    s_add_u32 s57, s57, 896
    v_cmp_gt_u32 vcc, 32, v0
    v_and_b32 v3, 7, v0
    v_add_u32 v3, s57, v3
    v_cndmask_b32 v2, v3, v2, vcc
    v_subrev_u32 v3, 40, v0
    v_lshlrev_b32 v3, 2, v3
    v_add_u32 v3, s62, v3
    s_mul_i32 s57, s62, 5
    v_min_u32 v1, 58, v0
    v_cmp_gt_u32 vcc, 54, v0
    v_add_u32 v1, s57, v1
    s_lshr_b32 s57, s61, 2
    v_cndmask_b32 v3, v1, v3, vcc
    s_sub_u32 s57, 255, s57
    s_lshl_b32 s57, s57, 2
    s_and_b32 s58, s61, 3
    s_add_u32 s57, s57, s58
    v_lshlrev_b32 v3, 3, v3
    v_cmp_gt_u32 vcc, 40, v0
    v_sub_u32 v3, s57, v3
    s_nop 0
    v_cndmask_b32 v2, v3, v2, vcc
    v_lshlrev_b32 v2, 7, v2
    v_add_u32 v44, 131072, v2
    v_lshrrev_b32 v2, 2, v0
    v_mul_u32_u24 v2, 160, v2
    v_and_b32 v3, 3, v0
    v_lshl_add_u32 v2, v3, 3, v2
    s_add_u32 s57, s96, 122880
    v_add_u32 v45, s57, v2
    s_add_u32 s58, s62, s61
    s_and_b32 s58, s58, 3
    s_lshl_b32 s58, s58, 4
    s_lshl_b32 s57, s60, 6
    s_add_u32 s57, s57, s58
    v_and_b32 v2, 15, v0
    v_add_u32 v2, s57, v2
    v_mul_u32_u24 v2, 1280, v2
    v_lshrrev_b32 v3, 4, v0
    v_lshl_add_u32 v2, v3, 3, v2
    s_mul_i32 s57, s61, 160
    v_add_u32 v47, s57, v2
    s_mul_i32 s57, s62, 20480
    s_add_u32 s57, s57, 49152
    v_add_u32 v46, s57, v22
    s_lshl_b32 s57, s60, 5
    s_lshl_b32 s58, s62, 3
    s_add_u32 s57, s57, s58
    s_add_u32 s57, s57, 2048
    v_and_b32 v2, 7, v0
    v_add_u32 v2, s57, v2
    v_lshlrev_b32 v40, 7, v2
    s_add_u32 s57, s62, 3
    s_and_b32 s57, s57, 3
    s_mul_i32 s57, s57, 20480
    s_add_u32 s57, s57, 49152
    v_add_u32 v41, s57, v22
    s_add_u32 s57, s62, 2
    s_and_b32 s57, s57, 3
    s_mul_i32 s57, s57, 20480
    s_add_u32 s57, s57, 54272
    v_add_u32 v42, s57, v22
    s_add_u32 s57, s62, 1
    s_and_b32 s57, s57, 3
    s_mul_i32 s57, s57, 20480
    s_add_u32 s57, s57, 59392
    v_add_u32 v43, s57, v22
    s_lshl_b32 s57, s62, 11
    s_add_u32 s57, s57, 147456
    v_add_u32 v1, s57, v22
    s_setprio 1
    s_cmp_ge_u32 s5, 10
    s_cbranch_scc1 LpassA_v
    s_waitcnt vmcnt(0)
    s_barrier
    ds_read_b64_tr_b16 v[160:161], v9 offset:16384
    ds_read_b64_tr_b16 v[162:163], v9 offset:17408
    ds_read_b64_tr_b16 v[164:165], v9 offset:24576
    ds_read_b64_tr_b16 v[166:167], v9 offset:25600
    ds_read_b128 v[128:131], v7 offset:0
    ds_read_b128 v[144:147], v8 offset:0
    ds_read_b128 v[132:135], v7 offset:2048
    ds_read_b128 v[148:151], v8 offset:2048
    ds_read_b128 v[136:139], v7 offset:4096
    ds_read_b128 v[152:155], v8 offset:4096
    ds_read_b128 v[140:143], v7 offset:6144
    ds_read_b128 v[156:159], v8 offset:6144
    ds_read_b64_tr_b16 v[168:169], v10 offset:16384
    ds_read_b64_tr_b16 v[170:171], v10 offset:17408
    ds_read_b64_tr_b16 v[172:173], v10 offset:24576
    ds_read_b64_tr_b16 v[174:175], v10 offset:25600
    ds_read_b64_tr_b16 v[176:177], v11 offset:16384
    ds_read_b64_tr_b16 v[178:179], v11 offset:17408
    ds_read_b64_tr_b16 v[180:181], v11 offset:24576
    ds_read_b64_tr_b16 v[182:183], v11 offset:25600
    ds_read_b64_tr_b16 v[184:185], v12 offset:16384
    ds_read_b64_tr_b16 v[186:187], v12 offset:17408
    ds_read_b64_tr_b16 v[188:189], v12 offset:24576
    ds_read_b64_tr_b16 v[190:191], v12 offset:25600
    s_waitcnt lgkmcnt(15)
    v_mfma_f32_16x16x32_bf16 v[64:67], v[160:163], v[128:131], 0
    v_mfma_f32_16x16x32_bf16 v[64:67], v[164:167], v[144:147], v[64:67]
    v_mfma_f32_16x16x32_bf16 v[68:71], v[160:163], v[132:135], 0
    v_mfma_f32_16x16x32_bf16 v[68:71], v[164:167], v[148:151], v[68:71]
    s_waitcnt lgkmcnt(14)
    v_mfma_f32_16x16x32_bf16 v[72:75], v[160:163], v[136:139], 0
    v_mfma_f32_16x16x32_bf16 v[72:75], v[164:167], v[152:155], v[72:75]
    s_waitcnt lgkmcnt(12)
    v_mfma_f32_16x16x32_bf16 v[76:79], v[160:163], v[140:143], 0
    v_mfma_f32_16x16x32_bf16 v[76:79], v[164:167], v[156:159], v[76:79]
    s_waitcnt lgkmcnt(8)
    v_mfma_f32_16x16x32_bf16 v[80:83], v[168:171], v[128:131], 0
    v_mfma_f32_16x16x32_bf16 v[80:83], v[172:175], v[144:147], v[80:83]
    v_mfma_f32_16x16x32_bf16 v[84:87], v[168:171], v[132:135], 0
    v_mfma_f32_16x16x32_bf16 v[84:87], v[172:175], v[148:151], v[84:87]
    v_mfma_f32_16x16x32_bf16 v[88:91], v[168:171], v[136:139], 0
    v_mfma_f32_16x16x32_bf16 v[88:91], v[172:175], v[152:155], v[88:91]
    v_mfma_f32_16x16x32_bf16 v[92:95], v[168:171], v[140:143], 0
    v_mfma_f32_16x16x32_bf16 v[92:95], v[172:175], v[156:159], v[92:95]
    s_waitcnt lgkmcnt(4)
    v_mfma_f32_16x16x32_bf16 v[96:99], v[176:179], v[128:131], 0
    v_mfma_f32_16x16x32_bf16 v[96:99], v[180:183], v[144:147], v[96:99]
    v_mfma_f32_16x16x32_bf16 v[100:103], v[176:179], v[132:135], 0
    v_mfma_f32_16x16x32_bf16 v[100:103], v[180:183], v[148:151], v[100:103]
    v_mfma_f32_16x16x32_bf16 v[104:107], v[176:179], v[136:139], 0
    v_mfma_f32_16x16x32_bf16 v[104:107], v[180:183], v[152:155], v[104:107]
    v_mfma_f32_16x16x32_bf16 v[108:111], v[176:179], v[140:143], 0
    v_mfma_f32_16x16x32_bf16 v[108:111], v[180:183], v[156:159], v[108:111]
    s_waitcnt lgkmcnt(0)
    v_mfma_f32_16x16x32_bf16 v[112:115], v[184:187], v[128:131], 0
    v_mfma_f32_16x16x32_bf16 v[112:115], v[188:191], v[144:147], v[112:115]
    v_mfma_f32_16x16x32_bf16 v[116:119], v[184:187], v[132:135], 0
    v_mfma_f32_16x16x32_bf16 v[116:119], v[188:191], v[148:151], v[116:119]
    v_mfma_f32_16x16x32_bf16 v[120:123], v[184:187], v[136:139], 0
    v_mfma_f32_16x16x32_bf16 v[120:123], v[188:191], v[152:155], v[120:123]
    v_mfma_f32_16x16x32_bf16 v[124:127], v[184:187], v[140:143], 0
    v_mfma_f32_16x16x32_bf16 v[124:127], v[188:191], v[156:159], v[124:127]
    s_cmp_eq_u32 0, 0
    s_branch Lpad_at_0
Lwarm_at:
    s_cmp_ge_u32 s5, 10
    s_cbranch_scc1 Lwarm_at_v
    s_barrier
    ds_read_b64_tr_b16 v[224:225], v9 offset:49152
    ds_read_b64_tr_b16 v[226:227], v9 offset:50176
    ds_read_b64_tr_b16 v[228:229], v9 offset:57344
    ds_read_b64_tr_b16 v[230:231], v9 offset:58368
    ds_read_b128 v[192:195], v7 offset:32768
    ds_read_b128 v[208:211], v8 offset:32768
    ds_read_b128 v[196:199], v7 offset:34816
    ds_read_b128 v[212:215], v8 offset:34816
    ds_read_b128 v[200:203], v7 offset:36864
    ds_read_b128 v[216:219], v8 offset:36864
    ds_read_b128 v[204:207], v7 offset:38912
    ds_read_b128 v[220:223], v8 offset:38912
    ds_read_b64_tr_b16 v[232:233], v10 offset:49152
    ds_read_b64_tr_b16 v[234:235], v10 offset:50176
    ds_read_b64_tr_b16 v[236:237], v10 offset:57344
    ds_read_b64_tr_b16 v[238:239], v10 offset:58368
    ds_read_b64_tr_b16 v[240:241], v11 offset:49152
    ds_read_b64_tr_b16 v[242:243], v11 offset:50176
    ds_read_b64_tr_b16 v[244:245], v11 offset:57344
    ds_read_b64_tr_b16 v[246:247], v11 offset:58368
    ds_read_b64_tr_b16 v[248:249], v12 offset:49152
    ds_read_b64_tr_b16 v[250:251], v12 offset:50176
    ds_read_b64_tr_b16 v[252:253], v12 offset:57344
    ds_read_b64_tr_b16 v[254:255], v12 offset:58368
    s_waitcnt lgkmcnt(15)
    v_mfma_f32_16x16x32_bf16 v[64:67], v[224:227], v[192:195], v[64:67]
    v_mfma_f32_16x16x32_bf16 v[64:67], v[228:231], v[208:211], v[64:67]
    v_mfma_f32_16x16x32_bf16 v[68:71], v[224:227], v[196:199], v[68:71]
    v_mfma_f32_16x16x32_bf16 v[68:71], v[228:231], v[212:215], v[68:71]
    s_waitcnt lgkmcnt(14)
    v_mfma_f32_16x16x32_bf16 v[72:75], v[224:227], v[200:203], v[72:75]
    v_mfma_f32_16x16x32_bf16 v[72:75], v[228:231], v[216:219], v[72:75]
    s_waitcnt lgkmcnt(12)
    v_mfma_f32_16x16x32_bf16 v[76:79], v[224:227], v[204:207], v[76:79]
    v_mfma_f32_16x16x32_bf16 v[76:79], v[228:231], v[220:223], v[76:79]
    s_waitcnt lgkmcnt(0)
    s_barrier
    v_mfma_f32_16x16x32_bf16 v[80:83], v[232:235], v[192:195], v[80:83]
    v_add_u32 v9, 81920, v9
    ds_read_b64_tr_b16 v[160:161], v9 offset:0
    v_mfma_f32_16x16x32_bf16 v[80:83], v[236:239], v[208:211], v[80:83]
    ds_read_b64_tr_b16 v[162:163], v9 offset:1024
    v_mfma_f32_16x16x32_bf16 v[84:87], v[232:235], v[196:199], v[84:87]
    ds_read_b64_tr_b16 v[164:165], v9 offset:8192
    v_mfma_f32_16x16x32_bf16 v[84:87], v[236:239], v[212:215], v[84:87]
    ds_read_b64_tr_b16 v[166:167], v9 offset:9216
    v_mfma_f32_16x16x32_bf16 v[88:91], v[232:235], v[200:203], v[88:91]
    v_add_u32 v7, 65536, v7
    ds_read_b128 v[128:131], v7 offset:0
    v_mfma_f32_16x16x32_bf16 v[88:91], v[236:239], v[216:219], v[88:91]
    v_add_u32 v8, 65536, v8
    ds_read_b128 v[144:147], v8 offset:0
    v_mfma_f32_16x16x32_bf16 v[92:95], v[232:235], v[204:207], v[92:95]
    ds_read_b128 v[132:135], v7 offset:2048
    v_mfma_f32_16x16x32_bf16 v[92:95], v[236:239], v[220:223], v[92:95]
    ds_read_b128 v[148:151], v8 offset:2048
    v_mfma_f32_16x16x32_bf16 v[96:99], v[240:243], v[192:195], v[96:99]
    ds_read_b128 v[136:139], v7 offset:4096
    v_mfma_f32_16x16x32_bf16 v[96:99], v[244:247], v[208:211], v[96:99]
    ds_read_b128 v[152:155], v8 offset:4096
    v_mfma_f32_16x16x32_bf16 v[100:103], v[240:243], v[196:199], v[100:103]
    ds_read_b128 v[140:143], v7 offset:6144
    v_mfma_f32_16x16x32_bf16 v[100:103], v[244:247], v[212:215], v[100:103]
    ds_read_b128 v[156:159], v8 offset:6144
    v_mfma_f32_16x16x32_bf16 v[104:107], v[240:243], v[200:203], v[104:107]
    v_add_u32 v10, 81920, v10
    ds_read_b64_tr_b16 v[168:169], v10 offset:0
    v_mfma_f32_16x16x32_bf16 v[104:107], v[244:247], v[216:219], v[104:107]
    ds_read_b64_tr_b16 v[170:171], v10 offset:1024
    v_mfma_f32_16x16x32_bf16 v[108:111], v[240:243], v[204:207], v[108:111]
    ds_read_b64_tr_b16 v[172:173], v10 offset:8192
    v_mfma_f32_16x16x32_bf16 v[108:111], v[244:247], v[220:223], v[108:111]
    ds_read_b64_tr_b16 v[174:175], v10 offset:9216
    v_mfma_f32_16x16x32_bf16 v[112:115], v[248:251], v[192:195], v[112:115]
    v_add_u32 v11, 81920, v11
    ds_read_b64_tr_b16 v[176:177], v11 offset:0
    v_mfma_f32_16x16x32_bf16 v[112:115], v[252:255], v[208:211], v[112:115]
    ds_read_b64_tr_b16 v[178:179], v11 offset:1024
    v_mfma_f32_16x16x32_bf16 v[116:119], v[248:251], v[196:199], v[116:119]
    ds_read_b64_tr_b16 v[180:181], v11 offset:8192
    v_mfma_f32_16x16x32_bf16 v[116:119], v[252:255], v[212:215], v[116:119]
    ds_read_b64_tr_b16 v[182:183], v11 offset:9216
    v_mfma_f32_16x16x32_bf16 v[120:123], v[248:251], v[200:203], v[120:123]
    v_add_u32 v12, 81920, v12
    ds_read_b64_tr_b16 v[184:185], v12 offset:0
    v_mfma_f32_16x16x32_bf16 v[120:123], v[252:255], v[216:219], v[120:123]
    ds_read_b64_tr_b16 v[186:187], v12 offset:1024
    v_mfma_f32_16x16x32_bf16 v[124:127], v[248:251], v[204:207], v[124:127]
    ds_read_b64_tr_b16 v[188:189], v12 offset:8192
    v_mfma_f32_16x16x32_bf16 v[124:127], v[252:255], v[220:223], v[124:127]
    ds_read_b64_tr_b16 v[190:191], v12 offset:9216
    s_waitcnt lgkmcnt(15)
    v_mfma_f32_16x16x32_bf16 v[64:67], v[160:163], v[128:131], v[64:67]
    v_mfma_f32_16x16x32_bf16 v[64:67], v[164:167], v[144:147], v[64:67]
    v_mfma_f32_16x16x32_bf16 v[68:71], v[160:163], v[132:135], v[68:71]
    v_mfma_f32_16x16x32_bf16 v[68:71], v[164:167], v[148:151], v[68:71]
    s_waitcnt lgkmcnt(14)
    v_mfma_f32_16x16x32_bf16 v[72:75], v[160:163], v[136:139], v[72:75]
    v_mfma_f32_16x16x32_bf16 v[72:75], v[164:167], v[152:155], v[72:75]
    s_waitcnt lgkmcnt(12)
    v_mfma_f32_16x16x32_bf16 v[76:79], v[160:163], v[140:143], v[76:79]
    v_mfma_f32_16x16x32_bf16 v[76:79], v[164:167], v[156:159], v[76:79]
    s_waitcnt lgkmcnt(0)
    s_barrier
    v_mfma_f32_16x16x32_bf16 v[80:83], v[168:171], v[128:131], v[80:83]
    ds_read_b64_tr_b16 v[224:225], v9 offset:32768
    v_mfma_f32_16x16x32_bf16 v[80:83], v[172:175], v[144:147], v[80:83]
    ds_read_b64_tr_b16 v[226:227], v9 offset:33792
    v_mfma_f32_16x16x32_bf16 v[84:87], v[168:171], v[132:135], v[84:87]
    ds_read_b64_tr_b16 v[228:229], v9 offset:40960
    v_mfma_f32_16x16x32_bf16 v[84:87], v[172:175], v[148:151], v[84:87]
    ds_read_b64_tr_b16 v[230:231], v9 offset:41984
    v_mfma_f32_16x16x32_bf16 v[88:91], v[168:171], v[136:139], v[88:91]
    ds_read_b128 v[192:195], v7 offset:32768
    v_mfma_f32_16x16x32_bf16 v[88:91], v[172:175], v[152:155], v[88:91]
    ds_read_b128 v[208:211], v8 offset:32768
    v_mfma_f32_16x16x32_bf16 v[92:95], v[168:171], v[140:143], v[92:95]
    ds_read_b128 v[196:199], v7 offset:34816
    v_mfma_f32_16x16x32_bf16 v[92:95], v[172:175], v[156:159], v[92:95]
    ds_read_b128 v[212:215], v8 offset:34816
    v_mfma_f32_16x16x32_bf16 v[96:99], v[176:179], v[128:131], v[96:99]
    ds_read_b128 v[200:203], v7 offset:36864
    v_mfma_f32_16x16x32_bf16 v[96:99], v[180:183], v[144:147], v[96:99]
    ds_read_b128 v[216:219], v8 offset:36864
    v_mfma_f32_16x16x32_bf16 v[100:103], v[176:179], v[132:135], v[100:103]
    ds_read_b128 v[204:207], v7 offset:38912
    v_mfma_f32_16x16x32_bf16 v[100:103], v[180:183], v[148:151], v[100:103]
    ds_read_b128 v[220:223], v8 offset:38912
    v_mfma_f32_16x16x32_bf16 v[104:107], v[176:179], v[136:139], v[104:107]
    ds_read_b64_tr_b16 v[232:233], v10 offset:32768
    v_mfma_f32_16x16x32_bf16 v[104:107], v[180:183], v[152:155], v[104:107]
    ds_read_b64_tr_b16 v[234:235], v10 offset:33792
    v_mfma_f32_16x16x32_bf16 v[108:111], v[176:179], v[140:143], v[108:111]
    ds_read_b64_tr_b16 v[236:237], v10 offset:40960
    v_mfma_f32_16x16x32_bf16 v[108:111], v[180:183], v[156:159], v[108:111]
    ds_read_b64_tr_b16 v[238:239], v10 offset:41984
    v_mfma_f32_16x16x32_bf16 v[112:115], v[184:187], v[128:131], v[112:115]
    ds_read_b64_tr_b16 v[240:241], v11 offset:32768
    v_mfma_f32_16x16x32_bf16 v[112:115], v[188:191], v[144:147], v[112:115]
    ds_read_b64_tr_b16 v[242:243], v11 offset:33792
    v_mfma_f32_16x16x32_bf16 v[116:119], v[184:187], v[132:135], v[116:119]
    ds_read_b64_tr_b16 v[244:245], v11 offset:40960
    v_mfma_f32_16x16x32_bf16 v[116:119], v[188:191], v[148:151], v[116:119]
    ds_read_b64_tr_b16 v[246:247], v11 offset:41984
    v_mfma_f32_16x16x32_bf16 v[120:123], v[184:187], v[136:139], v[120:123]
    ds_read_b64_tr_b16 v[248:249], v12 offset:32768
    v_mfma_f32_16x16x32_bf16 v[120:123], v[188:191], v[152:155], v[120:123]
    ds_read_b64_tr_b16 v[250:251], v12 offset:33792
    v_mfma_f32_16x16x32_bf16 v[124:127], v[184:187], v[140:143], v[124:127]
    ds_read_b64_tr_b16 v[252:253], v12 offset:40960
    v_mfma_f32_16x16x32_bf16 v[124:127], v[188:191], v[156:159], v[124:127]
    ds_read_b64_tr_b16 v[254:255], v12 offset:41984
    s_waitcnt lgkmcnt(15)
    v_mfma_f32_16x16x32_bf16 v[64:67], v[224:227], v[192:195], v[64:67]
    v_mfma_f32_16x16x32_bf16 v[64:67], v[228:231], v[208:211], v[64:67]
    v_mfma_f32_16x16x32_bf16 v[68:71], v[224:227], v[196:199], v[68:71]
    v_mfma_f32_16x16x32_bf16 v[68:71], v[228:231], v[212:215], v[68:71]
    s_waitcnt lgkmcnt(14)
    v_mfma_f32_16x16x32_bf16 v[72:75], v[224:227], v[200:203], v[72:75]
    v_mfma_f32_16x16x32_bf16 v[72:75], v[228:231], v[216:219], v[72:75]
    s_waitcnt lgkmcnt(12)
    v_mfma_f32_16x16x32_bf16 v[76:79], v[224:227], v[204:207], v[76:79]
    v_mfma_f32_16x16x32_bf16 v[76:79], v[228:231], v[220:223], v[76:79]
    s_waitcnt lgkmcnt(0)
    s_barrier
    v_mfma_f32_16x16x32_bf16 v[80:83], v[232:235], v[192:195], v[80:83]
    v_add_u32 v9, 16384, v9
    ds_read_b64_tr_b16 v[160:161], v9 offset:49152
    v_mfma_f32_16x16x32_bf16 v[80:83], v[236:239], v[208:211], v[80:83]
    ds_read_b64_tr_b16 v[162:163], v9 offset:50176
    v_mfma_f32_16x16x32_bf16 v[84:87], v[232:235], v[196:199], v[84:87]
    ds_read_b64_tr_b16 v[164:165], v9 offset:57344
    v_mfma_f32_16x16x32_bf16 v[84:87], v[236:239], v[212:215], v[84:87]
    ds_read_b64_tr_b16 v[166:167], v9 offset:58368
    v_mfma_f32_16x16x32_bf16 v[88:91], v[232:235], v[200:203], v[88:91]
    v_add_u32 v7, 32768, v7
    ds_read_b128 v[128:131], v7 offset:32768
    v_mfma_f32_16x16x32_bf16 v[88:91], v[236:239], v[216:219], v[88:91]
    v_add_u32 v8, 32768, v8
    ds_read_b128 v[144:147], v8 offset:32768
    v_mfma_f32_16x16x32_bf16 v[92:95], v[232:235], v[204:207], v[92:95]
    ds_read_b128 v[132:135], v7 offset:34816
    v_mfma_f32_16x16x32_bf16 v[92:95], v[236:239], v[220:223], v[92:95]
    ds_read_b128 v[148:151], v8 offset:34816
    v_mfma_f32_16x16x32_bf16 v[96:99], v[240:243], v[192:195], v[96:99]
    ds_read_b128 v[136:139], v7 offset:36864
    v_mfma_f32_16x16x32_bf16 v[96:99], v[244:247], v[208:211], v[96:99]
    ds_read_b128 v[152:155], v8 offset:36864
    v_mfma_f32_16x16x32_bf16 v[100:103], v[240:243], v[196:199], v[100:103]
    ds_read_b128 v[140:143], v7 offset:38912
    v_mfma_f32_16x16x32_bf16 v[100:103], v[244:247], v[212:215], v[100:103]
    ds_read_b128 v[156:159], v8 offset:38912
    v_mfma_f32_16x16x32_bf16 v[104:107], v[240:243], v[200:203], v[104:107]
    v_add_u32 v10, 16384, v10
    ds_read_b64_tr_b16 v[168:169], v10 offset:49152
    v_mfma_f32_16x16x32_bf16 v[104:107], v[244:247], v[216:219], v[104:107]
    ds_read_b64_tr_b16 v[170:171], v10 offset:50176
    v_mfma_f32_16x16x32_bf16 v[108:111], v[240:243], v[204:207], v[108:111]
    ds_read_b64_tr_b16 v[172:173], v10 offset:57344
    v_mfma_f32_16x16x32_bf16 v[108:111], v[244:247], v[220:223], v[108:111]
    ds_read_b64_tr_b16 v[174:175], v10 offset:58368
    v_mfma_f32_16x16x32_bf16 v[112:115], v[248:251], v[192:195], v[112:115]
    v_add_u32 v11, 16384, v11
    ds_read_b64_tr_b16 v[176:177], v11 offset:49152
    v_mfma_f32_16x16x32_bf16 v[112:115], v[252:255], v[208:211], v[112:115]
    ds_read_b64_tr_b16 v[178:179], v11 offset:50176
    v_mfma_f32_16x16x32_bf16 v[116:119], v[248:251], v[196:199], v[116:119]
    ds_read_b64_tr_b16 v[180:181], v11 offset:57344
    v_mfma_f32_16x16x32_bf16 v[116:119], v[252:255], v[212:215], v[116:119]
    ds_read_b64_tr_b16 v[182:183], v11 offset:58368
    v_mfma_f32_16x16x32_bf16 v[120:123], v[248:251], v[200:203], v[120:123]
    v_add_u32 v12, 16384, v12
    ds_read_b64_tr_b16 v[184:185], v12 offset:49152
    v_mfma_f32_16x16x32_bf16 v[120:123], v[252:255], v[216:219], v[120:123]
    ds_read_b64_tr_b16 v[186:187], v12 offset:50176
    v_mfma_f32_16x16x32_bf16 v[124:127], v[248:251], v[204:207], v[124:127]
    ds_read_b64_tr_b16 v[188:189], v12 offset:57344
    v_mfma_f32_16x16x32_bf16 v[124:127], v[252:255], v[220:223], v[124:127]
    ds_read_b64_tr_b16 v[190:191], v12 offset:58368
    s_waitcnt lgkmcnt(15)
    v_mfma_f32_16x16x32_bf16 v[64:67], v[160:163], v[128:131], v[64:67]
    v_mfma_f32_16x16x32_bf16 v[64:67], v[164:167], v[144:147], v[64:67]
    v_mfma_f32_16x16x32_bf16 v[68:71], v[160:163], v[132:135], v[68:71]
    v_mfma_f32_16x16x32_bf16 v[68:71], v[164:167], v[148:151], v[68:71]
    s_waitcnt lgkmcnt(14)
    v_mfma_f32_16x16x32_bf16 v[72:75], v[160:163], v[136:139], v[72:75]
    v_mfma_f32_16x16x32_bf16 v[72:75], v[164:167], v[152:155], v[72:75]
    s_waitcnt lgkmcnt(12)
    v_mfma_f32_16x16x32_bf16 v[76:79], v[160:163], v[140:143], v[76:79]
    v_mfma_f32_16x16x32_bf16 v[76:79], v[164:167], v[156:159], v[76:79]
    s_waitcnt lgkmcnt(0)
    s_barrier
    v_mfma_f32_16x16x32_bf16 v[80:83], v[168:171], v[128:131], v[80:83]
    v_add_u32 v9, 4294885376, v9
    ds_read_b64_tr_b16 v[224:225], v9 offset:0
    v_mfma_f32_16x16x32_bf16 v[80:83], v[172:175], v[144:147], v[80:83]
    ds_read_b64_tr_b16 v[226:227], v9 offset:1024
    v_mfma_f32_16x16x32_bf16 v[84:87], v[168:171], v[132:135], v[84:87]
    ds_read_b64_tr_b16 v[228:229], v9 offset:8192
    v_mfma_f32_16x16x32_bf16 v[84:87], v[172:175], v[148:151], v[84:87]
    ds_read_b64_tr_b16 v[230:231], v9 offset:9216
    v_mfma_f32_16x16x32_bf16 v[88:91], v[168:171], v[136:139], v[88:91]
    v_add_u32 v7, 4294868992, v7
    ds_read_b128 v[192:195], v7 offset:0
    v_mfma_f32_16x16x32_bf16 v[88:91], v[172:175], v[152:155], v[88:91]
    v_add_u32 v8, 4294868992, v8
    ds_read_b128 v[208:211], v8 offset:0
    v_mfma_f32_16x16x32_bf16 v[92:95], v[168:171], v[140:143], v[92:95]
    ds_read_b128 v[196:199], v7 offset:2048
    v_mfma_f32_16x16x32_bf16 v[92:95], v[172:175], v[156:159], v[92:95]
    ds_read_b128 v[212:215], v8 offset:2048
    v_mfma_f32_16x16x32_bf16 v[96:99], v[176:179], v[128:131], v[96:99]
    ds_read_b128 v[200:203], v7 offset:4096
    v_mfma_f32_16x16x32_bf16 v[96:99], v[180:183], v[144:147], v[96:99]
    ds_read_b128 v[216:219], v8 offset:4096
    v_mfma_f32_16x16x32_bf16 v[100:103], v[176:179], v[132:135], v[100:103]
    ds_read_b128 v[204:207], v7 offset:6144
    v_mfma_f32_16x16x32_bf16 v[100:103], v[180:183], v[148:151], v[100:103]
    ds_read_b128 v[220:223], v8 offset:6144
    v_mfma_f32_16x16x32_bf16 v[104:107], v[176:179], v[136:139], v[104:107]
    v_add_u32 v10, 4294885376, v10
    ds_read_b64_tr_b16 v[232:233], v10 offset:0
    v_mfma_f32_16x16x32_bf16 v[104:107], v[180:183], v[152:155], v[104:107]
    ds_read_b64_tr_b16 v[234:235], v10 offset:1024
    v_mfma_f32_16x16x32_bf16 v[108:111], v[176:179], v[140:143], v[108:111]
    ds_read_b64_tr_b16 v[236:237], v10 offset:8192
    v_mfma_f32_16x16x32_bf16 v[108:111], v[180:183], v[156:159], v[108:111]
    ds_read_b64_tr_b16 v[238:239], v10 offset:9216
    v_mfma_f32_16x16x32_bf16 v[112:115], v[184:187], v[128:131], v[112:115]
    v_add_u32 v11, 4294885376, v11
    ds_read_b64_tr_b16 v[240:241], v11 offset:0
    v_mfma_f32_16x16x32_bf16 v[112:115], v[188:191], v[144:147], v[112:115]
    ds_read_b64_tr_b16 v[242:243], v11 offset:1024
    v_mfma_f32_16x16x32_bf16 v[116:119], v[184:187], v[132:135], v[116:119]
    ds_read_b64_tr_b16 v[244:245], v11 offset:8192
    v_mfma_f32_16x16x32_bf16 v[116:119], v[188:191], v[148:151], v[116:119]
    ds_read_b64_tr_b16 v[246:247], v11 offset:9216
    v_mfma_f32_16x16x32_bf16 v[120:123], v[184:187], v[136:139], v[120:123]
    v_add_u32 v12, 4294885376, v12
    ds_read_b64_tr_b16 v[248:249], v12 offset:0
    v_mfma_f32_16x16x32_bf16 v[120:123], v[188:191], v[152:155], v[120:123]
    ds_read_b64_tr_b16 v[250:251], v12 offset:1024
    v_mfma_f32_16x16x32_bf16 v[124:127], v[184:187], v[140:143], v[124:127]
    ds_read_b64_tr_b16 v[252:253], v12 offset:8192
    v_mfma_f32_16x16x32_bf16 v[124:127], v[188:191], v[156:159], v[124:127]
    ds_read_b64_tr_b16 v[254:255], v12 offset:9216
    s_waitcnt lgkmcnt(15)
    v_mfma_f32_16x16x32_bf16 v[64:67], v[224:227], v[192:195], v[64:67]
    v_mfma_f32_16x16x32_bf16 v[64:67], v[228:231], v[208:211], v[64:67]
    v_mfma_f32_16x16x32_bf16 v[68:71], v[224:227], v[196:199], v[68:71]
    v_mfma_f32_16x16x32_bf16 v[68:71], v[228:231], v[212:215], v[68:71]
    s_waitcnt lgkmcnt(14)
    v_mfma_f32_16x16x32_bf16 v[72:75], v[224:227], v[200:203], v[72:75]
    v_mfma_f32_16x16x32_bf16 v[72:75], v[228:231], v[216:219], v[72:75]
    s_waitcnt lgkmcnt(12)
    v_mfma_f32_16x16x32_bf16 v[76:79], v[224:227], v[204:207], v[76:79]
    v_mfma_f32_16x16x32_bf16 v[76:79], v[228:231], v[220:223], v[76:79]
    s_waitcnt lgkmcnt(0)
    s_barrier
    v_mfma_f32_16x16x32_bf16 v[80:83], v[232:235], v[192:195], v[80:83]
    ds_read_b64_tr_b16 v[160:161], v9 offset:32768
    v_mfma_f32_16x16x32_bf16 v[80:83], v[236:239], v[208:211], v[80:83]
    ds_read_b64_tr_b16 v[162:163], v9 offset:33792
    v_mfma_f32_16x16x32_bf16 v[84:87], v[232:235], v[196:199], v[84:87]
    ds_read_b64_tr_b16 v[164:165], v9 offset:40960
    v_mfma_f32_16x16x32_bf16 v[84:87], v[236:239], v[212:215], v[84:87]
    ds_read_b64_tr_b16 v[166:167], v9 offset:41984
    v_mfma_f32_16x16x32_bf16 v[88:91], v[232:235], v[200:203], v[88:91]
    ds_read_b128 v[128:131], v7 offset:32768
    v_mfma_f32_16x16x32_bf16 v[88:91], v[236:239], v[216:219], v[88:91]
    ds_read_b128 v[144:147], v8 offset:32768
    v_mfma_f32_16x16x32_bf16 v[92:95], v[232:235], v[204:207], v[92:95]
    ds_read_b128 v[132:135], v7 offset:34816
    v_mfma_f32_16x16x32_bf16 v[92:95], v[236:239], v[220:223], v[92:95]
    ds_read_b128 v[148:151], v8 offset:34816
    v_mfma_f32_16x16x32_bf16 v[96:99], v[240:243], v[192:195], v[96:99]
    ds_read_b128 v[136:139], v7 offset:36864
    v_mfma_f32_16x16x32_bf16 v[96:99], v[244:247], v[208:211], v[96:99]
    ds_read_b128 v[152:155], v8 offset:36864
    v_mfma_f32_16x16x32_bf16 v[100:103], v[240:243], v[196:199], v[100:103]
    ds_read_b128 v[140:143], v7 offset:38912
    v_mfma_f32_16x16x32_bf16 v[100:103], v[244:247], v[212:215], v[100:103]
    ds_read_b128 v[156:159], v8 offset:38912
    v_mfma_f32_16x16x32_bf16 v[104:107], v[240:243], v[200:203], v[104:107]
    ds_read_b64_tr_b16 v[168:169], v10 offset:32768
    v_mfma_f32_16x16x32_bf16 v[104:107], v[244:247], v[216:219], v[104:107]
    ds_read_b64_tr_b16 v[170:171], v10 offset:33792
    v_mfma_f32_16x16x32_bf16 v[108:111], v[240:243], v[204:207], v[108:111]
    ds_read_b64_tr_b16 v[172:173], v10 offset:40960
    v_mfma_f32_16x16x32_bf16 v[108:111], v[244:247], v[220:223], v[108:111]
    ds_read_b64_tr_b16 v[174:175], v10 offset:41984
    v_mfma_f32_16x16x32_bf16 v[112:115], v[248:251], v[192:195], v[112:115]
    ds_read_b64_tr_b16 v[176:177], v11 offset:32768
    v_mfma_f32_16x16x32_bf16 v[112:115], v[252:255], v[208:211], v[112:115]
    ds_read_b64_tr_b16 v[178:179], v11 offset:33792
    v_mfma_f32_16x16x32_bf16 v[116:119], v[248:251], v[196:199], v[116:119]
    ds_read_b64_tr_b16 v[180:181], v11 offset:40960
    v_mfma_f32_16x16x32_bf16 v[116:119], v[252:255], v[212:215], v[116:119]
    ds_read_b64_tr_b16 v[182:183], v11 offset:41984
    v_mfma_f32_16x16x32_bf16 v[120:123], v[248:251], v[200:203], v[120:123]
    ds_read_b64_tr_b16 v[184:185], v12 offset:32768
    v_mfma_f32_16x16x32_bf16 v[120:123], v[252:255], v[216:219], v[120:123]
    ds_read_b64_tr_b16 v[186:187], v12 offset:33792
    v_mfma_f32_16x16x32_bf16 v[124:127], v[248:251], v[204:207], v[124:127]
    ds_read_b64_tr_b16 v[188:189], v12 offset:40960
    v_mfma_f32_16x16x32_bf16 v[124:127], v[252:255], v[220:223], v[124:127]
    ds_read_b64_tr_b16 v[190:191], v12 offset:41984
    s_waitcnt lgkmcnt(15)
    v_mfma_f32_16x16x32_bf16 v[64:67], v[160:163], v[128:131], v[64:67]
    v_mfma_f32_16x16x32_bf16 v[64:67], v[164:167], v[144:147], v[64:67]
    v_mfma_f32_16x16x32_bf16 v[68:71], v[160:163], v[132:135], v[68:71]
    v_mfma_f32_16x16x32_bf16 v[68:71], v[164:167], v[148:151], v[68:71]
    s_waitcnt lgkmcnt(14)
    v_mfma_f32_16x16x32_bf16 v[72:75], v[160:163], v[136:139], v[72:75]
    v_mfma_f32_16x16x32_bf16 v[72:75], v[164:167], v[152:155], v[72:75]
    s_waitcnt lgkmcnt(12)
    v_mfma_f32_16x16x32_bf16 v[76:79], v[160:163], v[140:143], v[76:79]
    v_mfma_f32_16x16x32_bf16 v[76:79], v[164:167], v[156:159], v[76:79]
    s_waitcnt lgkmcnt(0)
    s_barrier
    v_mfma_f32_16x16x32_bf16 v[80:83], v[168:171], v[128:131], v[80:83]
    v_add_u32 v9, 65536, v9
    ds_read_b64_tr_b16 v[224:225], v9 offset:0
    v_mfma_f32_16x16x32_bf16 v[80:83], v[172:175], v[144:147], v[80:83]
    ds_read_b64_tr_b16 v[226:227], v9 offset:1024
    v_mfma_f32_16x16x32_bf16 v[84:87], v[168:171], v[132:135], v[84:87]
    ds_read_b64_tr_b16 v[228:229], v9 offset:8192
    v_mfma_f32_16x16x32_bf16 v[84:87], v[172:175], v[148:151], v[84:87]
    ds_read_b64_tr_b16 v[230:231], v9 offset:9216
    v_mfma_f32_16x16x32_bf16 v[88:91], v[168:171], v[136:139], v[88:91]
    v_add_u32 v7, 65536, v7
    ds_read_b128 v[192:195], v7 offset:0
    v_mfma_f32_16x16x32_bf16 v[88:91], v[172:175], v[152:155], v[88:91]
    v_add_u32 v8, 65536, v8
    ds_read_b128 v[208:211], v8 offset:0
    v_mfma_f32_16x16x32_bf16 v[92:95], v[168:171], v[140:143], v[92:95]
    ds_read_b128 v[196:199], v7 offset:2048
    v_mfma_f32_16x16x32_bf16 v[92:95], v[172:175], v[156:159], v[92:95]
    ds_read_b128 v[212:215], v8 offset:2048
    v_mfma_f32_16x16x32_bf16 v[96:99], v[176:179], v[128:131], v[96:99]
    ds_read_b128 v[200:203], v7 offset:4096
    v_mfma_f32_16x16x32_bf16 v[96:99], v[180:183], v[144:147], v[96:99]
    ds_read_b128 v[216:219], v8 offset:4096
    v_mfma_f32_16x16x32_bf16 v[100:103], v[176:179], v[132:135], v[100:103]
    ds_read_b128 v[204:207], v7 offset:6144
    v_mfma_f32_16x16x32_bf16 v[100:103], v[180:183], v[148:151], v[100:103]
    ds_read_b128 v[220:223], v8 offset:6144
    v_mfma_f32_16x16x32_bf16 v[104:107], v[176:179], v[136:139], v[104:107]
    v_add_u32 v10, 65536, v10
    ds_read_b64_tr_b16 v[232:233], v10 offset:0
    v_mfma_f32_16x16x32_bf16 v[104:107], v[180:183], v[152:155], v[104:107]
    ds_read_b64_tr_b16 v[234:235], v10 offset:1024
    v_mfma_f32_16x16x32_bf16 v[108:111], v[176:179], v[140:143], v[108:111]
    ds_read_b64_tr_b16 v[236:237], v10 offset:8192
    v_mfma_f32_16x16x32_bf16 v[108:111], v[180:183], v[156:159], v[108:111]
    ds_read_b64_tr_b16 v[238:239], v10 offset:9216
    v_mfma_f32_16x16x32_bf16 v[112:115], v[184:187], v[128:131], v[112:115]
    v_add_u32 v11, 65536, v11
    ds_read_b64_tr_b16 v[240:241], v11 offset:0
    v_mfma_f32_16x16x32_bf16 v[112:115], v[188:191], v[144:147], v[112:115]
    ds_read_b64_tr_b16 v[242:243], v11 offset:1024
    v_mfma_f32_16x16x32_bf16 v[116:119], v[184:187], v[132:135], v[116:119]
    ds_read_b64_tr_b16 v[244:245], v11 offset:8192
    v_mfma_f32_16x16x32_bf16 v[116:119], v[188:191], v[148:151], v[116:119]
    ds_read_b64_tr_b16 v[246:247], v11 offset:9216
    v_mfma_f32_16x16x32_bf16 v[120:123], v[184:187], v[136:139], v[120:123]
    v_add_u32 v12, 65536, v12
    ds_read_b64_tr_b16 v[248:249], v12 offset:0
    v_mfma_f32_16x16x32_bf16 v[120:123], v[188:191], v[152:155], v[120:123]
    ds_read_b64_tr_b16 v[250:251], v12 offset:1024
    v_mfma_f32_16x16x32_bf16 v[124:127], v[184:187], v[140:143], v[124:127]
    ds_read_b64_tr_b16 v[252:253], v12 offset:8192
    v_mfma_f32_16x16x32_bf16 v[124:127], v[188:191], v[156:159], v[124:127]
    ds_read_b64_tr_b16 v[254:255], v12 offset:9216
    s_waitcnt lgkmcnt(15)
    v_mfma_f32_16x16x32_bf16 v[64:67], v[224:227], v[192:195], v[64:67]
    v_mfma_f32_16x16x32_bf16 v[64:67], v[228:231], v[208:211], v[64:67]
    v_mfma_f32_16x16x32_bf16 v[68:71], v[224:227], v[196:199], v[68:71]
    v_mfma_f32_16x16x32_bf16 v[68:71], v[228:231], v[212:215], v[68:71]
    s_waitcnt lgkmcnt(14)
    v_mfma_f32_16x16x32_bf16 v[72:75], v[224:227], v[200:203], v[72:75]
    v_mfma_f32_16x16x32_bf16 v[72:75], v[228:231], v[216:219], v[72:75]
    s_waitcnt lgkmcnt(12)
    v_mfma_f32_16x16x32_bf16 v[76:79], v[224:227], v[204:207], v[76:79]
    v_mfma_f32_16x16x32_bf16 v[76:79], v[228:231], v[220:223], v[76:79]
    s_waitcnt lgkmcnt(0)
    s_barrier
    v_mfma_f32_16x16x32_bf16 v[80:83], v[232:235], v[192:195], v[80:83]
    ds_read_b64_tr_b16 v[160:161], v9 offset:32768
    v_mfma_f32_16x16x32_bf16 v[80:83], v[236:239], v[208:211], v[80:83]
    ds_read_b64_tr_b16 v[162:163], v9 offset:33792
    v_mfma_f32_16x16x32_bf16 v[84:87], v[232:235], v[196:199], v[84:87]
    ds_read_b64_tr_b16 v[164:165], v9 offset:40960
    v_mfma_f32_16x16x32_bf16 v[84:87], v[236:239], v[212:215], v[84:87]
    ds_read_b64_tr_b16 v[166:167], v9 offset:41984
    v_mfma_f32_16x16x32_bf16 v[88:91], v[232:235], v[200:203], v[88:91]
    ds_read_b128 v[128:131], v7 offset:32768
    v_mfma_f32_16x16x32_bf16 v[88:91], v[236:239], v[216:219], v[88:91]
    ds_read_b128 v[144:147], v8 offset:32768
    v_mfma_f32_16x16x32_bf16 v[92:95], v[232:235], v[204:207], v[92:95]
    ds_read_b128 v[132:135], v7 offset:34816
    v_mfma_f32_16x16x32_bf16 v[92:95], v[236:239], v[220:223], v[92:95]
    ds_read_b128 v[148:151], v8 offset:34816
    v_mfma_f32_16x16x32_bf16 v[96:99], v[240:243], v[192:195], v[96:99]
    ds_read_b128 v[136:139], v7 offset:36864
    v_mfma_f32_16x16x32_bf16 v[96:99], v[244:247], v[208:211], v[96:99]
    ds_read_b128 v[152:155], v8 offset:36864
    v_mfma_f32_16x16x32_bf16 v[100:103], v[240:243], v[196:199], v[100:103]
    ds_read_b128 v[140:143], v7 offset:38912
    v_mfma_f32_16x16x32_bf16 v[100:103], v[244:247], v[212:215], v[100:103]
    ds_read_b128 v[156:159], v8 offset:38912
    v_mfma_f32_16x16x32_bf16 v[104:107], v[240:243], v[200:203], v[104:107]
    ds_read_b64_tr_b16 v[168:169], v10 offset:32768
    v_mfma_f32_16x16x32_bf16 v[104:107], v[244:247], v[216:219], v[104:107]
    ds_read_b64_tr_b16 v[170:171], v10 offset:33792
    v_mfma_f32_16x16x32_bf16 v[108:111], v[240:243], v[204:207], v[108:111]
    ds_read_b64_tr_b16 v[172:173], v10 offset:40960
    v_mfma_f32_16x16x32_bf16 v[108:111], v[244:247], v[220:223], v[108:111]
    ds_read_b64_tr_b16 v[174:175], v10 offset:41984
    v_mfma_f32_16x16x32_bf16 v[112:115], v[248:251], v[192:195], v[112:115]
    ds_read_b64_tr_b16 v[176:177], v11 offset:32768
    v_mfma_f32_16x16x32_bf16 v[112:115], v[252:255], v[208:211], v[112:115]
    ds_read_b64_tr_b16 v[178:179], v11 offset:33792
    v_mfma_f32_16x16x32_bf16 v[116:119], v[248:251], v[196:199], v[116:119]
    ds_read_b64_tr_b16 v[180:181], v11 offset:40960
    v_mfma_f32_16x16x32_bf16 v[116:119], v[252:255], v[212:215], v[116:119]
    ds_read_b64_tr_b16 v[182:183], v11 offset:41984
    v_mfma_f32_16x16x32_bf16 v[120:123], v[248:251], v[200:203], v[120:123]
    ds_read_b64_tr_b16 v[184:185], v12 offset:32768
    v_mfma_f32_16x16x32_bf16 v[120:123], v[252:255], v[216:219], v[120:123]
    ds_read_b64_tr_b16 v[186:187], v12 offset:33792
    v_mfma_f32_16x16x32_bf16 v[124:127], v[248:251], v[204:207], v[124:127]
    ds_read_b64_tr_b16 v[188:189], v12 offset:40960
    v_mfma_f32_16x16x32_bf16 v[124:127], v[252:255], v[220:223], v[124:127]
    ds_read_b64_tr_b16 v[190:191], v12 offset:41984
    s_waitcnt lgkmcnt(15)
    v_mfma_f32_16x16x32_bf16 v[64:67], v[160:163], v[128:131], v[64:67]
    v_mfma_f32_16x16x32_bf16 v[64:67], v[164:167], v[144:147], v[64:67]
    v_mfma_f32_16x16x32_bf16 v[68:71], v[160:163], v[132:135], v[68:71]
    v_mfma_f32_16x16x32_bf16 v[68:71], v[164:167], v[148:151], v[68:71]
    s_waitcnt lgkmcnt(14)
    v_mfma_f32_16x16x32_bf16 v[72:75], v[160:163], v[136:139], v[72:75]
    v_mfma_f32_16x16x32_bf16 v[72:75], v[164:167], v[152:155], v[72:75]
    s_waitcnt lgkmcnt(12)
    v_mfma_f32_16x16x32_bf16 v[76:79], v[160:163], v[140:143], v[76:79]
    v_mfma_f32_16x16x32_bf16 v[76:79], v[164:167], v[156:159], v[76:79]
    s_waitcnt lgkmcnt(0)
    s_barrier
    v_mfma_f32_16x16x32_bf16 v[80:83], v[168:171], v[128:131], v[80:83]
    v_add_u32 v9, 16384, v9
    ds_read_b64_tr_b16 v[224:225], v9 offset:49152
    v_mfma_f32_16x16x32_bf16 v[80:83], v[172:175], v[144:147], v[80:83]
    ds_read_b64_tr_b16 v[226:227], v9 offset:50176
    v_mfma_f32_16x16x32_bf16 v[84:87], v[168:171], v[132:135], v[84:87]
    ds_read_b64_tr_b16 v[228:229], v9 offset:57344
    v_mfma_f32_16x16x32_bf16 v[84:87], v[172:175], v[148:151], v[84:87]
    ds_read_b64_tr_b16 v[230:231], v9 offset:58368
    v_mfma_f32_16x16x32_bf16 v[88:91], v[168:171], v[136:139], v[88:91]
    v_add_u32 v7, 32768, v7
    ds_read_b128 v[192:195], v7 offset:32768
    v_mfma_f32_16x16x32_bf16 v[88:91], v[172:175], v[152:155], v[88:91]
    v_add_u32 v8, 32768, v8
    ds_read_b128 v[208:211], v8 offset:32768
    v_mfma_f32_16x16x32_bf16 v[92:95], v[168:171], v[140:143], v[92:95]
    ds_read_b128 v[196:199], v7 offset:34816
    v_mfma_f32_16x16x32_bf16 v[92:95], v[172:175], v[156:159], v[92:95]
    ds_read_b128 v[212:215], v8 offset:34816
    v_mfma_f32_16x16x32_bf16 v[96:99], v[176:179], v[128:131], v[96:99]
    ds_read_b128 v[200:203], v7 offset:36864
    v_mfma_f32_16x16x32_bf16 v[96:99], v[180:183], v[144:147], v[96:99]
    ds_read_b128 v[216:219], v8 offset:36864
    v_mfma_f32_16x16x32_bf16 v[100:103], v[176:179], v[132:135], v[100:103]
    ds_read_b128 v[204:207], v7 offset:38912
    v_mfma_f32_16x16x32_bf16 v[100:103], v[180:183], v[148:151], v[100:103]
    ds_read_b128 v[220:223], v8 offset:38912
    v_mfma_f32_16x16x32_bf16 v[104:107], v[176:179], v[136:139], v[104:107]
    v_add_u32 v10, 16384, v10
    ds_read_b64_tr_b16 v[232:233], v10 offset:49152
    v_mfma_f32_16x16x32_bf16 v[104:107], v[180:183], v[152:155], v[104:107]
    ds_read_b64_tr_b16 v[234:235], v10 offset:50176
    v_mfma_f32_16x16x32_bf16 v[108:111], v[176:179], v[140:143], v[108:111]
    ds_read_b64_tr_b16 v[236:237], v10 offset:57344
    v_mfma_f32_16x16x32_bf16 v[108:111], v[180:183], v[156:159], v[108:111]
    ds_read_b64_tr_b16 v[238:239], v10 offset:58368
    v_mfma_f32_16x16x32_bf16 v[112:115], v[184:187], v[128:131], v[112:115]
    v_add_u32 v11, 16384, v11
    ds_read_b64_tr_b16 v[240:241], v11 offset:49152
    v_mfma_f32_16x16x32_bf16 v[112:115], v[188:191], v[144:147], v[112:115]
    ds_read_b64_tr_b16 v[242:243], v11 offset:50176
    v_mfma_f32_16x16x32_bf16 v[116:119], v[184:187], v[132:135], v[116:119]
    ds_read_b64_tr_b16 v[244:245], v11 offset:57344
    v_mfma_f32_16x16x32_bf16 v[116:119], v[188:191], v[148:151], v[116:119]
    ds_read_b64_tr_b16 v[246:247], v11 offset:58368
    v_mfma_f32_16x16x32_bf16 v[120:123], v[184:187], v[136:139], v[120:123]
    v_add_u32 v12, 16384, v12
    ds_read_b64_tr_b16 v[248:249], v12 offset:49152
    v_mfma_f32_16x16x32_bf16 v[120:123], v[188:191], v[152:155], v[120:123]
    ds_read_b64_tr_b16 v[250:251], v12 offset:50176
    v_mfma_f32_16x16x32_bf16 v[124:127], v[184:187], v[140:143], v[124:127]
    ds_read_b64_tr_b16 v[252:253], v12 offset:57344
    v_mfma_f32_16x16x32_bf16 v[124:127], v[188:191], v[156:159], v[124:127]
    ds_read_b64_tr_b16 v[254:255], v12 offset:58368
    s_waitcnt lgkmcnt(15)
    v_mfma_f32_16x16x32_bf16 v[64:67], v[224:227], v[192:195], v[64:67]
    v_mfma_f32_16x16x32_bf16 v[64:67], v[228:231], v[208:211], v[64:67]
    v_mfma_f32_16x16x32_bf16 v[68:71], v[224:227], v[196:199], v[68:71]
    v_mfma_f32_16x16x32_bf16 v[68:71], v[228:231], v[212:215], v[68:71]
    s_waitcnt lgkmcnt(14)
    v_mfma_f32_16x16x32_bf16 v[72:75], v[224:227], v[200:203], v[72:75]
    v_mfma_f32_16x16x32_bf16 v[72:75], v[228:231], v[216:219], v[72:75]
    s_waitcnt lgkmcnt(12)
    v_mfma_f32_16x16x32_bf16 v[76:79], v[224:227], v[204:207], v[76:79]
    v_mfma_f32_16x16x32_bf16 v[76:79], v[228:231], v[220:223], v[76:79]
    v_mul_f32 v64, s65, v64
    v_mul_f32 v65, s65, v65
    v_mul_f32 v66, s65, v66
    s_waitcnt lgkmcnt(8)
    v_mfma_f32_16x16x32_bf16 v[80:83], v[232:235], v[192:195], v[80:83]
    v_mul_f32 v67, s65, v67
    v_cvt_pk_bf16_f32 v64, v64, v65
    v_cvt_pk_bf16_f32 v65, v66, v67
    v_mfma_f32_16x16x32_bf16 v[80:83], v[236:239], v[208:211], v[80:83]
    v_mul_f32 v68, s65, v68
    v_mul_f32 v69, s65, v69
    v_mul_f32 v70, s65, v70
    v_mfma_f32_16x16x32_bf16 v[84:87], v[232:235], v[196:199], v[84:87]
    v_mul_f32 v71, s65, v71
    v_cvt_pk_bf16_f32 v66, v68, v69
    v_cvt_pk_bf16_f32 v67, v70, v71
    v_mfma_f32_16x16x32_bf16 v[84:87], v[236:239], v[212:215], v[84:87]
    v_mul_f32 v72, s65, v72
    v_mul_f32 v73, s65, v73
    v_mul_f32 v74, s65, v74
    v_mfma_f32_16x16x32_bf16 v[88:91], v[232:235], v[200:203], v[88:91]
    v_mul_f32 v75, s65, v75
    v_cvt_pk_bf16_f32 v72, v72, v73
    v_cvt_pk_bf16_f32 v73, v74, v75
    v_mfma_f32_16x16x32_bf16 v[88:91], v[236:239], v[216:219], v[88:91]
    v_mul_f32 v76, s65, v76
    v_mul_f32 v77, s65, v77
    v_mul_f32 v78, s65, v78
    v_mfma_f32_16x16x32_bf16 v[92:95], v[232:235], v[204:207], v[92:95]
    v_mul_f32 v79, s65, v79
    v_cvt_pk_bf16_f32 v74, v76, v77
    v_cvt_pk_bf16_f32 v75, v78, v79
    v_mfma_f32_16x16x32_bf16 v[92:95], v[236:239], v[220:223], v[92:95]
    v_mul_f32 v80, s65, v80
    v_mul_f32 v81, s65, v81
    v_mul_f32 v82, s65, v82
    s_waitcnt lgkmcnt(4)
    v_mfma_f32_16x16x32_bf16 v[96:99], v[240:243], v[192:195], v[96:99]
    v_mul_f32 v83, s65, v83
    v_cvt_pk_bf16_f32 v80, v80, v81
    v_cvt_pk_bf16_f32 v81, v82, v83
    v_mfma_f32_16x16x32_bf16 v[96:99], v[244:247], v[208:211], v[96:99]
    v_mul_f32 v84, s65, v84
    v_mul_f32 v85, s65, v85
    v_mul_f32 v86, s65, v86
    v_mfma_f32_16x16x32_bf16 v[100:103], v[240:243], v[196:199], v[100:103]
    v_mul_f32 v87, s65, v87
    v_cvt_pk_bf16_f32 v82, v84, v85
    v_cvt_pk_bf16_f32 v83, v86, v87
    v_mfma_f32_16x16x32_bf16 v[100:103], v[244:247], v[212:215], v[100:103]
    v_mul_f32 v88, s65, v88
    v_mul_f32 v89, s65, v89
    v_mul_f32 v90, s65, v90
    v_mfma_f32_16x16x32_bf16 v[104:107], v[240:243], v[200:203], v[104:107]
    v_mul_f32 v91, s65, v91
    v_cvt_pk_bf16_f32 v88, v88, v89
    v_cvt_pk_bf16_f32 v89, v90, v91
    v_mfma_f32_16x16x32_bf16 v[104:107], v[244:247], v[216:219], v[104:107]
    v_mul_f32 v92, s65, v92
    v_mul_f32 v93, s65, v93
    v_mul_f32 v94, s65, v94
    v_mfma_f32_16x16x32_bf16 v[108:111], v[240:243], v[204:207], v[108:111]
    v_mul_f32 v95, s65, v95
    v_cvt_pk_bf16_f32 v90, v92, v93
    v_cvt_pk_bf16_f32 v91, v94, v95
    v_mfma_f32_16x16x32_bf16 v[108:111], v[244:247], v[220:223], v[108:111]
    v_mul_f32 v96, s65, v96
    v_mul_f32 v97, s65, v97
    v_mul_f32 v98, s65, v98
    s_waitcnt lgkmcnt(0)
    v_mfma_f32_16x16x32_bf16 v[112:115], v[248:251], v[192:195], v[112:115]
    v_mul_f32 v99, s65, v99
    v_cvt_pk_bf16_f32 v96, v96, v97
    v_cvt_pk_bf16_f32 v97, v98, v99
    v_mfma_f32_16x16x32_bf16 v[112:115], v[252:255], v[208:211], v[112:115]
    v_mul_f32 v100, s65, v100
    v_mul_f32 v101, s65, v101
    v_mul_f32 v102, s65, v102
    v_mfma_f32_16x16x32_bf16 v[116:119], v[248:251], v[196:199], v[116:119]
    v_mul_f32 v103, s65, v103
    v_cvt_pk_bf16_f32 v98, v100, v101
    v_cvt_pk_bf16_f32 v99, v102, v103
    v_mfma_f32_16x16x32_bf16 v[116:119], v[252:255], v[212:215], v[116:119]
    v_mul_f32 v104, s65, v104
    v_mul_f32 v105, s65, v105
    v_mul_f32 v106, s65, v106
    v_mfma_f32_16x16x32_bf16 v[120:123], v[248:251], v[200:203], v[120:123]
    v_mul_f32 v107, s65, v107
    v_cvt_pk_bf16_f32 v104, v104, v105
    v_cvt_pk_bf16_f32 v105, v106, v107
    v_mfma_f32_16x16x32_bf16 v[120:123], v[252:255], v[216:219], v[120:123]
    v_mul_f32 v108, s65, v108
    v_mul_f32 v109, s65, v109
    v_mul_f32 v110, s65, v110
    v_mfma_f32_16x16x32_bf16 v[124:127], v[248:251], v[204:207], v[124:127]
    v_mul_f32 v111, s65, v111
    v_cvt_pk_bf16_f32 v106, v108, v109
    v_cvt_pk_bf16_f32 v107, v110, v111
    v_mfma_f32_16x16x32_bf16 v[124:127], v[252:255], v[220:223], v[124:127]
    v_mul_f32 v112, s65, v112
    v_mul_f32 v113, s65, v113
    v_mul_f32 v114, s65, v114
    s_barrier
    s_add_u32 m0, s56, 65536
    s_add_u32 s57, s72, 0
    buffer_load_dwordx4 v6, s[16:19], s57 offen  lds
    s_add_u32 m0, s56, 69632
    s_add_u32 s57, s72, 55296
    buffer_load_dwordx4 v6, s[16:19], s57 offen  lds
    s_add_u32 m0, s56, 73728
    s_add_u32 s57, s72, 110592
    buffer_load_dwordx4 v6, s[16:19], s57 offen  lds
    s_add_u32 m0, s56, 77824
    s_add_u32 s57, s72, 165888
    buffer_load_dwordx4 v6, s[16:19], s57 offen  lds
    s_bfe_u32 s72, s94, 262164
    s_mul_i32 s72, s72, 221184
    s_add_u32 m0, s56, 81920
    s_add_u32 s57, s72, 0
    buffer_load_dwordx4 v6, s[16:19], s57 offen  lds
    s_add_u32 m0, s56, 86016
    s_add_u32 s57, s72, 55296
    buffer_load_dwordx4 v6, s[16:19], s57 offen  lds
    s_add_u32 m0, s56, 90112
    s_add_u32 s57, s72, 110592
    buffer_load_dwordx4 v6, s[16:19], s57 offen  lds
    s_add_u32 m0, s56, 94208
    s_add_u32 s57, s72, 165888
    buffer_load_dwordx4 v6, s[16:19], s57 offen  lds
    s_bfe_u32 s72, s94, 262168
    s_mul_i32 s72, s72, 221184
    v_mul_f32 v115, s65, v115
    v_cvt_pk_bf16_f32 v112, v112, v113
    v_cvt_pk_bf16_f32 v113, v114, v115
    v_mul_f32 v116, s65, v116
    v_mul_f32 v117, s65, v117
    v_mul_f32 v118, s65, v118
    v_mul_f32 v119, s65, v119
    v_cvt_pk_bf16_f32 v114, v116, v117
    v_cvt_pk_bf16_f32 v115, v118, v119
    v_mul_f32 v120, s65, v120
    v_mul_f32 v121, s65, v121
    v_mul_f32 v122, s65, v122
    v_mul_f32 v123, s65, v123
    v_cvt_pk_bf16_f32 v120, v120, v121
    v_cvt_pk_bf16_f32 v121, v122, v123
    v_mul_f32 v124, s65, v124
    v_mul_f32 v125, s65, v125
    v_mul_f32 v126, s65, v126
    v_mul_f32 v127, s65, v127
    v_cvt_pk_bf16_f32 v122, v124, v125
    v_cvt_pk_bf16_f32 v123, v126, v127
    s_barrier
    buffer_store_dwordx4 v[64:67], v13, s[20:23], 0 offen sc1
    buffer_store_dwordx4 v[72:75], v13, s[20:23], s75 offen sc1
    buffer_store_dwordx4 v[80:83], v14, s[20:23], 0 offen sc1
    buffer_store_dwordx4 v[88:91], v14, s[20:23], s75 offen sc1
    buffer_store_dwordx4 v[96:99], v15, s[20:23], 0 offen sc1
    buffer_store_dwordx4 v[104:107], v15, s[20:23], s75 offen sc1
    buffer_store_dwordx4 v[112:115], v16, s[20:23], 0 offen sc1
    buffer_store_dwordx4 v[120:123], v16, s[20:23], s75 offen sc1
    v_and_b32 v2, 15, v0
    v_lshlrev_b32 v2, 2, v2
    buffer_load_dword v3, v2, s[48:51], 0 offen sc1
    s_add_u32 m0, s56, 98304
    s_add_u32 s57, s72, 0
    buffer_load_dwordx4 v6, s[16:19], s57 offen  lds
    s_add_u32 m0, s56, 102400
    s_add_u32 s57, s72, 55296
    buffer_load_dwordx4 v6, s[16:19], s57 offen  lds
    s_add_u32 m0, s56, 106496
    s_add_u32 s57, s72, 110592
    buffer_load_dwordx4 v6, s[16:19], s57 offen  lds
    s_add_u32 m0, s56, 110592
    s_add_u32 s57, s72, 165888
    buffer_load_dwordx4 v6, s[16:19], s57 offen  lds
    s_bfe_u32 s72, s94, 262172
    s_mul_i32 s72, s72, 221184
    s_waitcnt vmcnt(13)
    s_barrier
    s_add_u32 m0, s56, 114688
    s_add_u32 s57, s72, 0
    buffer_load_dwordx4 v6, s[16:19], s57 offen  lds
    s_add_u32 m0, s56, 118784
    s_add_u32 s57, s72, 55296
    buffer_load_dwordx4 v6, s[16:19], s57 offen  lds
    s_add_u32 m0, s56, 122880
    s_add_u32 s57, s72, 110592
    buffer_load_dwordx4 v6, s[16:19], s57 offen  lds
    s_add_u32 m0, s56, 126976
    s_add_u32 s57, s72, 165888
    buffer_load_dwordx4 v6, s[16:19], s57 offen  lds
    s_bfe_u32 s72, s95, 262144
    s_mul_i32 s72, s72, 221184
    s_waitcnt vmcnt(8)
    v_cmp_ne_u32 vcc, 1, v3
    s_cbranch_vccz Lclean_5
    s_mov_b32 s64, 524288
Lpoll_6:
    buffer_load_dword v3, v2, s[48:51], 0 offen sc1
    s_sub_u32 s64, s64, 1
    s_cbranch_scc1 Lpolld_7
    s_waitcnt vmcnt(0)
    v_cmp_ne_u32 vcc, 1, v3
    s_cbranch_vccz Lpolld_7
    s_branch Lpoll_6
Lpolld_7:
    s_waitcnt vmcnt(0)
Lclean_5:
    s_mov_b32 s58, s66
    v_mov_b32 v2, 0
    v_mov_b32 v3, 1
    s_mov_b64 exec, 1
    buffer_store_dword v3, v2, s[20:23], s58 offen sc1
    s_mov_b64 exec, -1
    s_waitcnt vmcnt(1)
    s_barrier
    s_add_u32 m0, s56, 131072
    s_add_u32 s57, s72, 0
    buffer_load_dwordx4 v6, s[16:19], s57 offen  lds
    s_add_u32 m0, s56, 135168
    s_add_u32 s57, s72, 55296
    buffer_load_dwordx4 v6, s[16:19], s57 offen  lds
    s_add_u32 m0, s56, 139264
    s_add_u32 s57, s72, 110592
    buffer_load_dwordx4 v6, s[16:19], s57 offen  lds
    s_add_u32 m0, s56, 143360
    s_add_u32 s57, s72, 165888
    buffer_load_dwordx4 v6, s[16:19], s57 offen  lds
    s_bfe_u32 s72, s95, 262148
    s_mul_i32 s72, s72, 221184
    s_add_u32 m0, s56, 147456
    s_add_u32 s57, s72, 0
    buffer_load_dwordx4 v6, s[16:19], s57 offen  lds
    s_add_u32 m0, s56, 151552
    s_add_u32 s57, s72, 55296
    buffer_load_dwordx4 v6, s[16:19], s57 offen  lds
    s_add_u32 m0, s56, 155648
    s_add_u32 s57, s72, 110592
    buffer_load_dwordx4 v6, s[16:19], s57 offen  lds
    s_add_u32 m0, s56, 159744
    s_add_u32 s57, s72, 165888
    buffer_load_dwordx4 v6, s[16:19], s57 offen  lds
    s_branch Lattn0
Lgatez:
    s_setprio 0
    s_waitcnt vmcnt(0)
    s_barrier
    s_barrier
    s_barrier
    s_barrier
    v_lshlrev_b32 v4, 4, v0
    s_lshl_b32 s58, s56, 2
    s_add_u32 s58, s58, 81920
    s_mov_b64 exec, 0xff
    s_bfe_u32 s59, s94, 262144
    s_mul_i32 s59, s59, 128
    s_add_u32 m0, s58, 0
    s_add_u32 s57, s59, 0
    buffer_load_dwordx4 v4, s[44:47], s57 offen  lds
    s_bfe_u32 s59, s94, 262148
    s_mul_i32 s59, s59, 128
    s_add_u32 m0, s58, 128
    s_add_u32 s57, s59, 0
    buffer_load_dwordx4 v4, s[44:47], s57 offen  lds
    s_bfe_u32 s59, s94, 262152
    s_mul_i32 s59, s59, 128
    s_add_u32 m0, s58, 256
    s_add_u32 s57, s59, 0
    buffer_load_dwordx4 v4, s[44:47], s57 offen  lds
    s_bfe_u32 s59, s94, 262156
    s_mul_i32 s59, s59, 128
    s_add_u32 m0, s58, 384
    s_add_u32 s57, s59, 0
    buffer_load_dwordx4 v4, s[44:47], s57 offen  lds
    s_bfe_u32 s59, s94, 262160
    s_mul_i32 s59, s59, 128
    s_add_u32 m0, s58, 512
    s_add_u32 s57, s59, 0
    buffer_load_dwordx4 v4, s[44:47], s57 offen  lds
    s_bfe_u32 s59, s94, 262164
    s_mul_i32 s59, s59, 128
    s_add_u32 m0, s58, 640
    s_add_u32 s57, s59, 0
    buffer_load_dwordx4 v4, s[44:47], s57 offen  lds
    s_bfe_u32 s59, s94, 262168
    s_mul_i32 s59, s59, 128
    s_add_u32 m0, s58, 768
    s_add_u32 s57, s59, 0
    buffer_load_dwordx4 v4, s[44:47], s57 offen  lds
    s_bfe_u32 s59, s94, 262172
    s_mul_i32 s59, s59, 128
    s_add_u32 m0, s58, 896
    s_add_u32 s57, s59, 0
    buffer_load_dwordx4 v4, s[44:47], s57 offen  lds
    s_bfe_u32 s59, s95, 262144
    s_mul_i32 s59, s59, 128
    s_add_u32 m0, s58, 1024
    s_add_u32 s57, s59, 0
    buffer_load_dwordx4 v4, s[44:47], s57 offen  lds
    s_bfe_u32 s59, s95, 262148
    s_mul_i32 s59, s59, 128
    s_add_u32 m0, s58, 1152
    s_add_u32 s57, s59, 0
    buffer_load_dwordx4 v4, s[44:47], s57 offen  lds
    s_mov_b64 exec, -1
    v_lshrrev_b32 v5, 4, v0
    v_lshlrev_b32 v5, 4, v5
    v_add_u32 v5, s58, v5
    s_waitcnt vmcnt(0)
    ds_read_b128 v[32:35], v5 offset:0
    ds_read_b128 v[36:39], v5 offset:64
    ds_read_b128 v[40:43], v5 offset:128
    ds_read_b128 v[44:47], v5 offset:192
    ds_read_b128 v[48:51], v5 offset:256
    ds_read_b128 v[52:55], v5 offset:320
    ds_read_b128 v[56:59], v5 offset:384
    ds_read_b128 v[60:63], v5 offset:448
    ds_read_b128 v[64:67], v5 offset:512
    ds_read_b128 v[68:71], v5 offset:576
    s_waitcnt lgkmcnt(0)
    v_mfma_f32_16x16x32_bf16 v[80:83], v[32:35], v[96:99], 0
    v_mfma_f32_16x16x32_bf16 v[84:87], v[32:35], v[100:103], 0
    v_mfma_f32_16x16x32_bf16 v[80:83], v[36:39], v[104:107], v[80:83]
    v_mfma_f32_16x16x32_bf16 v[84:87], v[36:39], v[108:111], v[84:87]
    v_mfma_f32_16x16x32_bf16 v[80:83], v[40:43], v[112:115], v[80:83]
    v_mfma_f32_16x16x32_bf16 v[84:87], v[40:43], v[116:119], v[84:87]
    v_mfma_f32_16x16x32_bf16 v[80:83], v[44:47], v[120:123], v[80:83]
    v_mfma_f32_16x16x32_bf16 v[84:87], v[44:47], v[124:127], v[84:87]
    v_mfma_f32_16x16x32_bf16 v[80:83], v[48:51], v[128:131], v[80:83]
    v_mfma_f32_16x16x32_bf16 v[84:87], v[48:51], v[132:135], v[84:87]
    v_mfma_f32_16x16x32_bf16 v[80:83], v[52:55], v[136:139], v[80:83]
    v_mfma_f32_16x16x32_bf16 v[84:87], v[52:55], v[140:143], v[84:87]
    v_mfma_f32_16x16x32_bf16 v[80:83], v[56:59], v[144:147], v[80:83]
    v_mfma_f32_16x16x32_bf16 v[84:87], v[56:59], v[148:151], v[84:87]
    v_mfma_f32_16x16x32_bf16 v[80:83], v[60:63], v[152:155], v[80:83]
    v_mfma_f32_16x16x32_bf16 v[84:87], v[60:63], v[156:159], v[84:87]
    v_mfma_f32_16x16x32_bf16 v[80:83], v[64:67], v[160:163], v[80:83]
    v_mfma_f32_16x16x32_bf16 v[84:87], v[64:67], v[164:167], v[84:87]
    v_mfma_f32_16x16x32_bf16 v[80:83], v[68:71], v[168:171], v[80:83]
    v_mfma_f32_16x16x32_bf16 v[84:87], v[68:71], v[172:175], v[84:87]
    ds_read_b128 v[32:35], v5 offset:640
    ds_read_b128 v[36:39], v5 offset:704
    ds_read_b128 v[40:43], v5 offset:768
    ds_read_b128 v[44:47], v5 offset:832
    ds_read_b128 v[48:51], v5 offset:896
    ds_read_b128 v[52:55], v5 offset:960
    ds_read_b128 v[56:59], v5 offset:1024
    ds_read_b128 v[60:63], v5 offset:1088
    ds_read_b128 v[64:67], v5 offset:1152
    ds_read_b128 v[68:71], v5 offset:1216
    s_waitcnt lgkmcnt(0)
    v_mfma_f32_16x16x32_bf16 v[80:83], v[32:35], v[176:179], v[80:83]
    v_mfma_f32_16x16x32_bf16 v[84:87], v[32:35], v[180:183], v[84:87]
    v_mfma_f32_16x16x32_bf16 v[80:83], v[36:39], v[184:187], v[80:83]
    v_mfma_f32_16x16x32_bf16 v[84:87], v[36:39], v[188:191], v[84:87]
    v_mfma_f32_16x16x32_bf16 v[80:83], v[40:43], v[192:195], v[80:83]
    v_mfma_f32_16x16x32_bf16 v[84:87], v[40:43], v[196:199], v[84:87]
    v_mfma_f32_16x16x32_bf16 v[80:83], v[44:47], v[200:203], v[80:83]
    v_mfma_f32_16x16x32_bf16 v[84:87], v[44:47], v[204:207], v[84:87]
    v_mfma_f32_16x16x32_bf16 v[80:83], v[48:51], v[208:211], v[80:83]
    v_mfma_f32_16x16x32_bf16 v[84:87], v[48:51], v[212:215], v[84:87]
    v_mfma_f32_16x16x32_bf16 v[80:83], v[52:55], v[216:219], v[80:83]
    v_mfma_f32_16x16x32_bf16 v[84:87], v[52:55], v[220:223], v[84:87]
    v_mfma_f32_16x16x32_bf16 v[80:83], v[56:59], v[224:227], v[80:83]
    v_mfma_f32_16x16x32_bf16 v[84:87], v[56:59], v[228:231], v[84:87]
    v_mfma_f32_16x16x32_bf16 v[80:83], v[60:63], v[232:235], v[80:83]
    v_mfma_f32_16x16x32_bf16 v[84:87], v[60:63], v[236:239], v[84:87]
    v_mfma_f32_16x16x32_bf16 v[80:83], v[64:67], v[240:243], v[80:83]
    v_mfma_f32_16x16x32_bf16 v[84:87], v[64:67], v[244:247], v[84:87]
    v_mfma_f32_16x16x32_bf16 v[80:83], v[68:71], v[248:251], v[80:83]
    v_mfma_f32_16x16x32_bf16 v[84:87], v[68:71], v[252:255], v[84:87]
    s_nop 11
    v_cmp_gt_u32 vcc, 16, v0
    v_lshlrev_b32 v4, 2, v0
    s_lshl_b32 s57, s4, 9
    v_cndmask_b32 v80, v84, v80, vcc
    v_mul_f32 v80, 0xbfb8aa3b, v80
    v_exp_f32 v80, v80
    s_lshl_b32 s58, s62, 7
    v_add_f32 v80, 1.0, v80
    v_rcp_f32 v80, v80
    s_add_u32 s57, s57, s58
    s_add_u32 s57, s57, 393216
    s_mov_b32 exec_hi, 0
    buffer_store_dword v80, v4, s[20:23], s57 offen sc1
    s_mov_b32 exec_hi, -1
    v_mov_b32 v6, 0
    s_branch Lgemm
Loretry_31:
    s_mov_b32 s64, 524288
Lospin_39:
    s_sleep 4
    buffer_load_dwordx4 v[24:27], v248, s[20:23], s36 offen offset:0 sc1
    buffer_load_dwordx4 v[28:31], v248, s[20:23], s36 offen offset:1024 sc1
    buffer_load_dwordx4 v[32:35], v248, s[20:23], s36 offen offset:2048 sc1
    buffer_load_dwordx4 v[36:39], v248, s[20:23], s36 offen offset:3072 sc1
    buffer_load_dwordx2 v[40:41], v249, s[20:23], s36 offen offset:0 sc1
    buffer_load_dwordx2 v[42:43], v249, s[20:23], s36 offen offset:512 sc1
    s_sub_u32 s64, s64, 1
    s_waitcnt vmcnt(0)
    s_cbranch_scc1 Lodone_40
    v_max3_u32 v247, v24, v25, v26
    v_max3_u32 v247, v247, v27, v28
    v_max3_u32 v247, v247, v29, v30
    v_max3_u32 v247, v247, v31, v32
    v_max3_u32 v247, v247, v33, v34
    v_max3_u32 v247, v247, v35, v36
    v_max3_u32 v247, v247, v37, v38
    v_max3_u32 v247, v247, v39, v40
    v_max3_u32 v247, v247, v41, v42
    v_max_u32 v247, v247, v43
    v_cmp_eq_u32 vcc, -1, v247
    s_cbranch_vccnz Lospin_39
Lodone_40:
    buffer_load_dwordx4 v[44:47], v248, s[20:23], s37 offen offset:0 sc1
    buffer_load_dwordx4 v[48:51], v248, s[20:23], s37 offen offset:1024 sc1
    buffer_load_dwordx4 v[52:55], v248, s[20:23], s37 offen offset:2048 sc1
    buffer_load_dwordx4 v[56:59], v248, s[20:23], s37 offen offset:3072 sc1
    buffer_load_dwordx2 v[60:61], v249, s[20:23], s37 offen offset:0 sc1
    buffer_load_dwordx2 v[62:63], v249, s[20:23], s37 offen offset:512 sc1
    s_branch Loback_32
Loretry_33:
    s_mov_b32 s64, 524288
Lospin_41:
    s_sleep 4
    buffer_load_dwordx4 v[44:47], v248, s[20:23], s37 offen offset:0 sc1
    buffer_load_dwordx4 v[48:51], v248, s[20:23], s37 offen offset:1024 sc1
    buffer_load_dwordx4 v[52:55], v248, s[20:23], s37 offen offset:2048 sc1
    buffer_load_dwordx4 v[56:59], v248, s[20:23], s37 offen offset:3072 sc1
    buffer_load_dwordx2 v[60:61], v249, s[20:23], s37 offen offset:0 sc1
    buffer_load_dwordx2 v[62:63], v249, s[20:23], s37 offen offset:512 sc1
    s_sub_u32 s64, s64, 1
    s_waitcnt vmcnt(0)
    s_cbranch_scc1 Lodone_42
    v_max3_u32 v247, v44, v45, v46
    v_max3_u32 v247, v247, v47, v48
    v_max3_u32 v247, v247, v49, v50
    v_max3_u32 v247, v247, v51, v52
    v_max3_u32 v247, v247, v53, v54
    v_max3_u32 v247, v247, v55, v56
    v_max3_u32 v247, v247, v57, v58
    v_max3_u32 v247, v247, v59, v60
    v_max3_u32 v247, v247, v61, v62
    v_max_u32 v247, v247, v63
    v_cmp_eq_u32 vcc, -1, v247
    s_cbranch_vccnz Lospin_41
Lodone_42:
    s_branch Loback_34
Loretry_35:
    s_mov_b32 s64, 524288
Lospin_43:
    s_sleep 4
    buffer_load_dwordx4 v[224:227], v248, s[20:23], s38 offen offset:0 sc1
    buffer_load_dwordx4 v[228:231], v248, s[20:23], s38 offen offset:1024 sc1
    buffer_load_dwordx4 v[232:235], v248, s[20:23], s38 offen offset:2048 sc1
    buffer_load_dwordx4 v[236:239], v248, s[20:23], s38 offen offset:3072 sc1
    buffer_load_dwordx2 v[240:241], v249, s[20:23], s38 offen offset:0 sc1
    buffer_load_dwordx2 v[242:243], v249, s[20:23], s38 offen offset:512 sc1
    s_sub_u32 s64, s64, 1
    s_waitcnt vmcnt(0)
    s_cbranch_scc1 Lodone_44
    v_max3_u32 v247, v224, v225, v226
    v_max3_u32 v247, v247, v227, v228
    v_max3_u32 v247, v247, v229, v230
    v_max3_u32 v247, v247, v231, v232
    v_max3_u32 v247, v247, v233, v234
    v_max3_u32 v247, v247, v235, v236
    v_max3_u32 v247, v247, v237, v238
    v_max3_u32 v247, v247, v239, v240
    v_max3_u32 v247, v247, v241, v242
    v_max_u32 v247, v247, v243
    v_cmp_eq_u32 vcc, -1, v247
    s_cbranch_vccnz Lospin_43
Lodone_44:
    s_branch Loback_36
Loretry_37:
    s_mov_b32 s64, 524288
Lospin_45:
    s_sleep 4
    buffer_load_dwordx4 v[24:27], v248, s[20:23], s39 offen offset:0 sc1
    buffer_load_dwordx4 v[28:31], v248, s[20:23], s39 offen offset:1024 sc1
    buffer_load_dwordx4 v[32:35], v248, s[20:23], s39 offen offset:2048 sc1
    buffer_load_dwordx4 v[36:39], v248, s[20:23], s39 offen offset:3072 sc1
    buffer_load_dwordx2 v[40:41], v249, s[20:23], s39 offen offset:0 sc1
    buffer_load_dwordx2 v[42:43], v249, s[20:23], s39 offen offset:512 sc1
    s_sub_u32 s64, s64, 1
    s_waitcnt vmcnt(0)
    s_cbranch_scc1 Lodone_46
    v_max3_u32 v247, v24, v25, v26
    v_max3_u32 v247, v247, v27, v28
    v_max3_u32 v247, v247, v29, v30
    v_max3_u32 v247, v247, v31, v32
    v_max3_u32 v247, v247, v33, v34
    v_max3_u32 v247, v247, v35, v36
    v_max3_u32 v247, v247, v37, v38
    v_max3_u32 v247, v247, v39, v40
    v_max3_u32 v247, v247, v41, v42
    v_max_u32 v247, v247, v43
    v_cmp_eq_u32 vcc, -1, v247
    s_cbranch_vccnz Lospin_45
Lodone_46:
    s_branch Loback_38
.fill 121, 4, 0xbf800000
LpassA_v:
    s_waitcnt vmcnt(0)
    s_barrier
    ds_read_b64_tr_b16 v[160:161], v9 offset:16384
    ds_read_b64_tr_b16 v[162:163], v9 offset:17408
    ds_read_b64_tr_b16 v[164:165], v9 offset:24576
    ds_read_b64_tr_b16 v[166:167], v9 offset:25600
    ds_read_b128 v[128:131], v7 offset:0
    ds_read_b128 v[144:147], v8 offset:0
    ds_read_b128 v[132:135], v7 offset:2048
    ds_read_b128 v[148:151], v8 offset:2048
    ds_read_b128 v[136:139], v7 offset:4096
    ds_read_b128 v[152:155], v8 offset:4096
    ds_read_b128 v[140:143], v7 offset:6144
    ds_read_b128 v[156:159], v8 offset:6144
    ds_read_b64_tr_b16 v[168:169], v10 offset:16384
    ds_read_b64_tr_b16 v[170:171], v10 offset:17408
    ds_read_b64_tr_b16 v[172:173], v10 offset:24576
    ds_read_b64_tr_b16 v[174:175], v10 offset:25600
    ds_read_b64_tr_b16 v[176:177], v11 offset:16384
    ds_read_b64_tr_b16 v[178:179], v11 offset:17408
    ds_read_b64_tr_b16 v[180:181], v11 offset:24576
    ds_read_b64_tr_b16 v[182:183], v11 offset:25600
    ds_read_b64_tr_b16 v[184:185], v12 offset:16384
    ds_read_b64_tr_b16 v[186:187], v12 offset:17408
    ds_read_b64_tr_b16 v[188:189], v12 offset:24576
    ds_read_b64_tr_b16 v[190:191], v12 offset:25600
    s_waitcnt lgkmcnt(15)
    v_mfma_f32_16x16x32_bf16 v[64:67], v[128:131], v[160:163], 0
    v_mfma_f32_16x16x32_bf16 v[64:67], v[144:147], v[164:167], v[64:67]
    v_mfma_f32_16x16x32_bf16 v[68:71], v[132:135], v[160:163], 0
    v_mfma_f32_16x16x32_bf16 v[68:71], v[148:151], v[164:167], v[68:71]
    s_waitcnt lgkmcnt(14)
    v_mfma_f32_16x16x32_bf16 v[72:75], v[136:139], v[160:163], 0
    v_mfma_f32_16x16x32_bf16 v[72:75], v[152:155], v[164:167], v[72:75]
    s_waitcnt lgkmcnt(12)
    v_mfma_f32_16x16x32_bf16 v[76:79], v[140:143], v[160:163], 0
    v_mfma_f32_16x16x32_bf16 v[76:79], v[156:159], v[164:167], v[76:79]
    s_waitcnt lgkmcnt(8)
    v_mfma_f32_16x16x32_bf16 v[80:83], v[128:131], v[168:171], 0
    v_mfma_f32_16x16x32_bf16 v[80:83], v[144:147], v[172:175], v[80:83]
    v_mfma_f32_16x16x32_bf16 v[84:87], v[132:135], v[168:171], 0
    v_mfma_f32_16x16x32_bf16 v[84:87], v[148:151], v[172:175], v[84:87]
    v_mfma_f32_16x16x32_bf16 v[88:91], v[136:139], v[168:171], 0
    v_mfma_f32_16x16x32_bf16 v[88:91], v[152:155], v[172:175], v[88:91]
    v_mfma_f32_16x16x32_bf16 v[92:95], v[140:143], v[168:171], 0
    v_mfma_f32_16x16x32_bf16 v[92:95], v[156:159], v[172:175], v[92:95]
    s_waitcnt lgkmcnt(4)
    v_mfma_f32_16x16x32_bf16 v[96:99], v[128:131], v[176:179], 0
    v_mfma_f32_16x16x32_bf16 v[96:99], v[144:147], v[180:183], v[96:99]
    v_mfma_f32_16x16x32_bf16 v[100:103], v[132:135], v[176:179], 0
    v_mfma_f32_16x16x32_bf16 v[100:103], v[148:151], v[180:183], v[100:103]
    v_mfma_f32_16x16x32_bf16 v[104:107], v[136:139], v[176:179], 0
    v_mfma_f32_16x16x32_bf16 v[104:107], v[152:155], v[180:183], v[104:107]
    v_mfma_f32_16x16x32_bf16 v[108:111], v[140:143], v[176:179], 0
    v_mfma_f32_16x16x32_bf16 v[108:111], v[156:159], v[180:183], v[108:111]
    s_waitcnt lgkmcnt(0)
    v_mfma_f32_16x16x32_bf16 v[112:115], v[128:131], v[184:187], 0
    v_mfma_f32_16x16x32_bf16 v[112:115], v[144:147], v[188:191], v[112:115]
    v_mfma_f32_16x16x32_bf16 v[116:119], v[132:135], v[184:187], 0
    v_mfma_f32_16x16x32_bf16 v[116:119], v[148:151], v[188:191], v[116:119]
    v_mfma_f32_16x16x32_bf16 v[120:123], v[136:139], v[184:187], 0
    v_mfma_f32_16x16x32_bf16 v[120:123], v[152:155], v[188:191], v[120:123]
    v_mfma_f32_16x16x32_bf16 v[124:127], v[140:143], v[184:187], 0
    v_mfma_f32_16x16x32_bf16 v[124:127], v[156:159], v[188:191], v[124:127]
    s_cmp_eq_u32 0, 0
    s_branch Lpad_at_0
Lwarm_at_v:
    s_barrier
    ds_read_b64_tr_b16 v[224:225], v9 offset:49152
    ds_read_b64_tr_b16 v[226:227], v9 offset:50176
    ds_read_b64_tr_b16 v[228:229], v9 offset:57344
    ds_read_b64_tr_b16 v[230:231], v9 offset:58368
    ds_read_b128 v[192:195], v7 offset:32768
    ds_read_b128 v[208:211], v8 offset:32768
    ds_read_b128 v[196:199], v7 offset:34816
    ds_read_b128 v[212:215], v8 offset:34816
    ds_read_b128 v[200:203], v7 offset:36864
    ds_read_b128 v[216:219], v8 offset:36864
    ds_read_b128 v[204:207], v7 offset:38912
    ds_read_b128 v[220:223], v8 offset:38912
    ds_read_b64_tr_b16 v[232:233], v10 offset:49152
    ds_read_b64_tr_b16 v[234:235], v10 offset:50176
    ds_read_b64_tr_b16 v[236:237], v10 offset:57344
    ds_read_b64_tr_b16 v[238:239], v10 offset:58368
    ds_read_b64_tr_b16 v[240:241], v11 offset:49152
    ds_read_b64_tr_b16 v[242:243], v11 offset:50176
    ds_read_b64_tr_b16 v[244:245], v11 offset:57344
    ds_read_b64_tr_b16 v[246:247], v11 offset:58368
    ds_read_b64_tr_b16 v[248:249], v12 offset:49152
    ds_read_b64_tr_b16 v[250:251], v12 offset:50176
    ds_read_b64_tr_b16 v[252:253], v12 offset:57344
    ds_read_b64_tr_b16 v[254:255], v12 offset:58368
    s_waitcnt lgkmcnt(15)
    v_mfma_f32_16x16x32_bf16 v[64:67], v[192:195], v[224:227], v[64:67]
    v_mfma_f32_16x16x32_bf16 v[64:67], v[208:211], v[228:231], v[64:67]
    v_mfma_f32_16x16x32_bf16 v[68:71], v[196:199], v[224:227], v[68:71]
    v_mfma_f32_16x16x32_bf16 v[68:71], v[212:215], v[228:231], v[68:71]
    s_waitcnt lgkmcnt(14)
    v_mfma_f32_16x16x32_bf16 v[72:75], v[200:203], v[224:227], v[72:75]
    v_mfma_f32_16x16x32_bf16 v[72:75], v[216:219], v[228:231], v[72:75]
    s_waitcnt lgkmcnt(12)
    v_mfma_f32_16x16x32_bf16 v[76:79], v[204:207], v[224:227], v[76:79]
    v_mfma_f32_16x16x32_bf16 v[76:79], v[220:223], v[228:231], v[76:79]
    s_waitcnt lgkmcnt(0)
    s_barrier
    v_mfma_f32_16x16x32_bf16 v[80:83], v[192:195], v[232:235], v[80:83]
    v_add_u32 v9, 81920, v9
    ds_read_b64_tr_b16 v[160:161], v9 offset:0
    v_mfma_f32_16x16x32_bf16 v[80:83], v[208:211], v[236:239], v[80:83]
    ds_read_b64_tr_b16 v[162:163], v9 offset:1024
    v_mfma_f32_16x16x32_bf16 v[84:87], v[196:199], v[232:235], v[84:87]
    ds_read_b64_tr_b16 v[164:165], v9 offset:8192
    v_mfma_f32_16x16x32_bf16 v[84:87], v[212:215], v[236:239], v[84:87]
    ds_read_b64_tr_b16 v[166:167], v9 offset:9216
    v_mfma_f32_16x16x32_bf16 v[88:91], v[200:203], v[232:235], v[88:91]
    v_add_u32 v7, 65536, v7
    ds_read_b128 v[128:131], v7 offset:0
    v_mfma_f32_16x16x32_bf16 v[88:91], v[216:219], v[236:239], v[88:91]
    v_add_u32 v8, 65536, v8
    ds_read_b128 v[144:147], v8 offset:0
    v_mfma_f32_16x16x32_bf16 v[92:95], v[204:207], v[232:235], v[92:95]
    ds_read_b128 v[132:135], v7 offset:2048
    v_mfma_f32_16x16x32_bf16 v[92:95], v[220:223], v[236:239], v[92:95]
    ds_read_b128 v[148:151], v8 offset:2048
    v_mfma_f32_16x16x32_bf16 v[96:99], v[192:195], v[240:243], v[96:99]
    ds_read_b128 v[136:139], v7 offset:4096
    v_mfma_f32_16x16x32_bf16 v[96:99], v[208:211], v[244:247], v[96:99]
    ds_read_b128 v[152:155], v8 offset:4096
    v_mfma_f32_16x16x32_bf16 v[100:103], v[196:199], v[240:243], v[100:103]
    ds_read_b128 v[140:143], v7 offset:6144
    v_mfma_f32_16x16x32_bf16 v[100:103], v[212:215], v[244:247], v[100:103]
    ds_read_b128 v[156:159], v8 offset:6144
    v_mfma_f32_16x16x32_bf16 v[104:107], v[200:203], v[240:243], v[104:107]
    v_add_u32 v10, 81920, v10
    ds_read_b64_tr_b16 v[168:169], v10 offset:0
    v_mfma_f32_16x16x32_bf16 v[104:107], v[216:219], v[244:247], v[104:107]
    ds_read_b64_tr_b16 v[170:171], v10 offset:1024
    v_mfma_f32_16x16x32_bf16 v[108:111], v[204:207], v[240:243], v[108:111]
    ds_read_b64_tr_b16 v[172:173], v10 offset:8192
    v_mfma_f32_16x16x32_bf16 v[108:111], v[220:223], v[244:247], v[108:111]
    ds_read_b64_tr_b16 v[174:175], v10 offset:9216
    v_mfma_f32_16x16x32_bf16 v[112:115], v[192:195], v[248:251], v[112:115]
    v_add_u32 v11, 81920, v11
    ds_read_b64_tr_b16 v[176:177], v11 offset:0
    v_mfma_f32_16x16x32_bf16 v[112:115], v[208:211], v[252:255], v[112:115]
    ds_read_b64_tr_b16 v[178:179], v11 offset:1024
    v_mfma_f32_16x16x32_bf16 v[116:119], v[196:199], v[248:251], v[116:119]
    ds_read_b64_tr_b16 v[180:181], v11 offset:8192
    v_mfma_f32_16x16x32_bf16 v[116:119], v[212:215], v[252:255], v[116:119]
    ds_read_b64_tr_b16 v[182:183], v11 offset:9216
    v_mfma_f32_16x16x32_bf16 v[120:123], v[200:203], v[248:251], v[120:123]
    v_add_u32 v12, 81920, v12
    ds_read_b64_tr_b16 v[184:185], v12 offset:0
    v_mfma_f32_16x16x32_bf16 v[120:123], v[216:219], v[252:255], v[120:123]
    ds_read_b64_tr_b16 v[186:187], v12 offset:1024
    v_mfma_f32_16x16x32_bf16 v[124:127], v[204:207], v[248:251], v[124:127]
    ds_read_b64_tr_b16 v[188:189], v12 offset:8192
    v_mfma_f32_16x16x32_bf16 v[124:127], v[220:223], v[252:255], v[124:127]
    ds_read_b64_tr_b16 v[190:191], v12 offset:9216
    s_waitcnt lgkmcnt(15)
    v_mfma_f32_16x16x32_bf16 v[64:67], v[128:131], v[160:163], v[64:67]
    v_mfma_f32_16x16x32_bf16 v[64:67], v[144:147], v[164:167], v[64:67]
    v_mfma_f32_16x16x32_bf16 v[68:71], v[132:135], v[160:163], v[68:71]
    v_mfma_f32_16x16x32_bf16 v[68:71], v[148:151], v[164:167], v[68:71]
    s_waitcnt lgkmcnt(14)
    v_mfma_f32_16x16x32_bf16 v[72:75], v[136:139], v[160:163], v[72:75]
    v_mfma_f32_16x16x32_bf16 v[72:75], v[152:155], v[164:167], v[72:75]
    s_waitcnt lgkmcnt(12)
    v_mfma_f32_16x16x32_bf16 v[76:79], v[140:143], v[160:163], v[76:79]
    v_mfma_f32_16x16x32_bf16 v[76:79], v[156:159], v[164:167], v[76:79]
    s_waitcnt lgkmcnt(0)
    s_barrier
    v_mfma_f32_16x16x32_bf16 v[80:83], v[128:131], v[168:171], v[80:83]
    ds_read_b64_tr_b16 v[224:225], v9 offset:32768
    v_mfma_f32_16x16x32_bf16 v[80:83], v[144:147], v[172:175], v[80:83]
    ds_read_b64_tr_b16 v[226:227], v9 offset:33792
    v_mfma_f32_16x16x32_bf16 v[84:87], v[132:135], v[168:171], v[84:87]
    ds_read_b64_tr_b16 v[228:229], v9 offset:40960
    v_mfma_f32_16x16x32_bf16 v[84:87], v[148:151], v[172:175], v[84:87]
    ds_read_b64_tr_b16 v[230:231], v9 offset:41984
    v_mfma_f32_16x16x32_bf16 v[88:91], v[136:139], v[168:171], v[88:91]
    ds_read_b128 v[192:195], v7 offset:32768
    v_mfma_f32_16x16x32_bf16 v[88:91], v[152:155], v[172:175], v[88:91]
    ds_read_b128 v[208:211], v8 offset:32768
    v_mfma_f32_16x16x32_bf16 v[92:95], v[140:143], v[168:171], v[92:95]
    ds_read_b128 v[196:199], v7 offset:34816
    v_mfma_f32_16x16x32_bf16 v[92:95], v[156:159], v[172:175], v[92:95]
    ds_read_b128 v[212:215], v8 offset:34816
    v_mfma_f32_16x16x32_bf16 v[96:99], v[128:131], v[176:179], v[96:99]
    ds_read_b128 v[200:203], v7 offset:36864
    v_mfma_f32_16x16x32_bf16 v[96:99], v[144:147], v[180:183], v[96:99]
    ds_read_b128 v[216:219], v8 offset:36864
    v_mfma_f32_16x16x32_bf16 v[100:103], v[132:135], v[176:179], v[100:103]
    ds_read_b128 v[204:207], v7 offset:38912
    v_mfma_f32_16x16x32_bf16 v[100:103], v[148:151], v[180:183], v[100:103]
    ds_read_b128 v[220:223], v8 offset:38912
    v_mfma_f32_16x16x32_bf16 v[104:107], v[136:139], v[176:179], v[104:107]
    ds_read_b64_tr_b16 v[232:233], v10 offset:32768
    v_mfma_f32_16x16x32_bf16 v[104:107], v[152:155], v[180:183], v[104:107]
    ds_read_b64_tr_b16 v[234:235], v10 offset:33792
    v_mfma_f32_16x16x32_bf16 v[108:111], v[140:143], v[176:179], v[108:111]
    ds_read_b64_tr_b16 v[236:237], v10 offset:40960
    v_mfma_f32_16x16x32_bf16 v[108:111], v[156:159], v[180:183], v[108:111]
    ds_read_b64_tr_b16 v[238:239], v10 offset:41984
    v_mfma_f32_16x16x32_bf16 v[112:115], v[128:131], v[184:187], v[112:115]
    ds_read_b64_tr_b16 v[240:241], v11 offset:32768
    v_mfma_f32_16x16x32_bf16 v[112:115], v[144:147], v[188:191], v[112:115]
    ds_read_b64_tr_b16 v[242:243], v11 offset:33792
    v_mfma_f32_16x16x32_bf16 v[116:119], v[132:135], v[184:187], v[116:119]
    ds_read_b64_tr_b16 v[244:245], v11 offset:40960
    v_mfma_f32_16x16x32_bf16 v[116:119], v[148:151], v[188:191], v[116:119]
    ds_read_b64_tr_b16 v[246:247], v11 offset:41984
    v_mfma_f32_16x16x32_bf16 v[120:123], v[136:139], v[184:187], v[120:123]
    ds_read_b64_tr_b16 v[248:249], v12 offset:32768
    v_mfma_f32_16x16x32_bf16 v[120:123], v[152:155], v[188:191], v[120:123]
    ds_read_b64_tr_b16 v[250:251], v12 offset:33792
    v_mfma_f32_16x16x32_bf16 v[124:127], v[140:143], v[184:187], v[124:127]
    ds_read_b64_tr_b16 v[252:253], v12 offset:40960
    v_mfma_f32_16x16x32_bf16 v[124:127], v[156:159], v[188:191], v[124:127]
    ds_read_b64_tr_b16 v[254:255], v12 offset:41984
    s_waitcnt lgkmcnt(15)
    v_mfma_f32_16x16x32_bf16 v[64:67], v[192:195], v[224:227], v[64:67]
    v_mfma_f32_16x16x32_bf16 v[64:67], v[208:211], v[228:231], v[64:67]
    v_mfma_f32_16x16x32_bf16 v[68:71], v[196:199], v[224:227], v[68:71]
    v_mfma_f32_16x16x32_bf16 v[68:71], v[212:215], v[228:231], v[68:71]
    s_waitcnt lgkmcnt(14)
    v_mfma_f32_16x16x32_bf16 v[72:75], v[200:203], v[224:227], v[72:75]
    v_mfma_f32_16x16x32_bf16 v[72:75], v[216:219], v[228:231], v[72:75]
    s_waitcnt lgkmcnt(12)
    v_mfma_f32_16x16x32_bf16 v[76:79], v[204:207], v[224:227], v[76:79]
    v_mfma_f32_16x16x32_bf16 v[76:79], v[220:223], v[228:231], v[76:79]
    s_waitcnt lgkmcnt(0)
    s_barrier
    v_mfma_f32_16x16x32_bf16 v[80:83], v[192:195], v[232:235], v[80:83]
    v_add_u32 v9, 16384, v9
    ds_read_b64_tr_b16 v[160:161], v9 offset:49152
    v_mfma_f32_16x16x32_bf16 v[80:83], v[208:211], v[236:239], v[80:83]
    ds_read_b64_tr_b16 v[162:163], v9 offset:50176
    v_mfma_f32_16x16x32_bf16 v[84:87], v[196:199], v[232:235], v[84:87]
    ds_read_b64_tr_b16 v[164:165], v9 offset:57344
    v_mfma_f32_16x16x32_bf16 v[84:87], v[212:215], v[236:239], v[84:87]
    ds_read_b64_tr_b16 v[166:167], v9 offset:58368
    v_mfma_f32_16x16x32_bf16 v[88:91], v[200:203], v[232:235], v[88:91]
    v_add_u32 v7, 32768, v7
    ds_read_b128 v[128:131], v7 offset:32768
    v_mfma_f32_16x16x32_bf16 v[88:91], v[216:219], v[236:239], v[88:91]
    v_add_u32 v8, 32768, v8
    ds_read_b128 v[144:147], v8 offset:32768
    v_mfma_f32_16x16x32_bf16 v[92:95], v[204:207], v[232:235], v[92:95]
    ds_read_b128 v[132:135], v7 offset:34816
    v_mfma_f32_16x16x32_bf16 v[92:95], v[220:223], v[236:239], v[92:95]
    ds_read_b128 v[148:151], v8 offset:34816
    v_mfma_f32_16x16x32_bf16 v[96:99], v[192:195], v[240:243], v[96:99]
    ds_read_b128 v[136:139], v7 offset:36864
    v_mfma_f32_16x16x32_bf16 v[96:99], v[208:211], v[244:247], v[96:99]
    ds_read_b128 v[152:155], v8 offset:36864
    v_mfma_f32_16x16x32_bf16 v[100:103], v[196:199], v[240:243], v[100:103]
    ds_read_b128 v[140:143], v7 offset:38912
    v_mfma_f32_16x16x32_bf16 v[100:103], v[212:215], v[244:247], v[100:103]
    ds_read_b128 v[156:159], v8 offset:38912
    v_mfma_f32_16x16x32_bf16 v[104:107], v[200:203], v[240:243], v[104:107]
    v_add_u32 v10, 16384, v10
    ds_read_b64_tr_b16 v[168:169], v10 offset:49152
    v_mfma_f32_16x16x32_bf16 v[104:107], v[216:219], v[244:247], v[104:107]
    ds_read_b64_tr_b16 v[170:171], v10 offset:50176
    v_mfma_f32_16x16x32_bf16 v[108:111], v[204:207], v[240:243], v[108:111]
    ds_read_b64_tr_b16 v[172:173], v10 offset:57344
    v_mfma_f32_16x16x32_bf16 v[108:111], v[220:223], v[244:247], v[108:111]
    ds_read_b64_tr_b16 v[174:175], v10 offset:58368
    v_mfma_f32_16x16x32_bf16 v[112:115], v[192:195], v[248:251], v[112:115]
    v_add_u32 v11, 16384, v11
    ds_read_b64_tr_b16 v[176:177], v11 offset:49152
    v_mfma_f32_16x16x32_bf16 v[112:115], v[208:211], v[252:255], v[112:115]
    ds_read_b64_tr_b16 v[178:179], v11 offset:50176
    v_mfma_f32_16x16x32_bf16 v[116:119], v[196:199], v[248:251], v[116:119]
    ds_read_b64_tr_b16 v[180:181], v11 offset:57344
    v_mfma_f32_16x16x32_bf16 v[116:119], v[212:215], v[252:255], v[116:119]
    ds_read_b64_tr_b16 v[182:183], v11 offset:58368
    v_mfma_f32_16x16x32_bf16 v[120:123], v[200:203], v[248:251], v[120:123]
    v_add_u32 v12, 16384, v12
    ds_read_b64_tr_b16 v[184:185], v12 offset:49152
    v_mfma_f32_16x16x32_bf16 v[120:123], v[216:219], v[252:255], v[120:123]
    ds_read_b64_tr_b16 v[186:187], v12 offset:50176
    v_mfma_f32_16x16x32_bf16 v[124:127], v[204:207], v[248:251], v[124:127]
    ds_read_b64_tr_b16 v[188:189], v12 offset:57344
    v_mfma_f32_16x16x32_bf16 v[124:127], v[220:223], v[252:255], v[124:127]
    ds_read_b64_tr_b16 v[190:191], v12 offset:58368
    s_waitcnt lgkmcnt(15)
    v_mfma_f32_16x16x32_bf16 v[64:67], v[128:131], v[160:163], v[64:67]
    v_mfma_f32_16x16x32_bf16 v[64:67], v[144:147], v[164:167], v[64:67]
    v_mfma_f32_16x16x32_bf16 v[68:71], v[132:135], v[160:163], v[68:71]
    v_mfma_f32_16x16x32_bf16 v[68:71], v[148:151], v[164:167], v[68:71]
    s_waitcnt lgkmcnt(14)
    v_mfma_f32_16x16x32_bf16 v[72:75], v[136:139], v[160:163], v[72:75]
    v_mfma_f32_16x16x32_bf16 v[72:75], v[152:155], v[164:167], v[72:75]
    s_waitcnt lgkmcnt(12)
    v_mfma_f32_16x16x32_bf16 v[76:79], v[140:143], v[160:163], v[76:79]
    v_mfma_f32_16x16x32_bf16 v[76:79], v[156:159], v[164:167], v[76:79]
    s_waitcnt lgkmcnt(0)
    s_barrier
    v_mfma_f32_16x16x32_bf16 v[80:83], v[128:131], v[168:171], v[80:83]
    v_add_u32 v9, 4294885376, v9
    ds_read_b64_tr_b16 v[224:225], v9 offset:0
    v_mfma_f32_16x16x32_bf16 v[80:83], v[144:147], v[172:175], v[80:83]
    ds_read_b64_tr_b16 v[226:227], v9 offset:1024
    v_mfma_f32_16x16x32_bf16 v[84:87], v[132:135], v[168:171], v[84:87]
    ds_read_b64_tr_b16 v[228:229], v9 offset:8192
    v_mfma_f32_16x16x32_bf16 v[84:87], v[148:151], v[172:175], v[84:87]
    ds_read_b64_tr_b16 v[230:231], v9 offset:9216
    v_mfma_f32_16x16x32_bf16 v[88:91], v[136:139], v[168:171], v[88:91]
    v_add_u32 v7, 4294868992, v7
    ds_read_b128 v[192:195], v7 offset:0
    v_mfma_f32_16x16x32_bf16 v[88:91], v[152:155], v[172:175], v[88:91]
    v_add_u32 v8, 4294868992, v8
    ds_read_b128 v[208:211], v8 offset:0
    v_mfma_f32_16x16x32_bf16 v[92:95], v[140:143], v[168:171], v[92:95]
    ds_read_b128 v[196:199], v7 offset:2048
    v_mfma_f32_16x16x32_bf16 v[92:95], v[156:159], v[172:175], v[92:95]
    ds_read_b128 v[212:215], v8 offset:2048
    v_mfma_f32_16x16x32_bf16 v[96:99], v[128:131], v[176:179], v[96:99]
    ds_read_b128 v[200:203], v7 offset:4096
    v_mfma_f32_16x16x32_bf16 v[96:99], v[144:147], v[180:183], v[96:99]
    ds_read_b128 v[216:219], v8 offset:4096
    v_mfma_f32_16x16x32_bf16 v[100:103], v[132:135], v[176:179], v[100:103]
    ds_read_b128 v[204:207], v7 offset:6144
    v_mfma_f32_16x16x32_bf16 v[100:103], v[148:151], v[180:183], v[100:103]
    ds_read_b128 v[220:223], v8 offset:6144
    v_mfma_f32_16x16x32_bf16 v[104:107], v[136:139], v[176:179], v[104:107]
    v_add_u32 v10, 4294885376, v10
    ds_read_b64_tr_b16 v[232:233], v10 offset:0
    v_mfma_f32_16x16x32_bf16 v[104:107], v[152:155], v[180:183], v[104:107]
    ds_read_b64_tr_b16 v[234:235], v10 offset:1024
    v_mfma_f32_16x16x32_bf16 v[108:111], v[140:143], v[176:179], v[108:111]
    ds_read_b64_tr_b16 v[236:237], v10 offset:8192
    v_mfma_f32_16x16x32_bf16 v[108:111], v[156:159], v[180:183], v[108:111]
    ds_read_b64_tr_b16 v[238:239], v10 offset:9216
    v_mfma_f32_16x16x32_bf16 v[112:115], v[128:131], v[184:187], v[112:115]
    v_add_u32 v11, 4294885376, v11
    ds_read_b64_tr_b16 v[240:241], v11 offset:0
    v_mfma_f32_16x16x32_bf16 v[112:115], v[144:147], v[188:191], v[112:115]
    ds_read_b64_tr_b16 v[242:243], v11 offset:1024
    v_mfma_f32_16x16x32_bf16 v[116:119], v[132:135], v[184:187], v[116:119]
    ds_read_b64_tr_b16 v[244:245], v11 offset:8192
    v_mfma_f32_16x16x32_bf16 v[116:119], v[148:151], v[188:191], v[116:119]
    ds_read_b64_tr_b16 v[246:247], v11 offset:9216
    v_mfma_f32_16x16x32_bf16 v[120:123], v[136:139], v[184:187], v[120:123]
    v_add_u32 v12, 4294885376, v12
    ds_read_b64_tr_b16 v[248:249], v12 offset:0
    v_mfma_f32_16x16x32_bf16 v[120:123], v[152:155], v[188:191], v[120:123]
    ds_read_b64_tr_b16 v[250:251], v12 offset:1024
    v_mfma_f32_16x16x32_bf16 v[124:127], v[140:143], v[184:187], v[124:127]
    ds_read_b64_tr_b16 v[252:253], v12 offset:8192
    v_mfma_f32_16x16x32_bf16 v[124:127], v[156:159], v[188:191], v[124:127]
    ds_read_b64_tr_b16 v[254:255], v12 offset:9216
    s_waitcnt lgkmcnt(15)
    v_mfma_f32_16x16x32_bf16 v[64:67], v[192:195], v[224:227], v[64:67]
    v_mfma_f32_16x16x32_bf16 v[64:67], v[208:211], v[228:231], v[64:67]
    v_mfma_f32_16x16x32_bf16 v[68:71], v[196:199], v[224:227], v[68:71]
    v_mfma_f32_16x16x32_bf16 v[68:71], v[212:215], v[228:231], v[68:71]
    s_waitcnt lgkmcnt(14)
    v_mfma_f32_16x16x32_bf16 v[72:75], v[200:203], v[224:227], v[72:75]
    v_mfma_f32_16x16x32_bf16 v[72:75], v[216:219], v[228:231], v[72:75]
    s_waitcnt lgkmcnt(12)
    v_mfma_f32_16x16x32_bf16 v[76:79], v[204:207], v[224:227], v[76:79]
    v_mfma_f32_16x16x32_bf16 v[76:79], v[220:223], v[228:231], v[76:79]
    s_waitcnt lgkmcnt(0)
    s_barrier
    v_mfma_f32_16x16x32_bf16 v[80:83], v[192:195], v[232:235], v[80:83]
    ds_read_b64_tr_b16 v[160:161], v9 offset:32768
    v_mfma_f32_16x16x32_bf16 v[80:83], v[208:211], v[236:239], v[80:83]
    ds_read_b64_tr_b16 v[162:163], v9 offset:33792
    v_mfma_f32_16x16x32_bf16 v[84:87], v[196:199], v[232:235], v[84:87]
    ds_read_b64_tr_b16 v[164:165], v9 offset:40960
    v_mfma_f32_16x16x32_bf16 v[84:87], v[212:215], v[236:239], v[84:87]
    ds_read_b64_tr_b16 v[166:167], v9 offset:41984
    v_mfma_f32_16x16x32_bf16 v[88:91], v[200:203], v[232:235], v[88:91]
    ds_read_b128 v[128:131], v7 offset:32768
    v_mfma_f32_16x16x32_bf16 v[88:91], v[216:219], v[236:239], v[88:91]
    ds_read_b128 v[144:147], v8 offset:32768
    v_mfma_f32_16x16x32_bf16 v[92:95], v[204:207], v[232:235], v[92:95]
    ds_read_b128 v[132:135], v7 offset:34816
    v_mfma_f32_16x16x32_bf16 v[92:95], v[220:223], v[236:239], v[92:95]
    ds_read_b128 v[148:151], v8 offset:34816
    v_mfma_f32_16x16x32_bf16 v[96:99], v[192:195], v[240:243], v[96:99]
    ds_read_b128 v[136:139], v7 offset:36864
    v_mfma_f32_16x16x32_bf16 v[96:99], v[208:211], v[244:247], v[96:99]
    ds_read_b128 v[152:155], v8 offset:36864
    v_mfma_f32_16x16x32_bf16 v[100:103], v[196:199], v[240:243], v[100:103]
    ds_read_b128 v[140:143], v7 offset:38912
    v_mfma_f32_16x16x32_bf16 v[100:103], v[212:215], v[244:247], v[100:103]
    ds_read_b128 v[156:159], v8 offset:38912
    v_mfma_f32_16x16x32_bf16 v[104:107], v[200:203], v[240:243], v[104:107]
    ds_read_b64_tr_b16 v[168:169], v10 offset:32768
    v_mfma_f32_16x16x32_bf16 v[104:107], v[216:219], v[244:247], v[104:107]
    ds_read_b64_tr_b16 v[170:171], v10 offset:33792
    v_mfma_f32_16x16x32_bf16 v[108:111], v[204:207], v[240:243], v[108:111]
    ds_read_b64_tr_b16 v[172:173], v10 offset:40960
    v_mfma_f32_16x16x32_bf16 v[108:111], v[220:223], v[244:247], v[108:111]
    ds_read_b64_tr_b16 v[174:175], v10 offset:41984
    v_mfma_f32_16x16x32_bf16 v[112:115], v[192:195], v[248:251], v[112:115]
    ds_read_b64_tr_b16 v[176:177], v11 offset:32768
    v_mfma_f32_16x16x32_bf16 v[112:115], v[208:211], v[252:255], v[112:115]
    ds_read_b64_tr_b16 v[178:179], v11 offset:33792
    v_mfma_f32_16x16x32_bf16 v[116:119], v[196:199], v[248:251], v[116:119]
    ds_read_b64_tr_b16 v[180:181], v11 offset:40960
    v_mfma_f32_16x16x32_bf16 v[116:119], v[212:215], v[252:255], v[116:119]
    ds_read_b64_tr_b16 v[182:183], v11 offset:41984
    v_mfma_f32_16x16x32_bf16 v[120:123], v[200:203], v[248:251], v[120:123]
    ds_read_b64_tr_b16 v[184:185], v12 offset:32768
    v_mfma_f32_16x16x32_bf16 v[120:123], v[216:219], v[252:255], v[120:123]
    ds_read_b64_tr_b16 v[186:187], v12 offset:33792
    v_mfma_f32_16x16x32_bf16 v[124:127], v[204:207], v[248:251], v[124:127]
    ds_read_b64_tr_b16 v[188:189], v12 offset:40960
    v_mfma_f32_16x16x32_bf16 v[124:127], v[220:223], v[252:255], v[124:127]
    ds_read_b64_tr_b16 v[190:191], v12 offset:41984
    s_waitcnt lgkmcnt(15)
    v_mfma_f32_16x16x32_bf16 v[64:67], v[128:131], v[160:163], v[64:67]
    v_mfma_f32_16x16x32_bf16 v[64:67], v[144:147], v[164:167], v[64:67]
    v_mfma_f32_16x16x32_bf16 v[68:71], v[132:135], v[160:163], v[68:71]
    v_mfma_f32_16x16x32_bf16 v[68:71], v[148:151], v[164:167], v[68:71]
    s_waitcnt lgkmcnt(14)
    v_mfma_f32_16x16x32_bf16 v[72:75], v[136:139], v[160:163], v[72:75]
    v_mfma_f32_16x16x32_bf16 v[72:75], v[152:155], v[164:167], v[72:75]
    s_waitcnt lgkmcnt(12)
    v_mfma_f32_16x16x32_bf16 v[76:79], v[140:143], v[160:163], v[76:79]
    v_mfma_f32_16x16x32_bf16 v[76:79], v[156:159], v[164:167], v[76:79]
    s_waitcnt lgkmcnt(0)
    s_barrier
    v_mfma_f32_16x16x32_bf16 v[80:83], v[128:131], v[168:171], v[80:83]
    v_add_u32 v9, 65536, v9
    ds_read_b64_tr_b16 v[224:225], v9 offset:0
    v_mfma_f32_16x16x32_bf16 v[80:83], v[144:147], v[172:175], v[80:83]
    ds_read_b64_tr_b16 v[226:227], v9 offset:1024
    v_mfma_f32_16x16x32_bf16 v[84:87], v[132:135], v[168:171], v[84:87]
    ds_read_b64_tr_b16 v[228:229], v9 offset:8192
    v_mfma_f32_16x16x32_bf16 v[84:87], v[148:151], v[172:175], v[84:87]
    ds_read_b64_tr_b16 v[230:231], v9 offset:9216
    v_mfma_f32_16x16x32_bf16 v[88:91], v[136:139], v[168:171], v[88:91]
    v_add_u32 v7, 65536, v7
    ds_read_b128 v[192:195], v7 offset:0
    v_mfma_f32_16x16x32_bf16 v[88:91], v[152:155], v[172:175], v[88:91]
    v_add_u32 v8, 65536, v8
    ds_read_b128 v[208:211], v8 offset:0
    v_mfma_f32_16x16x32_bf16 v[92:95], v[140:143], v[168:171], v[92:95]
    ds_read_b128 v[196:199], v7 offset:2048
    v_mfma_f32_16x16x32_bf16 v[92:95], v[156:159], v[172:175], v[92:95]
    ds_read_b128 v[212:215], v8 offset:2048
    v_mfma_f32_16x16x32_bf16 v[96:99], v[128:131], v[176:179], v[96:99]
    ds_read_b128 v[200:203], v7 offset:4096
    v_mfma_f32_16x16x32_bf16 v[96:99], v[144:147], v[180:183], v[96:99]
    ds_read_b128 v[216:219], v8 offset:4096
    v_mfma_f32_16x16x32_bf16 v[100:103], v[132:135], v[176:179], v[100:103]
    ds_read_b128 v[204:207], v7 offset:6144
    v_mfma_f32_16x16x32_bf16 v[100:103], v[148:151], v[180:183], v[100:103]
    ds_read_b128 v[220:223], v8 offset:6144
    v_mfma_f32_16x16x32_bf16 v[104:107], v[136:139], v[176:179], v[104:107]
    v_add_u32 v10, 65536, v10
    ds_read_b64_tr_b16 v[232:233], v10 offset:0
    v_mfma_f32_16x16x32_bf16 v[104:107], v[152:155], v[180:183], v[104:107]
    ds_read_b64_tr_b16 v[234:235], v10 offset:1024
    v_mfma_f32_16x16x32_bf16 v[108:111], v[140:143], v[176:179], v[108:111]
    ds_read_b64_tr_b16 v[236:237], v10 offset:8192
    v_mfma_f32_16x16x32_bf16 v[108:111], v[156:159], v[180:183], v[108:111]
    ds_read_b64_tr_b16 v[238:239], v10 offset:9216
    v_mfma_f32_16x16x32_bf16 v[112:115], v[128:131], v[184:187], v[112:115]
    v_add_u32 v11, 65536, v11
    ds_read_b64_tr_b16 v[240:241], v11 offset:0
    v_mfma_f32_16x16x32_bf16 v[112:115], v[144:147], v[188:191], v[112:115]
    ds_read_b64_tr_b16 v[242:243], v11 offset:1024
    v_mfma_f32_16x16x32_bf16 v[116:119], v[132:135], v[184:187], v[116:119]
    ds_read_b64_tr_b16 v[244:245], v11 offset:8192
    v_mfma_f32_16x16x32_bf16 v[116:119], v[148:151], v[188:191], v[116:119]
    ds_read_b64_tr_b16 v[246:247], v11 offset:9216
    v_mfma_f32_16x16x32_bf16 v[120:123], v[136:139], v[184:187], v[120:123]
    v_add_u32 v12, 65536, v12
    ds_read_b64_tr_b16 v[248:249], v12 offset:0
    v_mfma_f32_16x16x32_bf16 v[120:123], v[152:155], v[188:191], v[120:123]
    ds_read_b64_tr_b16 v[250:251], v12 offset:1024
    v_mfma_f32_16x16x32_bf16 v[124:127], v[140:143], v[184:187], v[124:127]
    ds_read_b64_tr_b16 v[252:253], v12 offset:8192
    v_mfma_f32_16x16x32_bf16 v[124:127], v[156:159], v[188:191], v[124:127]
    ds_read_b64_tr_b16 v[254:255], v12 offset:9216
    s_waitcnt lgkmcnt(15)
    v_mfma_f32_16x16x32_bf16 v[64:67], v[192:195], v[224:227], v[64:67]
    v_mfma_f32_16x16x32_bf16 v[64:67], v[208:211], v[228:231], v[64:67]
    v_mfma_f32_16x16x32_bf16 v[68:71], v[196:199], v[224:227], v[68:71]
    v_mfma_f32_16x16x32_bf16 v[68:71], v[212:215], v[228:231], v[68:71]
    s_waitcnt lgkmcnt(14)
    v_mfma_f32_16x16x32_bf16 v[72:75], v[200:203], v[224:227], v[72:75]
    v_mfma_f32_16x16x32_bf16 v[72:75], v[216:219], v[228:231], v[72:75]
    s_waitcnt lgkmcnt(12)
    v_mfma_f32_16x16x32_bf16 v[76:79], v[204:207], v[224:227], v[76:79]
    v_mfma_f32_16x16x32_bf16 v[76:79], v[220:223], v[228:231], v[76:79]
    s_waitcnt lgkmcnt(0)
    s_barrier
    v_mfma_f32_16x16x32_bf16 v[80:83], v[192:195], v[232:235], v[80:83]
    ds_read_b64_tr_b16 v[160:161], v9 offset:32768
    v_mfma_f32_16x16x32_bf16 v[80:83], v[208:211], v[236:239], v[80:83]
    ds_read_b64_tr_b16 v[162:163], v9 offset:33792
    v_mfma_f32_16x16x32_bf16 v[84:87], v[196:199], v[232:235], v[84:87]
    ds_read_b64_tr_b16 v[164:165], v9 offset:40960
    v_mfma_f32_16x16x32_bf16 v[84:87], v[212:215], v[236:239], v[84:87]
    ds_read_b64_tr_b16 v[166:167], v9 offset:41984
    v_mfma_f32_16x16x32_bf16 v[88:91], v[200:203], v[232:235], v[88:91]
    ds_read_b128 v[128:131], v7 offset:32768
    v_mfma_f32_16x16x32_bf16 v[88:91], v[216:219], v[236:239], v[88:91]
    ds_read_b128 v[144:147], v8 offset:32768
    v_mfma_f32_16x16x32_bf16 v[92:95], v[204:207], v[232:235], v[92:95]
    ds_read_b128 v[132:135], v7 offset:34816
    v_mfma_f32_16x16x32_bf16 v[92:95], v[220:223], v[236:239], v[92:95]
    ds_read_b128 v[148:151], v8 offset:34816
    v_mfma_f32_16x16x32_bf16 v[96:99], v[192:195], v[240:243], v[96:99]
    ds_read_b128 v[136:139], v7 offset:36864
    v_mfma_f32_16x16x32_bf16 v[96:99], v[208:211], v[244:247], v[96:99]
    ds_read_b128 v[152:155], v8 offset:36864
    v_mfma_f32_16x16x32_bf16 v[100:103], v[196:199], v[240:243], v[100:103]
    ds_read_b128 v[140:143], v7 offset:38912
    v_mfma_f32_16x16x32_bf16 v[100:103], v[212:215], v[244:247], v[100:103]
    ds_read_b128 v[156:159], v8 offset:38912
    v_mfma_f32_16x16x32_bf16 v[104:107], v[200:203], v[240:243], v[104:107]
    ds_read_b64_tr_b16 v[168:169], v10 offset:32768
    v_mfma_f32_16x16x32_bf16 v[104:107], v[216:219], v[244:247], v[104:107]
    ds_read_b64_tr_b16 v[170:171], v10 offset:33792
    v_mfma_f32_16x16x32_bf16 v[108:111], v[204:207], v[240:243], v[108:111]
    ds_read_b64_tr_b16 v[172:173], v10 offset:40960
    v_mfma_f32_16x16x32_bf16 v[108:111], v[220:223], v[244:247], v[108:111]
    ds_read_b64_tr_b16 v[174:175], v10 offset:41984
    v_mfma_f32_16x16x32_bf16 v[112:115], v[192:195], v[248:251], v[112:115]
    ds_read_b64_tr_b16 v[176:177], v11 offset:32768
    v_mfma_f32_16x16x32_bf16 v[112:115], v[208:211], v[252:255], v[112:115]
    ds_read_b64_tr_b16 v[178:179], v11 offset:33792
    v_mfma_f32_16x16x32_bf16 v[116:119], v[196:199], v[248:251], v[116:119]
    ds_read_b64_tr_b16 v[180:181], v11 offset:40960
    v_mfma_f32_16x16x32_bf16 v[116:119], v[212:215], v[252:255], v[116:119]
    ds_read_b64_tr_b16 v[182:183], v11 offset:41984
    v_mfma_f32_16x16x32_bf16 v[120:123], v[200:203], v[248:251], v[120:123]
    ds_read_b64_tr_b16 v[184:185], v12 offset:32768
    v_mfma_f32_16x16x32_bf16 v[120:123], v[216:219], v[252:255], v[120:123]
    ds_read_b64_tr_b16 v[186:187], v12 offset:33792
    v_mfma_f32_16x16x32_bf16 v[124:127], v[204:207], v[248:251], v[124:127]
    ds_read_b64_tr_b16 v[188:189], v12 offset:40960
    v_mfma_f32_16x16x32_bf16 v[124:127], v[220:223], v[252:255], v[124:127]
    ds_read_b64_tr_b16 v[190:191], v12 offset:41984
    s_waitcnt lgkmcnt(15)
    v_mfma_f32_16x16x32_bf16 v[64:67], v[128:131], v[160:163], v[64:67]
    v_mfma_f32_16x16x32_bf16 v[64:67], v[144:147], v[164:167], v[64:67]
    v_mfma_f32_16x16x32_bf16 v[68:71], v[132:135], v[160:163], v[68:71]
    v_mfma_f32_16x16x32_bf16 v[68:71], v[148:151], v[164:167], v[68:71]
    s_waitcnt lgkmcnt(14)
    v_mfma_f32_16x16x32_bf16 v[72:75], v[136:139], v[160:163], v[72:75]
    v_mfma_f32_16x16x32_bf16 v[72:75], v[152:155], v[164:167], v[72:75]
    s_waitcnt lgkmcnt(12)
    v_mfma_f32_16x16x32_bf16 v[76:79], v[140:143], v[160:163], v[76:79]
    v_mfma_f32_16x16x32_bf16 v[76:79], v[156:159], v[164:167], v[76:79]
    s_waitcnt lgkmcnt(0)
    s_barrier
    v_mfma_f32_16x16x32_bf16 v[80:83], v[128:131], v[168:171], v[80:83]
    v_add_u32 v9, 16384, v9
    ds_read_b64_tr_b16 v[224:225], v9 offset:49152
    v_mfma_f32_16x16x32_bf16 v[80:83], v[144:147], v[172:175], v[80:83]
    ds_read_b64_tr_b16 v[226:227], v9 offset:50176
    v_mfma_f32_16x16x32_bf16 v[84:87], v[132:135], v[168:171], v[84:87]
    ds_read_b64_tr_b16 v[228:229], v9 offset:57344
    v_mfma_f32_16x16x32_bf16 v[84:87], v[148:151], v[172:175], v[84:87]
    ds_read_b64_tr_b16 v[230:231], v9 offset:58368
    v_mfma_f32_16x16x32_bf16 v[88:91], v[136:139], v[168:171], v[88:91]
    v_add_u32 v7, 32768, v7
    ds_read_b128 v[192:195], v7 offset:32768
    v_mfma_f32_16x16x32_bf16 v[88:91], v[152:155], v[172:175], v[88:91]
    v_add_u32 v8, 32768, v8
    ds_read_b128 v[208:211], v8 offset:32768
    v_mfma_f32_16x16x32_bf16 v[92:95], v[140:143], v[168:171], v[92:95]
    ds_read_b128 v[196:199], v7 offset:34816
    v_mfma_f32_16x16x32_bf16 v[92:95], v[156:159], v[172:175], v[92:95]
    ds_read_b128 v[212:215], v8 offset:34816
    v_mfma_f32_16x16x32_bf16 v[96:99], v[128:131], v[176:179], v[96:99]
    ds_read_b128 v[200:203], v7 offset:36864
    v_mfma_f32_16x16x32_bf16 v[96:99], v[144:147], v[180:183], v[96:99]
    ds_read_b128 v[216:219], v8 offset:36864
    v_mfma_f32_16x16x32_bf16 v[100:103], v[132:135], v[176:179], v[100:103]
    ds_read_b128 v[204:207], v7 offset:38912
    v_mfma_f32_16x16x32_bf16 v[100:103], v[148:151], v[180:183], v[100:103]
    ds_read_b128 v[220:223], v8 offset:38912
    v_mfma_f32_16x16x32_bf16 v[104:107], v[136:139], v[176:179], v[104:107]
    v_add_u32 v10, 16384, v10
    ds_read_b64_tr_b16 v[232:233], v10 offset:49152
    v_mfma_f32_16x16x32_bf16 v[104:107], v[152:155], v[180:183], v[104:107]
    ds_read_b64_tr_b16 v[234:235], v10 offset:50176
    v_mfma_f32_16x16x32_bf16 v[108:111], v[140:143], v[176:179], v[108:111]
    ds_read_b64_tr_b16 v[236:237], v10 offset:57344
    v_mfma_f32_16x16x32_bf16 v[108:111], v[156:159], v[180:183], v[108:111]
    ds_read_b64_tr_b16 v[238:239], v10 offset:58368
    v_mfma_f32_16x16x32_bf16 v[112:115], v[128:131], v[184:187], v[112:115]
    v_add_u32 v11, 16384, v11
    ds_read_b64_tr_b16 v[240:241], v11 offset:49152
    v_mfma_f32_16x16x32_bf16 v[112:115], v[144:147], v[188:191], v[112:115]
    ds_read_b64_tr_b16 v[242:243], v11 offset:50176
    v_mfma_f32_16x16x32_bf16 v[116:119], v[132:135], v[184:187], v[116:119]
    ds_read_b64_tr_b16 v[244:245], v11 offset:57344
    v_mfma_f32_16x16x32_bf16 v[116:119], v[148:151], v[188:191], v[116:119]
    ds_read_b64_tr_b16 v[246:247], v11 offset:58368
    v_mfma_f32_16x16x32_bf16 v[120:123], v[136:139], v[184:187], v[120:123]
    v_add_u32 v12, 16384, v12
    ds_read_b64_tr_b16 v[248:249], v12 offset:49152
    v_mfma_f32_16x16x32_bf16 v[120:123], v[152:155], v[188:191], v[120:123]
    ds_read_b64_tr_b16 v[250:251], v12 offset:50176
    v_mfma_f32_16x16x32_bf16 v[124:127], v[140:143], v[184:187], v[124:127]
    ds_read_b64_tr_b16 v[252:253], v12 offset:57344
    v_mfma_f32_16x16x32_bf16 v[124:127], v[156:159], v[188:191], v[124:127]
    ds_read_b64_tr_b16 v[254:255], v12 offset:58368
    s_waitcnt lgkmcnt(15)
    v_mfma_f32_16x16x32_bf16 v[64:67], v[192:195], v[224:227], v[64:67]
    v_mfma_f32_16x16x32_bf16 v[64:67], v[208:211], v[228:231], v[64:67]
    v_mfma_f32_16x16x32_bf16 v[68:71], v[196:199], v[224:227], v[68:71]
    v_mfma_f32_16x16x32_bf16 v[68:71], v[212:215], v[228:231], v[68:71]
    s_waitcnt lgkmcnt(14)
    v_mfma_f32_16x16x32_bf16 v[72:75], v[200:203], v[224:227], v[72:75]
    v_mfma_f32_16x16x32_bf16 v[72:75], v[216:219], v[228:231], v[72:75]
    s_waitcnt lgkmcnt(12)
    v_mfma_f32_16x16x32_bf16 v[76:79], v[204:207], v[224:227], v[76:79]
    v_mfma_f32_16x16x32_bf16 v[76:79], v[220:223], v[228:231], v[76:79]
    v_cvt_pk_bf16_f32 v64, v64, v65
    v_cvt_pk_bf16_f32 v65, v66, v67
    v_cvt_pk_bf16_f32 v66, v68, v69
    s_waitcnt lgkmcnt(8)
    v_mfma_f32_16x16x32_bf16 v[80:83], v[192:195], v[232:235], v[80:83]
    v_cvt_pk_bf16_f32 v67, v70, v71
    v_cvt_pk_bf16_f32 v72, v72, v73
    v_cvt_pk_bf16_f32 v73, v74, v75
    v_mfma_f32_16x16x32_bf16 v[80:83], v[208:211], v[236:239], v[80:83]
    v_cvt_pk_bf16_f32 v74, v76, v77
    v_cvt_pk_bf16_f32 v75, v78, v79
    v_mfma_f32_16x16x32_bf16 v[84:87], v[196:199], v[232:235], v[84:87]
    v_mfma_f32_16x16x32_bf16 v[84:87], v[212:215], v[236:239], v[84:87]
    v_mfma_f32_16x16x32_bf16 v[88:91], v[200:203], v[232:235], v[88:91]
    v_mfma_f32_16x16x32_bf16 v[88:91], v[216:219], v[236:239], v[88:91]
    v_mfma_f32_16x16x32_bf16 v[92:95], v[204:207], v[232:235], v[92:95]
    v_mfma_f32_16x16x32_bf16 v[92:95], v[220:223], v[236:239], v[92:95]
    v_cvt_pk_bf16_f32 v80, v80, v81
    v_cvt_pk_bf16_f32 v81, v82, v83
    s_waitcnt lgkmcnt(4)
    v_mfma_f32_16x16x32_bf16 v[96:99], v[192:195], v[240:243], v[96:99]
    v_cvt_pk_bf16_f32 v82, v84, v85
    v_cvt_pk_bf16_f32 v83, v86, v87
    v_cvt_pk_bf16_f32 v88, v88, v89
    v_mfma_f32_16x16x32_bf16 v[96:99], v[208:211], v[244:247], v[96:99]
    v_cvt_pk_bf16_f32 v89, v90, v91
    v_cvt_pk_bf16_f32 v90, v92, v93
    v_cvt_pk_bf16_f32 v91, v94, v95
    v_mfma_f32_16x16x32_bf16 v[100:103], v[196:199], v[240:243], v[100:103]
    v_mfma_f32_16x16x32_bf16 v[100:103], v[212:215], v[244:247], v[100:103]
    v_mfma_f32_16x16x32_bf16 v[104:107], v[200:203], v[240:243], v[104:107]
    v_mfma_f32_16x16x32_bf16 v[104:107], v[216:219], v[244:247], v[104:107]
    v_mfma_f32_16x16x32_bf16 v[108:111], v[204:207], v[240:243], v[108:111]
    v_cvt_pk_bf16_f32 v96, v96, v97
    v_cvt_pk_bf16_f32 v97, v98, v99
    v_mfma_f32_16x16x32_bf16 v[108:111], v[220:223], v[244:247], v[108:111]
    s_waitcnt lgkmcnt(0)
    v_mfma_f32_16x16x32_bf16 v[112:115], v[192:195], v[248:251], v[112:115]
    v_cvt_pk_bf16_f32 v98, v100, v101
    v_cvt_pk_bf16_f32 v99, v102, v103
    v_cvt_pk_bf16_f32 v104, v104, v105
    v_mfma_f32_16x16x32_bf16 v[112:115], v[208:211], v[252:255], v[112:115]
    v_cvt_pk_bf16_f32 v105, v106, v107
    v_mfma_f32_16x16x32_bf16 v[116:119], v[196:199], v[248:251], v[116:119]
    v_cvt_pk_bf16_f32 v106, v108, v109
    v_cvt_pk_bf16_f32 v107, v110, v111
    v_mfma_f32_16x16x32_bf16 v[116:119], v[212:215], v[252:255], v[116:119]
    v_mfma_f32_16x16x32_bf16 v[120:123], v[200:203], v[248:251], v[120:123]
    v_mfma_f32_16x16x32_bf16 v[120:123], v[216:219], v[252:255], v[120:123]
    v_mfma_f32_16x16x32_bf16 v[124:127], v[204:207], v[248:251], v[124:127]
    v_cvt_pk_bf16_f32 v112, v112, v113
    v_cvt_pk_bf16_f32 v113, v114, v115
    v_mfma_f32_16x16x32_bf16 v[124:127], v[220:223], v[252:255], v[124:127]
    s_barrier
    s_add_u32 m0, s56, 65536
    s_add_u32 s57, s72, 0
    buffer_load_dwordx4 v6, s[16:19], s57 offen  lds
    s_add_u32 m0, s56, 69632
    s_add_u32 s57, s72, 55296
    buffer_load_dwordx4 v6, s[16:19], s57 offen  lds
    s_add_u32 m0, s56, 73728
    s_add_u32 s57, s72, 110592
    buffer_load_dwordx4 v6, s[16:19], s57 offen  lds
    s_add_u32 m0, s56, 77824
    s_add_u32 s57, s72, 165888
    buffer_load_dwordx4 v6, s[16:19], s57 offen  lds
    s_bfe_u32 s72, s94, 262164
    s_mul_i32 s72, s72, 221184
    s_add_u32 m0, s56, 81920
    s_add_u32 s57, s72, 0
    buffer_load_dwordx4 v6, s[16:19], s57 offen  lds
    s_add_u32 m0, s56, 86016
    s_add_u32 s57, s72, 55296
    buffer_load_dwordx4 v6, s[16:19], s57 offen  lds
    s_add_u32 m0, s56, 90112
    s_add_u32 s57, s72, 110592
    buffer_load_dwordx4 v6, s[16:19], s57 offen  lds
    s_add_u32 m0, s56, 94208
    s_add_u32 s57, s72, 165888
    buffer_load_dwordx4 v6, s[16:19], s57 offen  lds
    s_bfe_u32 s72, s94, 262168
    s_mul_i32 s72, s72, 221184
    v_cvt_pk_bf16_f32 v114, v116, v117
    v_cvt_pk_bf16_f32 v115, v118, v119
    v_cvt_pk_bf16_f32 v120, v120, v121
    v_cvt_pk_bf16_f32 v121, v122, v123
    v_cvt_pk_bf16_f32 v122, v124, v125
    v_cvt_pk_bf16_f32 v123, v126, v127
    s_barrier
    buffer_store_dwordx4 v[64:67], v13, s[20:23], 0 offen sc1
    buffer_store_dwordx4 v[72:75], v13, s[20:23], s75 offen sc1
    buffer_store_dwordx4 v[80:83], v14, s[20:23], 0 offen sc1
    buffer_store_dwordx4 v[88:91], v14, s[20:23], s75 offen sc1
    buffer_store_dwordx4 v[96:99], v15, s[20:23], 0 offen sc1
    buffer_store_dwordx4 v[104:107], v15, s[20:23], s75 offen sc1
    buffer_store_dwordx4 v[112:115], v16, s[20:23], 0 offen sc1
    buffer_store_dwordx4 v[120:123], v16, s[20:23], s75 offen sc1
    v_and_b32 v2, 15, v0
    v_lshlrev_b32 v2, 2, v2
    buffer_load_dword v3, v2, s[48:51], 0 offen sc1
    s_add_u32 m0, s56, 98304
    s_add_u32 s57, s72, 0
    buffer_load_dwordx4 v6, s[16:19], s57 offen  lds
    s_add_u32 m0, s56, 102400
    s_add_u32 s57, s72, 55296
    buffer_load_dwordx4 v6, s[16:19], s57 offen  lds
    s_add_u32 m0, s56, 106496
    s_add_u32 s57, s72, 110592
    buffer_load_dwordx4 v6, s[16:19], s57 offen  lds
    s_add_u32 m0, s56, 110592
    s_add_u32 s57, s72, 165888
    buffer_load_dwordx4 v6, s[16:19], s57 offen  lds
    s_bfe_u32 s72, s94, 262172
    s_mul_i32 s72, s72, 221184
    s_waitcnt vmcnt(13)
    s_barrier
    s_add_u32 m0, s56, 114688
    s_add_u32 s57, s72, 0
    buffer_load_dwordx4 v6, s[16:19], s57 offen  lds
    s_add_u32 m0, s56, 118784
    s_add_u32 s57, s72, 55296
    buffer_load_dwordx4 v6, s[16:19], s57 offen  lds
    s_add_u32 m0, s56, 122880
    s_add_u32 s57, s72, 110592
    buffer_load_dwordx4 v6, s[16:19], s57 offen  lds
    s_add_u32 m0, s56, 126976
    s_add_u32 s57, s72, 165888
    buffer_load_dwordx4 v6, s[16:19], s57 offen  lds
    s_bfe_u32 s72, s95, 262144
    s_mul_i32 s72, s72, 221184
    s_waitcnt vmcnt(8)
    v_cmp_ne_u32 vcc, 1, v3
    s_cbranch_vccz Lclean_8
    s_mov_b32 s64, 524288
Lpoll_9:
    buffer_load_dword v3, v2, s[48:51], 0 offen sc1
    s_sub_u32 s64, s64, 1
    s_cbranch_scc1 Lpolld_10
    s_waitcnt vmcnt(0)
    v_cmp_ne_u32 vcc, 1, v3
    s_cbranch_vccz Lpolld_10
    s_branch Lpoll_9
Lpolld_10:
    s_waitcnt vmcnt(0)
Lclean_8:
    s_mov_b32 s58, s66
    v_mov_b32 v2, 0
    v_mov_b32 v3, 1
    s_mov_b64 exec, 1
    buffer_store_dword v3, v2, s[20:23], s58 offen sc1
    s_mov_b64 exec, -1
    s_waitcnt vmcnt(1)
    s_barrier
    s_add_u32 m0, s56, 131072
    s_add_u32 s57, s72, 0
    buffer_load_dwordx4 v6, s[16:19], s57 offen  lds
    s_add_u32 m0, s56, 135168
    s_add_u32 s57, s72, 55296
    buffer_load_dwordx4 v6, s[16:19], s57 offen  lds
    s_add_u32 m0, s56, 139264
    s_add_u32 s57, s72, 110592
    buffer_load_dwordx4 v6, s[16:19], s57 offen  lds
    s_add_u32 m0, s56, 143360
    s_add_u32 s57, s72, 165888
    buffer_load_dwordx4 v6, s[16:19], s57 offen  lds
    s_bfe_u32 s72, s95, 262148
    s_mul_i32 s72, s72, 221184
    s_add_u32 m0, s56, 147456
    s_add_u32 s57, s72, 0
    buffer_load_dwordx4 v6, s[16:19], s57 offen  lds
    s_add_u32 m0, s56, 151552
    s_add_u32 s57, s72, 55296
    buffer_load_dwordx4 v6, s[16:19], s57 offen  lds
    s_add_u32 m0, s56, 155648
    s_add_u32 s57, s72, 110592
    buffer_load_dwordx4 v6, s[16:19], s57 offen  lds
    s_add_u32 m0, s56, 159744
    s_add_u32 s57, s72, 165888
    buffer_load_dwordx4 v6, s[16:19], s57 offen  lds
    s_branch Lattn0
Lpb:
    s_waitcnt vmcnt(12) lgkmcnt(0)
    s_barrier
    s_setprio 2
    s_cmp_ge_u32 s5, 14
    s_cbranch_scc1 Lgatez
    s_cmp_lg_u32 0, 0
    ds_read_b64_tr_b16 v[12:13], v1 offset:0
    ds_read_b64_tr_b16 v[14:15], v1 offset:1024
    ds_read_b64_tr_b16 v[16:17], v1 offset:8192
    ds_read_b64_tr_b16 v[18:19], v1 offset:9216
    ds_read_b64_tr_b16 v[20:21], v2 offset:0
    ds_read_b64_tr_b16 v[22:23], v2 offset:1024
    ds_read_b64_tr_b16 v[24:25], v2 offset:8192
    ds_read_b64_tr_b16 v[26:27], v2 offset:9216
    ds_read_b64_tr_b16 v[28:29], v4 offset:0
    ds_read_b64_tr_b16 v[30:31], v4 offset:1024
    s_waitcnt lgkmcnt(6)
    v_mfma_f32_16x16x32_bf16 v[40:43], v[12:15], v[132:135], v[32:35]
    v_mfma_f32_16x16x32_bf16 v[40:43], v[16:19], v[140:143], v[40:43]
    v_mfma_f32_16x16x32_bf16 v[32:35], v[12:15], v[128:131], v[32:35]
    ds_read_b64_tr_b16 v[12:13], v4 offset:8192
    ds_read_b64_tr_b16 v[14:15], v4 offset:9216
    v_mfma_f32_16x16x32_bf16 v[32:35], v[16:19], v[136:139], v[32:35]
    ds_read_b64_tr_b16 v[16:17], v5 offset:0
    ds_read_b64_tr_b16 v[18:19], v5 offset:1024
    s_waitcnt lgkmcnt(6)
    v_mfma_f32_16x16x32_bf16 v[44:47], v[20:23], v[132:135], v[36:39]
    v_mfma_f32_16x16x32_bf16 v[44:47], v[24:27], v[140:143], v[44:47]
    v_mfma_f32_16x16x32_bf16 v[36:39], v[20:23], v[128:131], v[36:39]
    ds_read_b64_tr_b16 v[20:21], v5 offset:8192
    ds_read_b64_tr_b16 v[22:23], v5 offset:9216
    v_mfma_f32_16x16x32_bf16 v[36:39], v[24:27], v[136:139], v[36:39]
    ds_read_b64_tr_b16 v[24:25], v7 offset:0
    ds_read_b64_tr_b16 v[26:27], v7 offset:1024
    s_waitcnt lgkmcnt(6)
    v_mfma_f32_16x16x32_bf16 v[56:59], v[28:31], v[132:135], v[48:51]
    v_mfma_f32_16x16x32_bf16 v[56:59], v[12:15], v[140:143], v[56:59]
    v_mfma_f32_16x16x32_bf16 v[48:51], v[28:31], v[128:131], v[48:51]
    ds_read_b64_tr_b16 v[28:29], v7 offset:8192
    ds_read_b64_tr_b16 v[30:31], v7 offset:9216
    v_mfma_f32_16x16x32_bf16 v[48:51], v[12:15], v[136:139], v[48:51]
    ds_read_b64_tr_b16 v[12:13], v8 offset:0
    ds_read_b64_tr_b16 v[14:15], v8 offset:1024
    s_waitcnt lgkmcnt(6)
    v_mfma_f32_16x16x32_bf16 v[60:63], v[16:19], v[132:135], v[52:55]
    v_mfma_f32_16x16x32_bf16 v[60:63], v[20:23], v[140:143], v[60:63]
    v_mfma_f32_16x16x32_bf16 v[52:55], v[16:19], v[128:131], v[52:55]
    ds_read_b64_tr_b16 v[16:17], v8 offset:8192
    ds_read_b64_tr_b16 v[18:19], v8 offset:9216
    v_mfma_f32_16x16x32_bf16 v[52:55], v[20:23], v[136:139], v[52:55]
    ds_read_b64_tr_b16 v[20:21], v9 offset:0
    ds_read_b64_tr_b16 v[22:23], v9 offset:1024
    s_waitcnt lgkmcnt(6)
    v_mfma_f32_16x16x32_bf16 v[72:75], v[24:27], v[132:135], v[64:67]
    v_mfma_f32_16x16x32_bf16 v[72:75], v[28:31], v[140:143], v[72:75]
    v_mfma_f32_16x16x32_bf16 v[64:67], v[24:27], v[128:131], v[64:67]
    ds_read_b64_tr_b16 v[24:25], v9 offset:8192
    ds_read_b64_tr_b16 v[26:27], v9 offset:9216
    v_mfma_f32_16x16x32_bf16 v[64:67], v[28:31], v[136:139], v[64:67]
    ds_read_b64_tr_b16 v[28:29], v10 offset:0
    ds_read_b64_tr_b16 v[30:31], v10 offset:1024
    s_waitcnt lgkmcnt(6)
    v_mfma_f32_16x16x32_bf16 v[76:79], v[12:15], v[132:135], v[68:71]
    v_mfma_f32_16x16x32_bf16 v[76:79], v[16:19], v[140:143], v[76:79]
    v_mfma_f32_16x16x32_bf16 v[68:71], v[12:15], v[128:131], v[68:71]
    ds_read_b64_tr_b16 v[12:13], v10 offset:8192
    ds_read_b64_tr_b16 v[14:15], v10 offset:9216
    v_mfma_f32_16x16x32_bf16 v[68:71], v[16:19], v[136:139], v[68:71]
    s_waitcnt vmcnt(0)
    s_barrier
    ds_read_b64_tr_b16 v[16:17], v1 offset:16384
    ds_read_b64_tr_b16 v[18:19], v1 offset:17408
    s_waitcnt lgkmcnt(6)
    v_mfma_f32_16x16x32_bf16 v[88:91], v[20:23], v[132:135], v[80:83]
    v_mfma_f32_16x16x32_bf16 v[88:91], v[24:27], v[140:143], v[88:91]
    v_mfma_f32_16x16x32_bf16 v[80:83], v[20:23], v[128:131], v[80:83]
    ds_read_b64_tr_b16 v[20:21], v1 offset:24576
    ds_read_b64_tr_b16 v[22:23], v1 offset:25600
    v_mfma_f32_16x16x32_bf16 v[80:83], v[24:27], v[136:139], v[80:83]
    ds_read_b64_tr_b16 v[24:25], v2 offset:16384
    ds_read_b64_tr_b16 v[26:27], v2 offset:17408
    s_waitcnt lgkmcnt(6)
    v_mfma_f32_16x16x32_bf16 v[92:95], v[28:31], v[132:135], v[84:87]
    v_mfma_f32_16x16x32_bf16 v[92:95], v[12:15], v[140:143], v[92:95]
    v_mfma_f32_16x16x32_bf16 v[84:87], v[28:31], v[128:131], v[84:87]
    ds_read_b64_tr_b16 v[28:29], v2 offset:24576
    ds_read_b64_tr_b16 v[30:31], v2 offset:25600
    v_mfma_f32_16x16x32_bf16 v[84:87], v[12:15], v[136:139], v[84:87]
    ds_read_b64_tr_b16 v[12:13], v4 offset:16384
    ds_read_b64_tr_b16 v[14:15], v4 offset:17408
    s_waitcnt lgkmcnt(6)
    v_mfma_f32_16x16x32_bf16 v[40:43], v[16:19], v[148:151], v[40:43]
    ds_read_b64_tr_b16 v[128:129], v4 offset:24576
    v_mfma_f32_16x16x32_bf16 v[40:43], v[20:23], v[156:159], v[40:43]
    ds_read_b64_tr_b16 v[130:131], v4 offset:25600
    v_mfma_f32_16x16x32_bf16 v[32:35], v[16:19], v[144:147], v[32:35]
    ds_read_b64_tr_b16 v[132:133], v5 offset:16384
    v_mfma_f32_16x16x32_bf16 v[32:35], v[20:23], v[152:155], v[32:35]
    ds_read_b64_tr_b16 v[134:135], v5 offset:17408
    ds_read_b64_tr_b16 v[136:137], v5 offset:24576
    s_waitcnt lgkmcnt(7)
    v_mfma_f32_16x16x32_bf16 v[44:47], v[24:27], v[148:151], v[44:47]
    ds_read_b64_tr_b16 v[138:139], v5 offset:25600
    v_mfma_f32_16x16x32_bf16 v[44:47], v[28:31], v[156:159], v[44:47]
    ds_read_b64_tr_b16 v[140:141], v7 offset:16384
    v_mfma_f32_16x16x32_bf16 v[36:39], v[24:27], v[144:147], v[36:39]
    ds_read_b64_tr_b16 v[142:143], v7 offset:17408
    v_mfma_f32_16x16x32_bf16 v[36:39], v[28:31], v[152:155], v[36:39]
    ds_read_b64_tr_b16 v[16:17], v7 offset:24576
    s_waitcnt lgkmcnt(7)
    v_mfma_f32_16x16x32_bf16 v[56:59], v[12:15], v[148:151], v[56:59]
    ds_read_b64_tr_b16 v[18:19], v7 offset:25600
    v_mfma_f32_16x16x32_bf16 v[56:59], v[128:131], v[156:159], v[56:59]
    ds_read_b64_tr_b16 v[20:21], v8 offset:16384
    v_mfma_f32_16x16x32_bf16 v[48:51], v[12:15], v[144:147], v[48:51]
    ds_read_b64_tr_b16 v[22:23], v8 offset:17408
    v_mfma_f32_16x16x32_bf16 v[48:51], v[128:131], v[152:155], v[48:51]
    ds_read_b64_tr_b16 v[24:25], v8 offset:24576
    s_waitcnt lgkmcnt(7)
    v_mfma_f32_16x16x32_bf16 v[60:63], v[132:135], v[148:151], v[60:63]
    ds_read_b64_tr_b16 v[26:27], v8 offset:25600
    v_mfma_f32_16x16x32_bf16 v[60:63], v[136:139], v[156:159], v[60:63]
    ds_read_b64_tr_b16 v[28:29], v9 offset:16384
    v_mfma_f32_16x16x32_bf16 v[52:55], v[132:135], v[144:147], v[52:55]
    ds_read_b64_tr_b16 v[30:31], v9 offset:17408
    v_mfma_f32_16x16x32_bf16 v[52:55], v[136:139], v[152:155], v[52:55]
    ds_read_b64_tr_b16 v[12:13], v9 offset:24576
    s_waitcnt lgkmcnt(7)
    v_mfma_f32_16x16x32_bf16 v[72:75], v[140:143], v[148:151], v[72:75]
    ds_read_b64_tr_b16 v[14:15], v9 offset:25600
    v_mfma_f32_16x16x32_bf16 v[72:75], v[16:19], v[156:159], v[72:75]
    ds_read_b64_tr_b16 v[128:129], v10 offset:16384
    v_mfma_f32_16x16x32_bf16 v[64:67], v[140:143], v[144:147], v[64:67]
    ds_read_b64_tr_b16 v[130:131], v10 offset:17408
    v_mfma_f32_16x16x32_bf16 v[64:67], v[16:19], v[152:155], v[64:67]
    ds_read_b64_tr_b16 v[132:133], v10 offset:24576
    s_waitcnt lgkmcnt(7)
    v_mfma_f32_16x16x32_bf16 v[76:79], v[20:23], v[148:151], v[76:79]
    ds_read_b64_tr_b16 v[134:135], v10 offset:25600
    v_mfma_f32_16x16x32_bf16 v[76:79], v[24:27], v[156:159], v[76:79]
    ds_read_b64_tr_b16 v[136:137], v1 offset:32768
    v_mfma_f32_16x16x32_bf16 v[68:71], v[20:23], v[144:147], v[68:71]
    ds_read_b64_tr_b16 v[138:139], v1 offset:33792
    v_mfma_f32_16x16x32_bf16 v[68:71], v[24:27], v[152:155], v[68:71]
    ds_read_b64_tr_b16 v[140:141], v1 offset:40960
    s_waitcnt lgkmcnt(7)
    v_mfma_f32_16x16x32_bf16 v[88:91], v[28:31], v[148:151], v[88:91]
    ds_read_b64_tr_b16 v[142:143], v1 offset:41984
    v_mfma_f32_16x16x32_bf16 v[88:91], v[12:15], v[156:159], v[88:91]
    ds_read_b64_tr_b16 v[16:17], v2 offset:32768
    v_mfma_f32_16x16x32_bf16 v[80:83], v[28:31], v[144:147], v[80:83]
    ds_read_b64_tr_b16 v[18:19], v2 offset:33792
    v_mfma_f32_16x16x32_bf16 v[80:83], v[12:15], v[152:155], v[80:83]
    ds_read_b64_tr_b16 v[20:21], v2 offset:40960
    s_waitcnt lgkmcnt(7)
    v_mfma_f32_16x16x32_bf16 v[92:95], v[128:131], v[148:151], v[92:95]
    ds_read_b64_tr_b16 v[22:23], v2 offset:41984
    v_mfma_f32_16x16x32_bf16 v[92:95], v[132:135], v[156:159], v[92:95]
    ds_read_b64_tr_b16 v[24:25], v4 offset:32768
    v_mfma_f32_16x16x32_bf16 v[84:87], v[128:131], v[144:147], v[84:87]
    ds_read_b64_tr_b16 v[26:27], v4 offset:33792
    v_mfma_f32_16x16x32_bf16 v[84:87], v[132:135], v[152:155], v[84:87]
    ds_read_b64_tr_b16 v[28:29], v4 offset:40960
    s_waitcnt lgkmcnt(7)
    v_mfma_f32_16x16x32_bf16 v[40:43], v[136:139], v[100:103], v[40:43]
    ds_read_b64_tr_b16 v[30:31], v4 offset:41984
    v_mfma_f32_16x16x32_bf16 v[40:43], v[140:143], v[108:111], v[40:43]
    ds_read_b64_tr_b16 v[12:13], v5 offset:32768
    v_mfma_f32_16x16x32_bf16 v[32:35], v[136:139], v[96:99], v[32:35]
    ds_read_b64_tr_b16 v[14:15], v5 offset:33792
    v_mfma_f32_16x16x32_bf16 v[32:35], v[140:143], v[104:107], v[32:35]
    ds_read_b64_tr_b16 v[128:129], v5 offset:40960
    s_waitcnt lgkmcnt(7)
    v_mfma_f32_16x16x32_bf16 v[44:47], v[16:19], v[100:103], v[44:47]
    ds_read_b64_tr_b16 v[130:131], v5 offset:41984
    v_mfma_f32_16x16x32_bf16 v[44:47], v[20:23], v[108:111], v[44:47]
    ds_read_b64_tr_b16 v[132:133], v7 offset:32768
    v_mfma_f32_16x16x32_bf16 v[36:39], v[16:19], v[96:99], v[36:39]
    ds_read_b64_tr_b16 v[134:135], v7 offset:33792
    v_mfma_f32_16x16x32_bf16 v[36:39], v[20:23], v[104:107], v[36:39]
    ds_read_b64_tr_b16 v[144:145], v7 offset:40960
    s_waitcnt lgkmcnt(7)
    v_mfma_f32_16x16x32_bf16 v[56:59], v[24:27], v[100:103], v[56:59]
    ds_read_b64_tr_b16 v[146:147], v7 offset:41984
    v_mfma_f32_16x16x32_bf16 v[56:59], v[28:31], v[108:111], v[56:59]
    ds_read_b64_tr_b16 v[148:149], v8 offset:32768
    v_mfma_f32_16x16x32_bf16 v[48:51], v[24:27], v[96:99], v[48:51]
    ds_read_b64_tr_b16 v[150:151], v8 offset:33792
    v_mfma_f32_16x16x32_bf16 v[48:51], v[28:31], v[104:107], v[48:51]
    ds_read_b64_tr_b16 v[152:153], v8 offset:40960
    s_waitcnt lgkmcnt(7)
    v_mfma_f32_16x16x32_bf16 v[60:63], v[12:15], v[100:103], v[60:63]
    ds_read_b64_tr_b16 v[154:155], v8 offset:41984
    v_mfma_f32_16x16x32_bf16 v[60:63], v[128:131], v[108:111], v[60:63]
    ds_read_b64_tr_b16 v[156:157], v9 offset:32768
    v_mfma_f32_16x16x32_bf16 v[52:55], v[12:15], v[96:99], v[52:55]
    ds_read_b64_tr_b16 v[158:159], v9 offset:33792
    v_mfma_f32_16x16x32_bf16 v[52:55], v[128:131], v[104:107], v[52:55]
    ds_read_b64_tr_b16 v[136:137], v9 offset:40960
    s_waitcnt lgkmcnt(7)
    v_mfma_f32_16x16x32_bf16 v[72:75], v[132:135], v[100:103], v[72:75]
    ds_read_b64_tr_b16 v[138:139], v9 offset:41984
    v_mfma_f32_16x16x32_bf16 v[72:75], v[144:147], v[108:111], v[72:75]
    ds_read_b64_tr_b16 v[140:141], v10 offset:32768
    v_mfma_f32_16x16x32_bf16 v[64:67], v[132:135], v[96:99], v[64:67]
    ds_read_b64_tr_b16 v[142:143], v10 offset:33792
    v_mfma_f32_16x16x32_bf16 v[64:67], v[144:147], v[104:107], v[64:67]
    ds_read_b64_tr_b16 v[16:17], v10 offset:40960
    s_waitcnt lgkmcnt(7)
    v_mfma_f32_16x16x32_bf16 v[76:79], v[148:151], v[100:103], v[76:79]
    ds_read_b64_tr_b16 v[18:19], v10 offset:41984
    v_mfma_f32_16x16x32_bf16 v[76:79], v[152:155], v[108:111], v[76:79]
    ds_read_b64_tr_b16 v[20:21], v1 offset:49152
    v_mfma_f32_16x16x32_bf16 v[68:71], v[148:151], v[96:99], v[68:71]
    ds_read_b64_tr_b16 v[22:23], v1 offset:50176
    v_mfma_f32_16x16x32_bf16 v[68:71], v[152:155], v[104:107], v[68:71]
    ds_read_b64_tr_b16 v[24:25], v1 offset:57344
    s_waitcnt lgkmcnt(7)
    v_mfma_f32_16x16x32_bf16 v[88:91], v[156:159], v[100:103], v[88:91]
    ds_read_b64_tr_b16 v[26:27], v1 offset:58368
    v_mfma_f32_16x16x32_bf16 v[88:91], v[136:139], v[108:111], v[88:91]
    ds_read_b64_tr_b16 v[28:29], v2 offset:49152
    v_mfma_f32_16x16x32_bf16 v[80:83], v[156:159], v[96:99], v[80:83]
    ds_read_b64_tr_b16 v[30:31], v2 offset:50176
    v_mfma_f32_16x16x32_bf16 v[80:83], v[136:139], v[104:107], v[80:83]
    ds_read_b64_tr_b16 v[12:13], v2 offset:57344
    s_waitcnt lgkmcnt(7)
    v_mfma_f32_16x16x32_bf16 v[92:95], v[140:143], v[100:103], v[92:95]
    ds_read_b64_tr_b16 v[14:15], v2 offset:58368
    v_mfma_f32_16x16x32_bf16 v[92:95], v[16:19], v[108:111], v[92:95]
    ds_read_b64_tr_b16 v[128:129], v4 offset:49152
    v_mfma_f32_16x16x32_bf16 v[84:87], v[140:143], v[96:99], v[84:87]
    ds_read_b64_tr_b16 v[130:131], v4 offset:50176
    v_mfma_f32_16x16x32_bf16 v[84:87], v[16:19], v[104:107], v[84:87]
    ds_read_b64_tr_b16 v[132:133], v4 offset:57344
    s_waitcnt lgkmcnt(7)
    v_mfma_f32_16x16x32_bf16 v[40:43], v[20:23], v[116:119], v[40:43]
    ds_read_b64_tr_b16 v[134:135], v4 offset:58368
    v_mfma_f32_16x16x32_bf16 v[40:43], v[24:27], v[124:127], v[40:43]
    ds_read_b64_tr_b16 v[144:145], v5 offset:49152
    v_mfma_f32_16x16x32_bf16 v[32:35], v[20:23], v[112:115], v[32:35]
    ds_read_b64_tr_b16 v[146:147], v5 offset:50176
    v_mfma_f32_16x16x32_bf16 v[32:35], v[24:27], v[120:123], v[32:35]
    ds_read_b64_tr_b16 v[148:149], v5 offset:57344
    s_waitcnt lgkmcnt(7)
    v_mfma_f32_16x16x32_bf16 v[44:47], v[28:31], v[116:119], v[44:47]
    ds_read_b64_tr_b16 v[150:151], v5 offset:58368
    v_mfma_f32_16x16x32_bf16 v[44:47], v[12:15], v[124:127], v[44:47]
    ds_read_b64_tr_b16 v[152:153], v7 offset:49152
    v_mfma_f32_16x16x32_bf16 v[36:39], v[28:31], v[112:115], v[36:39]
    ds_read_b64_tr_b16 v[154:155], v7 offset:50176
    v_mfma_f32_16x16x32_bf16 v[36:39], v[12:15], v[120:123], v[36:39]
    ds_read_b64_tr_b16 v[156:157], v7 offset:57344
    s_waitcnt lgkmcnt(7)
    v_mfma_f32_16x16x32_bf16 v[56:59], v[128:131], v[116:119], v[56:59]
    ds_read_b64_tr_b16 v[158:159], v7 offset:58368
    v_mfma_f32_16x16x32_bf16 v[56:59], v[132:135], v[124:127], v[56:59]
    ds_read_b64_tr_b16 v[136:137], v8 offset:49152
    v_mfma_f32_16x16x32_bf16 v[48:51], v[128:131], v[112:115], v[48:51]
    ds_read_b64_tr_b16 v[138:139], v8 offset:50176
    v_mfma_f32_16x16x32_bf16 v[48:51], v[132:135], v[120:123], v[48:51]
    ds_read_b64_tr_b16 v[140:141], v8 offset:57344
    s_waitcnt lgkmcnt(7)
    v_mfma_f32_16x16x32_bf16 v[60:63], v[144:147], v[116:119], v[60:63]
    ds_read_b64_tr_b16 v[142:143], v8 offset:58368
    v_mfma_f32_16x16x32_bf16 v[60:63], v[148:151], v[124:127], v[60:63]
    ds_read_b64_tr_b16 v[16:17], v9 offset:49152
    v_mfma_f32_16x16x32_bf16 v[52:55], v[144:147], v[112:115], v[52:55]
    ds_read_b64_tr_b16 v[18:19], v9 offset:50176
    v_mfma_f32_16x16x32_bf16 v[52:55], v[148:151], v[120:123], v[52:55]
    ds_read_b64_tr_b16 v[96:97], v9 offset:57344
    s_waitcnt lgkmcnt(7)
    v_mfma_f32_16x16x32_bf16 v[72:75], v[152:155], v[116:119], v[72:75]
    ds_read_b64_tr_b16 v[98:99], v9 offset:58368
    v_mfma_f32_16x16x32_bf16 v[72:75], v[156:159], v[124:127], v[72:75]
    ds_read_b64_tr_b16 v[100:101], v10 offset:49152
    v_mfma_f32_16x16x32_bf16 v[64:67], v[152:155], v[112:115], v[64:67]
    ds_read_b64_tr_b16 v[102:103], v10 offset:50176
    v_mfma_f32_16x16x32_bf16 v[64:67], v[156:159], v[120:123], v[64:67]
    ds_read_b64_tr_b16 v[104:105], v10 offset:57344
    s_waitcnt lgkmcnt(7)
    v_mfma_f32_16x16x32_bf16 v[76:79], v[136:139], v[116:119], v[76:79]
    ds_read_b64_tr_b16 v[106:107], v10 offset:58368
    v_mfma_f32_16x16x32_bf16 v[76:79], v[140:143], v[124:127], v[76:79]
    s_barrier
    v_add_u32 v1, 65536, v1
    ds_read_b64_tr_b16 v[108:109], v1 offset:0
    v_mfma_f32_16x16x32_bf16 v[68:71], v[136:139], v[112:115], v[68:71]
    ds_read_b64_tr_b16 v[110:111], v1 offset:1024
    v_mfma_f32_16x16x32_bf16 v[68:71], v[140:143], v[120:123], v[68:71]
    ds_read_b64_tr_b16 v[20:21], v1 offset:8192
    s_waitcnt lgkmcnt(7)
    v_mfma_f32_16x16x32_bf16 v[88:91], v[16:19], v[116:119], v[88:91]
    ds_read_b64_tr_b16 v[22:23], v1 offset:9216
    v_mfma_f32_16x16x32_bf16 v[88:91], v[96:99], v[124:127], v[88:91]
    v_add_u32 v2, 65536, v2
    ds_read_b64_tr_b16 v[24:25], v2 offset:0
    v_mfma_f32_16x16x32_bf16 v[80:83], v[16:19], v[112:115], v[80:83]
    ds_read_b64_tr_b16 v[26:27], v2 offset:1024
    v_mfma_f32_16x16x32_bf16 v[80:83], v[96:99], v[120:123], v[80:83]
    ds_read_b64_tr_b16 v[28:29], v2 offset:8192
    s_waitcnt lgkmcnt(7)
    v_mfma_f32_16x16x32_bf16 v[92:95], v[100:103], v[116:119], v[92:95]
    ds_read_b64_tr_b16 v[30:31], v2 offset:9216
    v_mfma_f32_16x16x32_bf16 v[92:95], v[104:107], v[124:127], v[92:95]
    v_add_u32 v4, 65536, v4
    ds_read_b64_tr_b16 v[12:13], v4 offset:0
    v_mfma_f32_16x16x32_bf16 v[84:87], v[100:103], v[112:115], v[84:87]
    ds_read_b64_tr_b16 v[14:15], v4 offset:1024
    v_mfma_f32_16x16x32_bf16 v[84:87], v[104:107], v[120:123], v[84:87]
    ds_read_b64_tr_b16 v[128:129], v4 offset:8192
    s_waitcnt lgkmcnt(7)
    v_mfma_f32_16x16x32_bf16 v[40:43], v[108:111], v[164:167], v[40:43]
    ds_read_b64_tr_b16 v[130:131], v4 offset:9216
    v_mfma_f32_16x16x32_bf16 v[40:43], v[20:23], v[172:175], v[40:43]
    v_add_u32 v5, 65536, v5
    ds_read_b64_tr_b16 v[132:133], v5 offset:0
    v_mfma_f32_16x16x32_bf16 v[32:35], v[108:111], v[160:163], v[32:35]
    ds_read_b64_tr_b16 v[134:135], v5 offset:1024
    v_mfma_f32_16x16x32_bf16 v[32:35], v[20:23], v[168:171], v[32:35]
    ds_read_b64_tr_b16 v[144:145], v5 offset:8192
    s_waitcnt lgkmcnt(7)
    v_mfma_f32_16x16x32_bf16 v[44:47], v[24:27], v[164:167], v[44:47]
    ds_read_b64_tr_b16 v[146:147], v5 offset:9216
    v_mfma_f32_16x16x32_bf16 v[44:47], v[28:31], v[172:175], v[44:47]
    v_add_u32 v7, 65536, v7
    ds_read_b64_tr_b16 v[148:149], v7 offset:0
    v_mfma_f32_16x16x32_bf16 v[36:39], v[24:27], v[160:163], v[36:39]
    ds_read_b64_tr_b16 v[150:151], v7 offset:1024
    v_mfma_f32_16x16x32_bf16 v[36:39], v[28:31], v[168:171], v[36:39]
    ds_read_b64_tr_b16 v[152:153], v7 offset:8192
    s_waitcnt lgkmcnt(7)
    v_mfma_f32_16x16x32_bf16 v[56:59], v[12:15], v[164:167], v[56:59]
    ds_read_b64_tr_b16 v[154:155], v7 offset:9216
    v_mfma_f32_16x16x32_bf16 v[56:59], v[128:131], v[172:175], v[56:59]
    v_add_u32 v8, 65536, v8
    ds_read_b64_tr_b16 v[156:157], v8 offset:0
    v_mfma_f32_16x16x32_bf16 v[48:51], v[12:15], v[160:163], v[48:51]
    ds_read_b64_tr_b16 v[158:159], v8 offset:1024
    v_mfma_f32_16x16x32_bf16 v[48:51], v[128:131], v[168:171], v[48:51]
    ds_read_b64_tr_b16 v[136:137], v8 offset:8192
    s_waitcnt lgkmcnt(7)
    v_mfma_f32_16x16x32_bf16 v[60:63], v[132:135], v[164:167], v[60:63]
    ds_read_b64_tr_b16 v[138:139], v8 offset:9216
    v_mfma_f32_16x16x32_bf16 v[60:63], v[144:147], v[172:175], v[60:63]
    v_add_u32 v9, 65536, v9
    ds_read_b64_tr_b16 v[140:141], v9 offset:0
    v_mfma_f32_16x16x32_bf16 v[52:55], v[132:135], v[160:163], v[52:55]
    ds_read_b64_tr_b16 v[142:143], v9 offset:1024
    v_mfma_f32_16x16x32_bf16 v[52:55], v[144:147], v[168:171], v[52:55]
    ds_read_b64_tr_b16 v[16:17], v9 offset:8192
    s_waitcnt lgkmcnt(7)
    v_mfma_f32_16x16x32_bf16 v[72:75], v[148:151], v[164:167], v[72:75]
    ds_read_b64_tr_b16 v[18:19], v9 offset:9216
    v_mfma_f32_16x16x32_bf16 v[72:75], v[152:155], v[172:175], v[72:75]
    v_add_u32 v10, 65536, v10
    ds_read_b64_tr_b16 v[96:97], v10 offset:0
    v_mfma_f32_16x16x32_bf16 v[64:67], v[148:151], v[160:163], v[64:67]
    ds_read_b64_tr_b16 v[98:99], v10 offset:1024
    v_mfma_f32_16x16x32_bf16 v[64:67], v[152:155], v[168:171], v[64:67]
    ds_read_b64_tr_b16 v[100:101], v10 offset:8192
    s_waitcnt lgkmcnt(7)
    v_mfma_f32_16x16x32_bf16 v[76:79], v[156:159], v[164:167], v[76:79]
    ds_read_b64_tr_b16 v[102:103], v10 offset:9216
    v_mfma_f32_16x16x32_bf16 v[76:79], v[136:139], v[172:175], v[76:79]
    ds_read_b64_tr_b16 v[104:105], v1 offset:16384
    v_mfma_f32_16x16x32_bf16 v[68:71], v[156:159], v[160:163], v[68:71]
    ds_read_b64_tr_b16 v[106:107], v1 offset:17408
    v_mfma_f32_16x16x32_bf16 v[68:71], v[136:139], v[168:171], v[68:71]
    ds_read_b64_tr_b16 v[112:113], v1 offset:24576
    s_waitcnt lgkmcnt(7)
    v_mfma_f32_16x16x32_bf16 v[88:91], v[140:143], v[164:167], v[88:91]
    ds_read_b64_tr_b16 v[114:115], v1 offset:25600
    v_mfma_f32_16x16x32_bf16 v[88:91], v[16:19], v[172:175], v[88:91]
    ds_read_b64_tr_b16 v[116:117], v2 offset:16384
    v_mfma_f32_16x16x32_bf16 v[80:83], v[140:143], v[160:163], v[80:83]
    ds_read_b64_tr_b16 v[118:119], v2 offset:17408
    v_mfma_f32_16x16x32_bf16 v[80:83], v[16:19], v[168:171], v[80:83]
    ds_read_b64_tr_b16 v[120:121], v2 offset:24576
    s_waitcnt lgkmcnt(7)
    v_mfma_f32_16x16x32_bf16 v[92:95], v[96:99], v[164:167], v[92:95]
    ds_read_b64_tr_b16 v[122:123], v2 offset:25600
    v_mfma_f32_16x16x32_bf16 v[92:95], v[100:103], v[172:175], v[92:95]
    ds_read_b64_tr_b16 v[124:125], v4 offset:16384
    v_mfma_f32_16x16x32_bf16 v[84:87], v[96:99], v[160:163], v[84:87]
    ds_read_b64_tr_b16 v[126:127], v4 offset:17408
    v_mfma_f32_16x16x32_bf16 v[84:87], v[100:103], v[168:171], v[84:87]
    ds_read_b64_tr_b16 v[108:109], v4 offset:24576
    s_waitcnt lgkmcnt(7)
    v_mfma_f32_16x16x32_bf16 v[40:43], v[104:107], v[180:183], v[40:43]
    ds_read_b64_tr_b16 v[110:111], v4 offset:25600
    v_mfma_f32_16x16x32_bf16 v[40:43], v[112:115], v[188:191], v[40:43]
    ds_read_b64_tr_b16 v[20:21], v5 offset:16384
    v_mfma_f32_16x16x32_bf16 v[32:35], v[104:107], v[176:179], v[32:35]
    ds_read_b64_tr_b16 v[22:23], v5 offset:17408
    v_mfma_f32_16x16x32_bf16 v[32:35], v[112:115], v[184:187], v[32:35]
    ds_read_b64_tr_b16 v[24:25], v5 offset:24576
    s_waitcnt lgkmcnt(7)
    v_mfma_f32_16x16x32_bf16 v[44:47], v[116:119], v[180:183], v[44:47]
    ds_read_b64_tr_b16 v[26:27], v5 offset:25600
    v_mfma_f32_16x16x32_bf16 v[44:47], v[120:123], v[188:191], v[44:47]
    ds_read_b64_tr_b16 v[28:29], v7 offset:16384
    v_mfma_f32_16x16x32_bf16 v[36:39], v[116:119], v[176:179], v[36:39]
    ds_read_b64_tr_b16 v[30:31], v7 offset:17408
    v_mfma_f32_16x16x32_bf16 v[36:39], v[120:123], v[184:187], v[36:39]
    ds_read_b64_tr_b16 v[12:13], v7 offset:24576
    s_waitcnt lgkmcnt(7)
    v_mfma_f32_16x16x32_bf16 v[56:59], v[124:127], v[180:183], v[56:59]
    ds_read_b64_tr_b16 v[14:15], v7 offset:25600
    v_mfma_f32_16x16x32_bf16 v[56:59], v[108:111], v[188:191], v[56:59]
    ds_read_b64_tr_b16 v[128:129], v8 offset:16384
    v_mfma_f32_16x16x32_bf16 v[48:51], v[124:127], v[176:179], v[48:51]
    ds_read_b64_tr_b16 v[130:131], v8 offset:17408
    v_mfma_f32_16x16x32_bf16 v[48:51], v[108:111], v[184:187], v[48:51]
    ds_read_b64_tr_b16 v[132:133], v8 offset:24576
    s_waitcnt lgkmcnt(7)
    v_mfma_f32_16x16x32_bf16 v[60:63], v[20:23], v[180:183], v[60:63]
    ds_read_b64_tr_b16 v[134:135], v8 offset:25600
    v_mfma_f32_16x16x32_bf16 v[60:63], v[24:27], v[188:191], v[60:63]
    ds_read_b64_tr_b16 v[144:145], v9 offset:16384
    v_mfma_f32_16x16x32_bf16 v[52:55], v[20:23], v[176:179], v[52:55]
    ds_read_b64_tr_b16 v[146:147], v9 offset:17408
    v_mfma_f32_16x16x32_bf16 v[52:55], v[24:27], v[184:187], v[52:55]
    ds_read_b64_tr_b16 v[148:149], v9 offset:24576
    s_waitcnt lgkmcnt(7)
    v_mfma_f32_16x16x32_bf16 v[72:75], v[28:31], v[180:183], v[72:75]
    ds_read_b64_tr_b16 v[150:151], v9 offset:25600
    v_mfma_f32_16x16x32_bf16 v[72:75], v[12:15], v[188:191], v[72:75]
    ds_read_b64_tr_b16 v[152:153], v10 offset:16384
    v_mfma_f32_16x16x32_bf16 v[64:67], v[28:31], v[176:179], v[64:67]
    ds_read_b64_tr_b16 v[154:155], v10 offset:17408
    v_mfma_f32_16x16x32_bf16 v[64:67], v[12:15], v[184:187], v[64:67]
    ds_read_b64_tr_b16 v[156:157], v10 offset:24576
    s_waitcnt lgkmcnt(7)
    v_mfma_f32_16x16x32_bf16 v[76:79], v[128:131], v[180:183], v[76:79]
    ds_read_b64_tr_b16 v[158:159], v10 offset:25600
    v_mfma_f32_16x16x32_bf16 v[76:79], v[132:135], v[188:191], v[76:79]
    s_barrier
    ds_read_b64_tr_b16 v[136:137], v1 offset:32768
    v_mfma_f32_16x16x32_bf16 v[68:71], v[128:131], v[176:179], v[68:71]
    ds_read_b64_tr_b16 v[138:139], v1 offset:33792
    v_mfma_f32_16x16x32_bf16 v[68:71], v[132:135], v[184:187], v[68:71]
    ds_read_b64_tr_b16 v[140:141], v1 offset:40960
    s_waitcnt lgkmcnt(7)
    v_mfma_f32_16x16x32_bf16 v[88:91], v[144:147], v[180:183], v[88:91]
    ds_read_b64_tr_b16 v[142:143], v1 offset:41984
    v_mfma_f32_16x16x32_bf16 v[88:91], v[148:151], v[188:191], v[88:91]
    ds_read_b64_tr_b16 v[16:17], v2 offset:32768
    v_mfma_f32_16x16x32_bf16 v[80:83], v[144:147], v[176:179], v[80:83]
    ds_read_b64_tr_b16 v[18:19], v2 offset:33792
    v_mfma_f32_16x16x32_bf16 v[80:83], v[148:151], v[184:187], v[80:83]
    ds_read_b64_tr_b16 v[96:97], v2 offset:40960
    s_waitcnt lgkmcnt(7)
    v_mfma_f32_16x16x32_bf16 v[92:95], v[152:155], v[180:183], v[92:95]
    ds_read_b64_tr_b16 v[98:99], v2 offset:41984
    v_mfma_f32_16x16x32_bf16 v[92:95], v[156:159], v[188:191], v[92:95]
    ds_read_b64_tr_b16 v[100:101], v4 offset:32768
    v_mfma_f32_16x16x32_bf16 v[84:87], v[152:155], v[176:179], v[84:87]
    ds_read_b64_tr_b16 v[102:103], v4 offset:33792
    v_mfma_f32_16x16x32_bf16 v[84:87], v[156:159], v[184:187], v[84:87]
    ds_read_b64_tr_b16 v[160:161], v4 offset:40960
    s_waitcnt lgkmcnt(7)
    v_mfma_f32_16x16x32_bf16 v[40:43], v[136:139], v[196:199], v[40:43]
    ds_read_b64_tr_b16 v[162:163], v4 offset:41984
    v_mfma_f32_16x16x32_bf16 v[40:43], v[140:143], v[204:207], v[40:43]
    ds_read_b64_tr_b16 v[164:165], v5 offset:32768
    v_mfma_f32_16x16x32_bf16 v[32:35], v[136:139], v[192:195], v[32:35]
    ds_read_b64_tr_b16 v[166:167], v5 offset:33792
    v_mfma_f32_16x16x32_bf16 v[32:35], v[140:143], v[200:203], v[32:35]
    ds_read_b64_tr_b16 v[168:169], v5 offset:40960
    s_waitcnt lgkmcnt(7)
    v_mfma_f32_16x16x32_bf16 v[44:47], v[16:19], v[196:199], v[44:47]
    ds_read_b64_tr_b16 v[170:171], v5 offset:41984
    v_mfma_f32_16x16x32_bf16 v[44:47], v[96:99], v[204:207], v[44:47]
    ds_read_b64_tr_b16 v[172:173], v7 offset:32768
    v_mfma_f32_16x16x32_bf16 v[36:39], v[16:19], v[192:195], v[36:39]
    ds_read_b64_tr_b16 v[174:175], v7 offset:33792
    v_mfma_f32_16x16x32_bf16 v[36:39], v[96:99], v[200:203], v[36:39]
    ds_read_b64_tr_b16 v[104:105], v7 offset:40960
    s_waitcnt lgkmcnt(7)
    v_mfma_f32_16x16x32_bf16 v[56:59], v[100:103], v[196:199], v[56:59]
    ds_read_b64_tr_b16 v[106:107], v7 offset:41984
    v_mfma_f32_16x16x32_bf16 v[56:59], v[160:163], v[204:207], v[56:59]
    ds_read_b64_tr_b16 v[112:113], v8 offset:32768
    v_mfma_f32_16x16x32_bf16 v[48:51], v[100:103], v[192:195], v[48:51]
    ds_read_b64_tr_b16 v[114:115], v8 offset:33792
    v_mfma_f32_16x16x32_bf16 v[48:51], v[160:163], v[200:203], v[48:51]
    ds_read_b64_tr_b16 v[116:117], v8 offset:40960
    s_waitcnt lgkmcnt(7)
    v_mfma_f32_16x16x32_bf16 v[60:63], v[164:167], v[196:199], v[60:63]
    ds_read_b64_tr_b16 v[118:119], v8 offset:41984
    v_mfma_f32_16x16x32_bf16 v[60:63], v[168:171], v[204:207], v[60:63]
    ds_read_b64_tr_b16 v[120:121], v9 offset:32768
    v_mfma_f32_16x16x32_bf16 v[52:55], v[164:167], v[192:195], v[52:55]
    ds_read_b64_tr_b16 v[122:123], v9 offset:33792
    v_mfma_f32_16x16x32_bf16 v[52:55], v[168:171], v[200:203], v[52:55]
    ds_read_b64_tr_b16 v[124:125], v9 offset:40960
    s_waitcnt lgkmcnt(7)
    v_mfma_f32_16x16x32_bf16 v[72:75], v[172:175], v[196:199], v[72:75]
    ds_read_b64_tr_b16 v[126:127], v9 offset:41984
    v_mfma_f32_16x16x32_bf16 v[72:75], v[104:107], v[204:207], v[72:75]
    ds_read_b64_tr_b16 v[108:109], v10 offset:32768
    v_mfma_f32_16x16x32_bf16 v[64:67], v[172:175], v[192:195], v[64:67]
    ds_read_b64_tr_b16 v[110:111], v10 offset:33792
    v_mfma_f32_16x16x32_bf16 v[64:67], v[104:107], v[200:203], v[64:67]
    ds_read_b64_tr_b16 v[20:21], v10 offset:40960
    s_waitcnt lgkmcnt(7)
    v_mfma_f32_16x16x32_bf16 v[76:79], v[112:115], v[196:199], v[76:79]
    ds_read_b64_tr_b16 v[22:23], v10 offset:41984
    v_mfma_f32_16x16x32_bf16 v[76:79], v[116:119], v[204:207], v[76:79]
    ds_read_b64_tr_b16 v[24:25], v1 offset:49152
    v_mfma_f32_16x16x32_bf16 v[68:71], v[112:115], v[192:195], v[68:71]
    ds_read_b64_tr_b16 v[26:27], v1 offset:50176
    v_mfma_f32_16x16x32_bf16 v[68:71], v[116:119], v[200:203], v[68:71]
    ds_read_b64_tr_b16 v[28:29], v1 offset:57344
    s_waitcnt lgkmcnt(7)
    v_mfma_f32_16x16x32_bf16 v[88:91], v[120:123], v[196:199], v[88:91]
    ds_read_b64_tr_b16 v[30:31], v1 offset:58368
    v_mfma_f32_16x16x32_bf16 v[88:91], v[124:127], v[204:207], v[88:91]
    ds_read_b64_tr_b16 v[12:13], v2 offset:49152
    v_mfma_f32_16x16x32_bf16 v[80:83], v[120:123], v[192:195], v[80:83]
    ds_read_b64_tr_b16 v[14:15], v2 offset:50176
    v_mfma_f32_16x16x32_bf16 v[80:83], v[124:127], v[200:203], v[80:83]
    ds_read_b64_tr_b16 v[128:129], v2 offset:57344
    s_waitcnt lgkmcnt(7)
    v_mfma_f32_16x16x32_bf16 v[92:95], v[108:111], v[196:199], v[92:95]
    ds_read_b64_tr_b16 v[130:131], v2 offset:58368
    v_mfma_f32_16x16x32_bf16 v[92:95], v[20:23], v[204:207], v[92:95]
    ds_read_b64_tr_b16 v[132:133], v4 offset:49152
    v_mfma_f32_16x16x32_bf16 v[84:87], v[108:111], v[192:195], v[84:87]
    ds_read_b64_tr_b16 v[134:135], v4 offset:50176
    v_mfma_f32_16x16x32_bf16 v[84:87], v[20:23], v[200:203], v[84:87]
    ds_read_b64_tr_b16 v[144:145], v4 offset:57344
    s_waitcnt lgkmcnt(7)
    v_mfma_f32_16x16x32_bf16 v[40:43], v[24:27], v[212:215], v[40:43]
    ds_read_b64_tr_b16 v[146:147], v4 offset:58368
    v_mfma_f32_16x16x32_bf16 v[40:43], v[28:31], v[220:223], v[40:43]
    ds_read_b64_tr_b16 v[148:149], v5 offset:49152
    v_mfma_f32_16x16x32_bf16 v[32:35], v[24:27], v[208:211], v[32:35]
    ds_read_b64_tr_b16 v[150:151], v5 offset:50176
    v_mfma_f32_16x16x32_bf16 v[32:35], v[28:31], v[216:219], v[32:35]
    ds_read_b64_tr_b16 v[152:153], v5 offset:57344
    s_waitcnt lgkmcnt(7)
    v_mfma_f32_16x16x32_bf16 v[44:47], v[12:15], v[212:215], v[44:47]
    ds_read_b64_tr_b16 v[154:155], v5 offset:58368
    v_mfma_f32_16x16x32_bf16 v[44:47], v[128:131], v[220:223], v[44:47]
Lpad_gb_0:
    s_cbranch_scc1 Lwarm_gb
    ds_read_b64_tr_b16 v[156:157], v7 offset:49152
    v_mfma_f32_16x16x32_bf16 v[36:39], v[12:15], v[208:211], v[36:39]
    ds_read_b64_tr_b16 v[158:159], v7 offset:50176
    v_mfma_f32_16x16x32_bf16 v[36:39], v[128:131], v[216:219], v[36:39]
    ds_read_b64_tr_b16 v[176:177], v7 offset:57344
    s_waitcnt lgkmcnt(7)
    v_mfma_f32_16x16x32_bf16 v[56:59], v[132:135], v[212:215], v[56:59]
    ds_read_b64_tr_b16 v[178:179], v7 offset:58368
    v_mfma_f32_16x16x32_bf16 v[56:59], v[144:147], v[220:223], v[56:59]
    ds_read_b64_tr_b16 v[180:181], v8 offset:49152
    v_mfma_f32_16x16x32_bf16 v[48:51], v[132:135], v[208:211], v[48:51]
    ds_read_b64_tr_b16 v[182:183], v8 offset:50176
    v_mfma_f32_16x16x32_bf16 v[48:51], v[144:147], v[216:219], v[48:51]
    ds_read_b64_tr_b16 v[184:185], v8 offset:57344
    s_waitcnt lgkmcnt(7)
    v_mfma_f32_16x16x32_bf16 v[60:63], v[148:151], v[212:215], v[60:63]
    ds_read_b64_tr_b16 v[186:187], v8 offset:58368
    v_mfma_f32_16x16x32_bf16 v[60:63], v[152:155], v[220:223], v[60:63]
    ds_read_b64_tr_b16 v[188:189], v9 offset:49152
    v_mfma_f32_16x16x32_bf16 v[52:55], v[148:151], v[208:211], v[52:55]
    ds_read_b64_tr_b16 v[190:191], v9 offset:50176
    v_mfma_f32_16x16x32_bf16 v[52:55], v[152:155], v[216:219], v[52:55]
    ds_read_b64_tr_b16 v[136:137], v9 offset:57344
    s_waitcnt lgkmcnt(7)
    v_mfma_f32_16x16x32_bf16 v[72:75], v[156:159], v[212:215], v[72:75]
    ds_read_b64_tr_b16 v[138:139], v9 offset:58368
    v_mfma_f32_16x16x32_bf16 v[72:75], v[176:179], v[220:223], v[72:75]
    ds_read_b64_tr_b16 v[140:141], v10 offset:49152
    v_mfma_f32_16x16x32_bf16 v[64:67], v[156:159], v[208:211], v[64:67]
    ds_read_b64_tr_b16 v[142:143], v10 offset:50176
    v_mfma_f32_16x16x32_bf16 v[64:67], v[176:179], v[216:219], v[64:67]
    ds_read_b64_tr_b16 v[16:17], v10 offset:57344
    s_waitcnt lgkmcnt(7)
    v_mfma_f32_16x16x32_bf16 v[76:79], v[180:183], v[212:215], v[76:79]
    ds_read_b64_tr_b16 v[18:19], v10 offset:58368
    v_mfma_f32_16x16x32_bf16 v[76:79], v[184:187], v[220:223], v[76:79]
    s_barrier
    v_add_u32 v1, 32768, v1
    ds_read_b64_tr_b16 v[96:97], v1 offset:32768
    v_mfma_f32_16x16x32_bf16 v[68:71], v[180:183], v[208:211], v[68:71]
    ds_read_b64_tr_b16 v[98:99], v1 offset:33792
    v_mfma_f32_16x16x32_bf16 v[68:71], v[184:187], v[216:219], v[68:71]
    ds_read_b64_tr_b16 v[100:101], v1 offset:40960
    s_waitcnt lgkmcnt(7)
    v_mfma_f32_16x16x32_bf16 v[88:91], v[188:191], v[212:215], v[88:91]
    ds_read_b64_tr_b16 v[102:103], v1 offset:41984
    v_mfma_f32_16x16x32_bf16 v[88:91], v[136:139], v[220:223], v[88:91]
    ds_read_b64_tr_b16 v[160:161], v1 offset:49152
    v_mfma_f32_16x16x32_bf16 v[80:83], v[188:191], v[208:211], v[80:83]
    ds_read_b64_tr_b16 v[162:163], v1 offset:50176
    v_mfma_f32_16x16x32_bf16 v[80:83], v[136:139], v[216:219], v[80:83]
    ds_read_b64_tr_b16 v[164:165], v1 offset:57344
    s_waitcnt lgkmcnt(7)
    v_mfma_f32_16x16x32_bf16 v[92:95], v[140:143], v[212:215], v[92:95]
    ds_read_b64_tr_b16 v[166:167], v1 offset:58368
    v_mfma_f32_16x16x32_bf16 v[92:95], v[16:19], v[220:223], v[92:95]
    v_add_u32 v2, 32768, v2
    ds_read_b64_tr_b16 v[168:169], v2 offset:32768
    v_mfma_f32_16x16x32_bf16 v[84:87], v[140:143], v[208:211], v[84:87]
    ds_read_b64_tr_b16 v[170:171], v2 offset:33792
    v_mfma_f32_16x16x32_bf16 v[84:87], v[16:19], v[216:219], v[84:87]
    ds_read_b64_tr_b16 v[172:173], v2 offset:40960
    s_waitcnt lgkmcnt(7)
    v_mfma_f32_16x16x32_bf16 v[40:43], v[96:99], v[228:231], v[40:43]
    ds_read_b64_tr_b16 v[174:175], v2 offset:41984
    v_mfma_f32_16x16x32_bf16 v[40:43], v[100:103], v[236:239], v[40:43]
    ds_read_b64_tr_b16 v[104:105], v2 offset:49152
    v_mfma_f32_16x16x32_bf16 v[32:35], v[96:99], v[224:227], v[32:35]
    ds_read_b64_tr_b16 v[106:107], v2 offset:50176
    v_mfma_f32_16x16x32_bf16 v[32:35], v[100:103], v[232:235], v[32:35]
    ds_read_b64_tr_b16 v[112:113], v2 offset:57344
    s_waitcnt lgkmcnt(7)
    v_mfma_f32_16x16x32_bf16 v[40:43], v[160:163], v[244:247], v[40:43]
    ds_read_b64_tr_b16 v[114:115], v2 offset:58368
    v_mfma_f32_16x16x32_bf16 v[40:43], v[164:167], v[252:255], v[40:43]
    v_add_u32 v4, 32768, v4
    ds_read_b64_tr_b16 v[116:117], v4 offset:32768
    v_mfma_f32_16x16x32_bf16 v[32:35], v[160:163], v[240:243], v[32:35]
    ds_read_b64_tr_b16 v[118:119], v4 offset:33792
    v_mfma_f32_16x16x32_bf16 v[32:35], v[164:167], v[248:251], v[32:35]
    ds_read_b64_tr_b16 v[120:121], v4 offset:40960
    s_waitcnt lgkmcnt(7)
    v_mfma_f32_16x16x32_bf16 v[44:47], v[168:171], v[228:231], v[44:47]
    ds_read_b64_tr_b16 v[122:123], v4 offset:41984
    v_mul_f32 v40, v40, |v40|
    v_mfma_f32_16x16x32_bf16 v[44:47], v[172:175], v[236:239], v[44:47]
    ds_read_b64_tr_b16 v[124:125], v4 offset:49152
    v_mul_f32 v41, v41, |v41|
    v_mul_f32 v42, v42, |v42|
    v_mfma_f32_16x16x32_bf16 v[36:39], v[168:171], v[224:227], v[36:39]
    ds_read_b64_tr_b16 v[126:127], v4 offset:50176
    v_mul_f32 v43, v43, |v43|
    v_mfma_f32_16x16x32_bf16 v[36:39], v[172:175], v[232:235], v[36:39]
    ds_read_b64_tr_b16 v[108:109], v4 offset:57344
    v_cvt_pk_bf16_f32 v40, v40, v41
    s_waitcnt lgkmcnt(7)
    v_mfma_f32_16x16x32_bf16 v[44:47], v[104:107], v[244:247], v[44:47]
    ds_read_b64_tr_b16 v[110:111], v4 offset:58368
    v_cvt_pk_bf16_f32 v41, v42, v43
    v_mfma_f32_16x16x32_bf16 v[44:47], v[112:115], v[252:255], v[44:47]
    v_add_u32 v5, 32768, v5
    ds_read_b64_tr_b16 v[20:21], v5 offset:32768
    v_pk_max_i16 v40, v40, 0
    v_pk_max_i16 v41, v41, 0
    v_mfma_f32_16x16x32_bf16 v[36:39], v[104:107], v[240:243], v[36:39]
    ds_read_b64_tr_b16 v[22:23], v5 offset:33792
    v_mul_f32 v32, v32, |v32|
    v_mfma_f32_16x16x32_bf16 v[36:39], v[112:115], v[248:251], v[36:39]
    ds_read_b64_tr_b16 v[192:193], v5 offset:40960
    v_mul_f32 v33, v33, |v33|
    s_waitcnt lgkmcnt(7)
    v_mfma_f32_16x16x32_bf16 v[56:59], v[116:119], v[228:231], v[56:59]
    ds_read_b64_tr_b16 v[194:195], v5 offset:41984
    v_mul_f32 v34, v34, |v34|
    v_mfma_f32_16x16x32_bf16 v[56:59], v[120:123], v[236:239], v[56:59]
    ds_read_b64_tr_b16 v[196:197], v5 offset:49152
    v_mul_f32 v35, v35, |v35|
    v_cvt_pk_bf16_f32 v32, v32, v33
    v_mfma_f32_16x16x32_bf16 v[48:51], v[116:119], v[224:227], v[48:51]
    ds_read_b64_tr_b16 v[198:199], v5 offset:50176
    v_cvt_pk_bf16_f32 v33, v34, v35
    v_mfma_f32_16x16x32_bf16 v[48:51], v[120:123], v[232:235], v[48:51]
    ds_read_b64_tr_b16 v[200:201], v5 offset:57344
    v_pk_max_i16 v32, v32, 0
    s_waitcnt lgkmcnt(7)
    v_mfma_f32_16x16x32_bf16 v[56:59], v[124:127], v[244:247], v[56:59]
    ds_read_b64_tr_b16 v[202:203], v5 offset:58368
    v_pk_max_i16 v33, v33, 0
    v_mfma_f32_16x16x32_bf16 v[56:59], v[108:111], v[252:255], v[56:59]
    v_add_u32 v7, 32768, v7
    ds_read_b64_tr_b16 v[204:205], v7 offset:32768
    v_mul_f32 v44, v44, |v44|
    v_mul_f32 v45, v45, |v45|
    v_mfma_f32_16x16x32_bf16 v[48:51], v[124:127], v[240:243], v[48:51]
    ds_read_b64_tr_b16 v[206:207], v7 offset:33792
    v_mul_f32 v46, v46, |v46|
    v_mfma_f32_16x16x32_bf16 v[48:51], v[108:111], v[248:251], v[48:51]
    ds_read_b64_tr_b16 v[24:25], v7 offset:40960
    v_mul_f32 v47, v47, |v47|
    s_waitcnt lgkmcnt(7)
    v_mfma_f32_16x16x32_bf16 v[60:63], v[20:23], v[228:231], v[60:63]
    ds_read_b64_tr_b16 v[26:27], v7 offset:41984
    v_cvt_pk_bf16_f32 v42, v44, v45
    v_mfma_f32_16x16x32_bf16 v[60:63], v[192:195], v[236:239], v[60:63]
    ds_read_b64_tr_b16 v[28:29], v7 offset:49152
    v_cvt_pk_bf16_f32 v43, v46, v47
    v_pk_max_i16 v42, v42, 0
    v_mfma_f32_16x16x32_bf16 v[52:55], v[20:23], v[224:227], v[52:55]
    ds_read_b64_tr_b16 v[30:31], v7 offset:50176
    v_pk_max_i16 v43, v43, 0
    v_mfma_f32_16x16x32_bf16 v[52:55], v[192:195], v[232:235], v[52:55]
    ds_read_b64_tr_b16 v[12:13], v7 offset:57344
    v_mul_f32 v36, v36, |v36|
    s_waitcnt lgkmcnt(7)
    v_mfma_f32_16x16x32_bf16 v[60:63], v[196:199], v[244:247], v[60:63]
    ds_read_b64_tr_b16 v[14:15], v7 offset:58368
    v_mul_f32 v37, v37, |v37|
    v_mfma_f32_16x16x32_bf16 v[60:63], v[200:203], v[252:255], v[60:63]
    v_add_u32 v8, 32768, v8
    ds_read_b64_tr_b16 v[128:129], v8 offset:32768
    v_mul_f32 v38, v38, |v38|
    v_mul_f32 v39, v39, |v39|
    v_mfma_f32_16x16x32_bf16 v[52:55], v[196:199], v[240:243], v[52:55]
    ds_read_b64_tr_b16 v[130:131], v8 offset:33792
    v_cvt_pk_bf16_f32 v34, v36, v37
    v_mfma_f32_16x16x32_bf16 v[52:55], v[200:203], v[248:251], v[52:55]
    ds_read_b64_tr_b16 v[132:133], v8 offset:40960
    v_cvt_pk_bf16_f32 v35, v38, v39
    s_waitcnt lgkmcnt(7)
    v_mfma_f32_16x16x32_bf16 v[72:75], v[204:207], v[228:231], v[72:75]
    ds_read_b64_tr_b16 v[134:135], v8 offset:41984
    v_pk_max_i16 v34, v34, 0
    v_mfma_f32_16x16x32_bf16 v[72:75], v[24:27], v[236:239], v[72:75]
    ds_read_b64_tr_b16 v[144:145], v8 offset:49152
    v_pk_max_i16 v35, v35, 0
    v_mul_f32 v56, v56, |v56|
    v_mfma_f32_16x16x32_bf16 v[64:67], v[204:207], v[224:227], v[64:67]
    ds_read_b64_tr_b16 v[146:147], v8 offset:50176
    v_mul_f32 v57, v57, |v57|
    v_mfma_f32_16x16x32_bf16 v[64:67], v[24:27], v[232:235], v[64:67]
    ds_read_b64_tr_b16 v[148:149], v8 offset:57344
    v_mul_f32 v58, v58, |v58|
    s_waitcnt lgkmcnt(7)
    v_mfma_f32_16x16x32_bf16 v[72:75], v[28:31], v[244:247], v[72:75]
    ds_read_b64_tr_b16 v[150:151], v8 offset:58368
    v_mul_f32 v59, v59, |v59|
    v_mfma_f32_16x16x32_bf16 v[72:75], v[12:15], v[252:255], v[72:75]
    v_add_u32 v9, 32768, v9
    ds_read_b64_tr_b16 v[152:153], v9 offset:32768
    v_cvt_pk_bf16_f32 v56, v56, v57
    v_cvt_pk_bf16_f32 v57, v58, v59
    v_mfma_f32_16x16x32_bf16 v[64:67], v[28:31], v[240:243], v[64:67]
    ds_read_b64_tr_b16 v[154:155], v9 offset:33792
    v_pk_max_i16 v56, v56, 0
    v_mfma_f32_16x16x32_bf16 v[64:67], v[12:15], v[248:251], v[64:67]
    ds_read_b64_tr_b16 v[156:157], v9 offset:40960
    v_pk_max_i16 v57, v57, 0
    s_waitcnt lgkmcnt(7)
    v_mfma_f32_16x16x32_bf16 v[76:79], v[128:131], v[228:231], v[76:79]
    ds_read_b64_tr_b16 v[158:159], v9 offset:41984
    v_mul_f32 v48, v48, |v48|
    v_mfma_f32_16x16x32_bf16 v[76:79], v[132:135], v[236:239], v[76:79]
    ds_read_b64_tr_b16 v[176:177], v9 offset:49152
    v_mul_f32 v49, v49, |v49|
    v_mul_f32 v50, v50, |v50|
    v_mfma_f32_16x16x32_bf16 v[68:71], v[128:131], v[224:227], v[68:71]
    ds_read_b64_tr_b16 v[178:179], v9 offset:50176
    v_mul_f32 v51, v51, |v51|
    v_mfma_f32_16x16x32_bf16 v[68:71], v[132:135], v[232:235], v[68:71]
    ds_read_b64_tr_b16 v[180:181], v9 offset:57344
    v_cvt_pk_bf16_f32 v48, v48, v49
    s_waitcnt lgkmcnt(7)
    v_mfma_f32_16x16x32_bf16 v[76:79], v[144:147], v[244:247], v[76:79]
    ds_read_b64_tr_b16 v[182:183], v9 offset:58368
    v_cvt_pk_bf16_f32 v49, v50, v51
    v_mfma_f32_16x16x32_bf16 v[76:79], v[148:151], v[252:255], v[76:79]
    v_add_u32 v10, 32768, v10
    ds_read_b64_tr_b16 v[184:185], v10 offset:32768
    v_pk_max_i16 v48, v48, 0
    v_pk_max_i16 v49, v49, 0
    v_mfma_f32_16x16x32_bf16 v[68:71], v[144:147], v[240:243], v[68:71]
    ds_read_b64_tr_b16 v[186:187], v10 offset:33792
    v_mul_f32 v60, v60, |v60|
    v_mfma_f32_16x16x32_bf16 v[68:71], v[148:151], v[248:251], v[68:71]
    ds_read_b64_tr_b16 v[188:189], v10 offset:40960
    v_mul_f32 v61, v61, |v61|
    s_waitcnt lgkmcnt(7)
    v_mfma_f32_16x16x32_bf16 v[88:91], v[152:155], v[228:231], v[88:91]
    ds_read_b64_tr_b16 v[190:191], v10 offset:41984
    v_mul_f32 v62, v62, |v62|
    v_mfma_f32_16x16x32_bf16 v[88:91], v[156:159], v[236:239], v[88:91]
    ds_read_b64_tr_b16 v[136:137], v10 offset:49152
    v_mul_f32 v63, v63, |v63|
    v_cvt_pk_bf16_f32 v58, v60, v61
    v_mfma_f32_16x16x32_bf16 v[80:83], v[152:155], v[224:227], v[80:83]
    ds_read_b64_tr_b16 v[138:139], v10 offset:50176
    v_cvt_pk_bf16_f32 v59, v62, v63
    v_mfma_f32_16x16x32_bf16 v[80:83], v[156:159], v[232:235], v[80:83]
    ds_read_b64_tr_b16 v[140:141], v10 offset:57344
    v_pk_max_i16 v58, v58, 0
    s_waitcnt lgkmcnt(7)
    v_mfma_f32_16x16x32_bf16 v[88:91], v[176:179], v[244:247], v[88:91]
    ds_read_b64_tr_b16 v[142:143], v10 offset:58368
    v_pk_max_i16 v59, v59, 0
    v_mfma_f32_16x16x32_bf16 v[88:91], v[180:183], v[252:255], v[88:91]
    v_mul_f32 v52, v52, |v52|
    v_mul_f32 v53, v53, |v53|
    v_mfma_f32_16x16x32_bf16 v[80:83], v[176:179], v[240:243], v[80:83]
    v_mul_f32 v54, v54, |v54|
    v_mul_f32 v55, v55, |v55|
    v_mfma_f32_16x16x32_bf16 v[80:83], v[180:183], v[248:251], v[80:83]
    v_cvt_pk_bf16_f32 v50, v52, v53
    v_cvt_pk_bf16_f32 v51, v54, v55
    s_waitcnt lgkmcnt(4)
    v_mfma_f32_16x16x32_bf16 v[92:95], v[184:187], v[228:231], v[92:95]
    v_pk_max_i16 v50, v50, 0
    v_pk_max_i16 v51, v51, 0
    v_mfma_f32_16x16x32_bf16 v[92:95], v[188:191], v[236:239], v[92:95]
    v_mul_f32 v72, v72, |v72|
    v_mul_f32 v73, v73, |v73|
    v_mfma_f32_16x16x32_bf16 v[84:87], v[184:187], v[224:227], v[84:87]
    v_mul_f32 v74, v74, |v74|
    v_mul_f32 v75, v75, |v75|
    v_mfma_f32_16x16x32_bf16 v[84:87], v[188:191], v[232:235], v[84:87]
    v_cvt_pk_bf16_f32 v72, v72, v73
    v_cvt_pk_bf16_f32 v73, v74, v75
    s_waitcnt lgkmcnt(0)
    v_mfma_f32_16x16x32_bf16 v[92:95], v[136:139], v[244:247], v[92:95]
    v_pk_max_i16 v72, v72, 0
    v_pk_max_i16 v73, v73, 0
    v_mfma_f32_16x16x32_bf16 v[92:95], v[140:143], v[252:255], v[92:95]
    v_mul_f32 v64, v64, |v64|
    v_mul_f32 v65, v65, |v65|
    v_mfma_f32_16x16x32_bf16 v[84:87], v[136:139], v[240:243], v[84:87]
    v_mul_f32 v66, v66, |v66|
    v_mul_f32 v67, v67, |v67|
    v_mfma_f32_16x16x32_bf16 v[84:87], v[140:143], v[248:251], v[84:87]
    v_cvt_pk_bf16_f32 v64, v64, v65
    v_cvt_pk_bf16_f32 v65, v66, v67
    v_pk_max_i16 v64, v64, 0
    v_pk_max_i16 v65, v65, 0
    v_mul_f32 v76, v76, |v76|
    v_mul_f32 v77, v77, |v77|
    v_mul_f32 v78, v78, |v78|
    v_mul_f32 v79, v79, |v79|
    v_cvt_pk_bf16_f32 v74, v76, v77
    v_cvt_pk_bf16_f32 v75, v78, v79
    v_pk_max_i16 v74, v74, 0
    v_pk_max_i16 v75, v75, 0
    v_mul_f32 v68, v68, |v68|
    v_mul_f32 v69, v69, |v69|
    v_mul_f32 v70, v70, |v70|
    v_mul_f32 v71, v71, |v71|
    v_cvt_pk_bf16_f32 v66, v68, v69
    v_cvt_pk_bf16_f32 v67, v70, v71
    v_pk_max_i16 v66, v66, 0
    v_pk_max_i16 v67, v67, 0
    v_mul_f32 v88, v88, |v88|
    v_mul_f32 v89, v89, |v89|
    v_mul_f32 v90, v90, |v90|
    v_mul_f32 v91, v91, |v91|
    v_cvt_pk_bf16_f32 v88, v88, v89
    v_cvt_pk_bf16_f32 v89, v90, v91
    v_pk_max_i16 v88, v88, 0
    v_pk_max_i16 v89, v89, 0
    v_mul_f32 v80, v80, |v80|
    v_mul_f32 v81, v81, |v81|
    v_mul_f32 v82, v82, |v82|
    v_mul_f32 v83, v83, |v83|
    v_cvt_pk_bf16_f32 v80, v80, v81
    v_cvt_pk_bf16_f32 v81, v82, v83
    v_pk_max_i16 v80, v80, 0
    v_pk_max_i16 v81, v81, 0
    v_mul_f32 v92, v92, |v92|
    v_mul_f32 v93, v93, |v93|
    v_mul_f32 v94, v94, |v94|
    v_mul_f32 v95, v95, |v95|
    v_cvt_pk_bf16_f32 v90, v92, v93
    v_cvt_pk_bf16_f32 v91, v94, v95
    v_pk_max_i16 v90, v90, 0
    v_pk_max_i16 v91, v91, 0
    v_mul_f32 v84, v84, |v84|
    v_mul_f32 v85, v85, |v85|
    v_mul_f32 v86, v86, |v86|
    v_mul_f32 v87, v87, |v87|
    v_cvt_pk_bf16_f32 v82, v84, v85
    v_cvt_pk_bf16_f32 v83, v86, v87
    v_pk_max_i16 v82, v82, 0
    v_pk_max_i16 v83, v83, 0
    s_setprio 0
Lgemm:
    v_lshlrev_b32 v248, 4, v0
    v_add_u32 v249, 4096, v248
    s_lshl_b32 s57, s62, 11
    s_add_u32 s57, s57, 147456
    v_add_u32 v12, s57, v248
    v_and_b32 v13, 15, v0
    v_lshlrev_b32 v13, 2, v13
    v_mov_b32 v14, 0
    v_mov_b32 v15, 1
    v_mov_b32 v16, -1
    v_mov_b32 v17, -1
    v_mov_b32 v18, -1
    v_mov_b32 v19, -1
    s_barrier
    s_mov_b32 s64, 524288
    s_setprio 3
Lpoll_22:
    buffer_load_dword v2, v11, s[20:23], 0 offen sc1
    s_sub_u32 s64, s64, 1
    s_cbranch_scc1 Lpolld_23
    s_waitcnt vmcnt(0)
    v_cmp_ne_u32 vcc, 1, v2
    s_cbranch_vccz Lpolld_23
    s_sleep 2
    s_branch Lpoll_22
Lpolld_23:
    s_waitcnt vmcnt(0)
    s_setprio 0
    s_mul_i32 s58, s74, 5120
    s_add_u32 s58, s58, s73
    s_add_u32 m0, s75, 24576
    s_add_u32 s57, s58, 0
    buffer_load_dwordx4 v248, s[20:23], s57 offen sc1 lds
    s_add_u32 m0, s75, 25600
    s_add_u32 s57, s58, 1024
    buffer_load_dwordx4 v248, s[20:23], s57 offen sc1 lds
    s_add_u32 m0, s75, 27648
    s_add_u32 s57, s58, 2560
    buffer_load_dwordx4 v248, s[20:23], s57 offen sc1 lds
    s_add_u32 m0, s75, 28672
    s_add_u32 s57, s58, 3584
    buffer_load_dwordx4 v248, s[20:23], s57 offen sc1 lds
    s_mov_b32 exec_hi, 0
    s_add_u32 m0, s75, 26624
    s_add_u32 s57, s58, 2048
    buffer_load_dwordx4 v248, s[20:23], s57 offen sc1 lds
    s_add_u32 m0, s75, 29696
    s_add_u32 s57, s58, 4608
    buffer_load_dwordx4 v248, s[20:23], s57 offen sc1 lds
    s_mov_b32 exec_hi, -1
    s_add_u32 s74, s74, 4
    s_and_b32 s74, s74, 31
    s_mul_i32 s58, s74, 5120
    s_add_u32 s58, s58, s73
    s_add_u32 m0, s75, 49152
    s_add_u32 s57, s58, 0
    buffer_load_dwordx4 v248, s[20:23], s57 offen sc1 lds
    s_add_u32 m0, s75, 50176
    s_add_u32 s57, s58, 1024
    buffer_load_dwordx4 v248, s[20:23], s57 offen sc1 lds
    s_add_u32 m0, s75, 52224
    s_add_u32 s57, s58, 2560
    buffer_load_dwordx4 v248, s[20:23], s57 offen sc1 lds
    s_add_u32 m0, s75, 53248
    s_add_u32 s57, s58, 3584
    buffer_load_dwordx4 v248, s[20:23], s57 offen sc1 lds
    s_mov_b32 exec_hi, 0
    s_add_u32 m0, s75, 51200
    s_add_u32 s57, s58, 2048
    buffer_load_dwordx4 v248, s[20:23], s57 offen sc1 lds
    s_add_u32 m0, s75, 54272
    s_add_u32 s57, s58, 4608
    buffer_load_dwordx4 v248, s[20:23], s57 offen sc1 lds
    s_mov_b32 exec_hi, -1
    s_add_u32 s74, s74, 4
    s_and_b32 s74, s74, 31
    s_waitcnt vmcnt(0)
    s_cmp_eq_u32 s48, 2130706432
    s_cbranch_scc1 Lnopk_24
    s_mov_b32 exec_hi, 0xff
    s_mov_b32 s58, s99
    s_add_u32 m0, s75, 122880
    s_add_u32 s57, s58, 0
    buffer_load_dwordx4 v3, s[52:55], s57 offen  lds
    s_mov_b32 s58, s99
    s_add_u32 s58, s58, s98
    s_add_u32 m0, s75, 123520
    s_add_u32 s57, s58, 0
    buffer_load_dwordx4 v3, s[52:55], s57 offen  lds
    s_mov_b32 s58, s99
    s_add_u32 s58, s58, s97
    s_add_u32 m0, s75, 124160
    s_add_u32 s57, s58, 0
    buffer_load_dwordx4 v3, s[52:55], s57 offen  lds
    s_mov_b32 s58, s99
    s_add_u32 s58, s58, s97
    s_add_u32 s58, s58, s98
    s_add_u32 m0, s75, 124800
    s_add_u32 s57, s58, 0
    buffer_load_dwordx4 v3, s[52:55], s57 offen  lds
    s_mov_b32 s58, s99
    s_add_u32 s58, s58, s96
    s_add_u32 m0, s75, 125952
    s_add_u32 s57, s58, 0
    buffer_load_dwordx4 v3, s[52:55], s57 offen  lds
    s_mov_b32 s58, s99
    s_add_u32 s58, s58, s96
    s_add_u32 s58, s58, s98
    s_add_u32 m0, s75, 126592
    s_add_u32 s57, s58, 0
    buffer_load_dwordx4 v3, s[52:55], s57 offen  lds
    s_mov_b32 s58, s99
    s_add_u32 s58, s58, s96
    s_add_u32 s58, s58, s97
    s_add_u32 m0, s75, 127232
    s_add_u32 s57, s58, 0
    buffer_load_dwordx4 v3, s[52:55], s57 offen  lds
    s_mov_b32 s58, s99
    s_add_u32 s58, s58, s96
    s_add_u32 s58, s58, s97
    s_add_u32 s58, s58, s98
    s_add_u32 m0, s75, 127872
    s_add_u32 s57, s58, 0
    buffer_load_dwordx4 v3, s[52:55], s57 offen  lds
    s_mov_b32 exec_hi, -1
Lnopk_24:
    s_barrier
    ds_read_b128 v[4:7], v12 offset:1024
    ds_read_b128 v[0:3], v12
    s_mul_i32 s58, s74, 5120
    s_add_u32 s58, s58, s73
    s_add_u32 m0, s75, 73728
    s_add_u32 s57, s58, 0
    buffer_load_dwordx4 v248, s[20:23], s57 offen sc1 lds
    s_add_u32 m0, s75, 74752
    s_add_u32 s57, s58, 1024
    buffer_load_dwordx4 v248, s[20:23], s57 offen sc1 lds
    s_add_u32 m0, s75, 76800
    s_add_u32 s57, s58, 2560
    buffer_load_dwordx4 v248, s[20:23], s57 offen sc1 lds
    s_add_u32 m0, s75, 77824
    s_add_u32 s57, s58, 3584
    buffer_load_dwordx4 v248, s[20:23], s57 offen sc1 lds
    s_mov_b32 exec_hi, 0
    s_add_u32 m0, s75, 75776
    s_add_u32 s57, s58, 2048
    buffer_load_dwordx4 v248, s[20:23], s57 offen sc1 lds
    s_add_u32 m0, s75, 78848
    s_add_u32 s57, s58, 4608
    buffer_load_dwordx4 v248, s[20:23], s57 offen sc1 lds
    s_mov_b32 exec_hi, -1
    s_add_u32 s74, s74, 4
    s_and_b32 s74, s74, 31
    s_mul_i32 s58, s74, 5120
    s_add_u32 s58, s58, s73
    s_add_u32 m0, s75, 98304
    s_add_u32 s57, s58, 0
    buffer_load_dwordx4 v248, s[20:23], s57 offen sc1 lds
    s_add_u32 m0, s75, 99328
    s_add_u32 s57, s58, 1024
    buffer_load_dwordx4 v248, s[20:23], s57 offen sc1 lds
    s_add_u32 m0, s75, 101376
    s_add_u32 s57, s58, 2560
    buffer_load_dwordx4 v248, s[20:23], s57 offen sc1 lds
    s_add_u32 m0, s75, 102400
    s_add_u32 s57, s58, 3584
    buffer_load_dwordx4 v248, s[20:23], s57 offen sc1 lds
    s_mov_b32 exec_hi, 0
    s_add_u32 m0, s75, 100352
    s_add_u32 s57, s58, 2048
    buffer_load_dwordx4 v248, s[20:23], s57 offen sc1 lds
    s_add_u32 m0, s75, 103424
    s_add_u32 s57, s58, 4608
    buffer_load_dwordx4 v248, s[20:23], s57 offen sc1 lds
    s_mov_b32 exec_hi, -1
    s_add_u32 s74, s74, 4
    s_and_b32 s74, s74, 31
    s_waitcnt vmcnt(12) lgkmcnt(0)
    ds_read_b64_tr_b16 v[96:97], v5 offset:0
    ds_read_b64_tr_b16 v[98:99], v5 offset:3072
    ds_read_b64_tr_b16 v[100:101], v5 offset:32
    ds_read_b64_tr_b16 v[102:103], v5 offset:3104
    ds_read_b64_tr_b16 v[104:105], v5 offset:64
    ds_read_b64_tr_b16 v[106:107], v5 offset:3136
    ds_read_b64_tr_b16 v[108:109], v5 offset:96
    ds_read_b64_tr_b16 v[110:111], v5 offset:3168
    ds_read_b64_tr_b16 v[112:113], v5 offset:128
    ds_read_b64_tr_b16 v[114:115], v5 offset:3200
    ds_read_b64 v[250:251], v12 offset:1032
    ds_read_b64 v[6:7], v12 offset:8192
    s_waitcnt lgkmcnt(0)
    s_mul_i32 s58, s74, 5120
    s_add_u32 s58, s58, s73
    s_add_u32 m0, s75, 122880
    s_add_u32 s57, s58, 0
    buffer_load_dwordx4 v248, s[20:23], s57 offen sc1 lds
    s_add_u32 m0, s75, 123904
    s_add_u32 s57, s58, 1024
    buffer_load_dwordx4 v248, s[20:23], s57 offen sc1 lds
    s_add_u32 m0, s75, 125952
    s_add_u32 s57, s58, 2560
    buffer_load_dwordx4 v248, s[20:23], s57 offen sc1 lds
    s_add_u32 m0, s75, 126976
    s_add_u32 s57, s58, 3584
    buffer_load_dwordx4 v248, s[20:23], s57 offen sc1 lds
    s_mov_b32 exec_hi, 0
    s_add_u32 m0, s75, 124928
    s_add_u32 s57, s58, 2048
    buffer_load_dwordx4 v248, s[20:23], s57 offen sc1 lds
    s_add_u32 m0, s75, 128000
    s_add_u32 s57, s58, 4608
    buffer_load_dwordx4 v248, s[20:23], s57 offen sc1 lds
    s_mov_b32 exec_hi, -1
    s_add_u32 s74, s74, 4
    s_and_b32 s74, s74, 31
    s_add_u32 s57, s66, 0
    buffer_store_dwordx4 v[32:35], v248, s[20:23], s57 offen sc1
    s_add_u32 s57, s66, 55296
    buffer_store_dwordx4 v[40:43], v248, s[20:23], s57 offen sc1
    s_add_u32 s57, s66, 1024
    buffer_store_dwordx4 v[48:51], v248, s[20:23], s57 offen sc1
    s_add_u32 s57, s66, 56320
    buffer_store_dwordx4 v[56:59], v248, s[20:23], s57 offen sc1
    s_add_u32 s57, s65, 2048
    buffer_store_dwordx4 v[64:67], v248, s[20:23], s57 offen sc1
    s_add_u32 s57, s65, 57344
    buffer_store_dwordx4 v[72:75], v248, s[20:23], s57 offen sc1
    s_add_u32 s57, s65, 3072
    buffer_store_dwordx4 v[80:83], v248, s[20:23], s57 offen sc1
    s_add_u32 s57, s65, 58368
    buffer_store_dwordx4 v[88:91], v248, s[20:23], s57 offen sc1
    s_cmp_eq_u32 s48, 2130706432
    s_cbranch_scc1 Lnops_25
    buffer_store_dwordx4 v[96:99], v248, s[20:23], s48 offen offset:0 sc1
    buffer_store_dwordx4 v[100:103], v248, s[20:23], s48 offen offset:1024 sc1
    buffer_store_dwordx4 v[104:107], v248, s[20:23], s48 offen offset:2048 sc1
    buffer_store_dwordx4 v[108:111], v248, s[20:23], s48 offen offset:3072 sc1
    buffer_store_dwordx4 v[112:115], v249, s[20:23], s48 offen offset:0 sc1
Lnops_25:
    s_lshl_b32 s57, s76, 6
    s_add_u32 s96, s57, 393216
    s_mul_i32 s57, s76, 20480
    s_mul_i32 s58, s62, 5120
    s_add_u32 s57, s57, s58
    s_add_u32 s36, s57, 16777216
    s_mul_i32 s76, s76, 54
    s_add_u32 s76, s76, s62
    s_lshl_b32 s76, s76, 10
    s_add_u32 s76, s76, 9437184
    s_lshl_b32 s57, s77, 6
    s_add_u32 s97, s57, 393216
    s_mul_i32 s57, s77, 20480
    s_mul_i32 s58, s62, 5120
    s_add_u32 s57, s57, s58
    s_add_u32 s37, s57, 16777216
    s_mul_i32 s77, s77, 54
    s_add_u32 s77, s77, s62
    s_lshl_b32 s77, s77, 10
    s_add_u32 s77, s77, 9437184
    s_lshl_b32 s57, s78, 6
    s_add_u32 s98, s57, 393216
    s_mul_i32 s57, s78, 20480
    s_mul_i32 s58, s62, 5120
    s_add_u32 s57, s57, s58
    s_add_u32 s38, s57, 16777216
    s_mul_i32 s78, s78, 54
    s_add_u32 s78, s78, s62
    s_lshl_b32 s78, s78, 10
    s_add_u32 s78, s78, 9437184
    s_lshl_b32 s57, s79, 6
    s_add_u32 s99, s57, 393216
    s_mul_i32 s57, s79, 20480
    s_mul_i32 s58, s62, 5120
    s_add_u32 s57, s57, s58
    s_add_u32 s39, s57, 16777216
    s_mul_i32 s79, s79, 54
    s_add_u32 s79, s79, s62
    s_lshl_b32 s79, s79, 10
    s_add_u32 s79, s79, 9437184
    s_mul_i32 s70, s62, 40960
    s_mul_i32 s57, s61, 5120
    s_add_u32 s70, s70, s57
    s_add_u32 s70, s70, 19398656
    s_mul_i32 s72, s62, 163840
    s_add_u32 s72, s72, s70
    s_add_u32 s72, s72, 2211840
    s_mul_i32 s71, s62, 20480
    s_lshl_b32 s50, s62, 12
    s_waitcnt vmcnt(0)
    s_mov_b64 exec, 1
    buffer_store_dword v15, v14, s[20:23], s51 offen sc1
    s_mov_b64 exec, -1
    s_lshl_b32 s59, s6, 2
    s_add_u32 s59, s59, s62
    s_mul_i32 s67, s59, 81920
    s_lshr_b32 s68, s7, 3
    s_mul_i32 s68, s68, 5120
    s_add_u32 s67, s67, s68
    s_add_u32 s67, s67, 16777216
    s_add_u32 s68, s67, 20480
    s_lshl_b32 s59, s59, 5
    s_add_u32 s59, s59, s7
    s_lshl_b32 s59, s59, 7
    s_add_u32 s49, s59, 262144
    buffer_store_dwordx4 v[16:19], v6, s[20:23], s67 offen sc1
    buffer_store_dwordx4 v[16:19], v6, s[20:23], s68 offen sc1
    s_mov_b32 exec_hi, 0
    buffer_store_dwordx2 v[16:17], v7, s[20:23], s67 offen sc1
    buffer_store_dwordx2 v[16:17], v7, s[20:23], s68 offen sc1
    s_mov_b32 exec_hi, -1
    s_barrier
    s_mov_b32 s64, 524288
    s_setprio 3
Lpoll_26:
    buffer_load_dword v12, v4, s[20:23], 0 offen sc1
    s_sub_u32 s64, s64, 1
    s_cbranch_scc1 Lpolld_27
    s_waitcnt vmcnt(0)
    v_cmp_ne_u32 vcc, 1, v12
    s_cbranch_vccz Lpolld_27
    s_sleep 12
    s_branch Lpoll_26
Lpolld_27:
    s_waitcnt vmcnt(0)
    s_setprio 0
    s_mov_b64 exec, 1
    buffer_store_dword v15, v14, s[20:23], s49 offen sc1
    s_mov_b64 exec, -1
    buffer_load_dwordx4 v[24:27], v248, s[20:23], s70 offen offset:0 sc1
    buffer_load_dwordx4 v[28:31], v248, s[20:23], s70 offen offset:1024 sc1
    buffer_load_dwordx4 v[32:35], v248, s[20:23], s70 offen offset:2048 sc1
    buffer_load_dwordx4 v[36:39], v248, s[20:23], s70 offen offset:3072 sc1
    buffer_load_dwordx4 v[40:43], v249, s[20:23], s70 offen offset:0 sc1
    buffer_load_dwordx4 v[44:47], v248, s[20:23], s76 offen sc1
    s_add_u32 s76, s76, 4096
    buffer_load_dwordx4 v[48:51], v248, s[20:23], s77 offen sc1
    s_add_u32 s77, s77, 4096
    buffer_load_dwordx4 v[52:55], v248, s[20:23], s78 offen sc1
    s_add_u32 s78, s78, 4096
    buffer_load_dwordx4 v[56:59], v248, s[20:23], s79 offen sc1
    s_add_u32 s79, s79, 4096
    s_add_u32 s70, s70, 163840
    buffer_load_dwordx4 v[60:63], v248, s[20:23], s70 offen offset:0 sc1
    buffer_load_dwordx4 v[144:147], v248, s[20:23], s70 offen offset:1024 sc1
    buffer_load_dwordx4 v[148:151], v248, s[20:23], s70 offen offset:2048 sc1
    buffer_load_dwordx4 v[152:155], v248, s[20:23], s70 offen offset:3072 sc1
    buffer_load_dwordx4 v[156:159], v249, s[20:23], s70 offen offset:0 sc1
    buffer_load_dwordx4 v[160:163], v248, s[20:23], s76 offen sc1
    s_add_u32 s76, s76, 4096
    buffer_load_dwordx4 v[164:167], v248, s[20:23], s77 offen sc1
    s_add_u32 s77, s77, 4096
    buffer_load_dwordx4 v[168:171], v248, s[20:23], s78 offen sc1
    s_add_u32 s78, s78, 4096
    buffer_load_dwordx4 v[172:175], v248, s[20:23], s79 offen sc1
    s_add_u32 s79, s79, 4096
    s_add_u32 s70, s70, 163840
    s_waitcnt vmcnt(9)
    v_mfma_f32_16x16x32_bf16 v[64:67], v[24:27], v[44:47], 0
    buffer_load_dwordx4 v[176:179], v248, s[20:23], s70 offen offset:0 sc1
    v_mfma_f32_16x16x32_bf16 v[84:87], v[24:27], v[48:51], 0
    v_mfma_f32_16x16x32_bf16 v[104:107], v[24:27], v[52:55], 0
    buffer_load_dwordx4 v[180:183], v248, s[20:23], s70 offen offset:1024 sc1
    v_mfma_f32_16x16x32_bf16 v[124:127], v[24:27], v[56:59], 0
    v_mfma_f32_16x16x32_bf16 v[68:71], v[28:31], v[44:47], 0
    buffer_load_dwordx4 v[184:187], v248, s[20:23], s70 offen offset:2048 sc1
    v_mfma_f32_16x16x32_bf16 v[88:91], v[28:31], v[48:51], 0
    v_mfma_f32_16x16x32_bf16 v[108:111], v[28:31], v[52:55], 0
    buffer_load_dwordx4 v[188:191], v248, s[20:23], s70 offen offset:3072 sc1
    v_mfma_f32_16x16x32_bf16 v[128:131], v[28:31], v[56:59], 0
    v_mfma_f32_16x16x32_bf16 v[72:75], v[32:35], v[44:47], 0
    buffer_load_dwordx4 v[192:195], v249, s[20:23], s70 offen offset:0 sc1
    v_mfma_f32_16x16x32_bf16 v[92:95], v[32:35], v[48:51], 0
    v_mfma_f32_16x16x32_bf16 v[112:115], v[32:35], v[52:55], 0
    buffer_load_dwordx4 v[196:199], v248, s[20:23], s76 offen sc1
    s_add_u32 s76, s76, 4096
    v_mfma_f32_16x16x32_bf16 v[132:135], v[32:35], v[56:59], 0
    v_mfma_f32_16x16x32_bf16 v[76:79], v[36:39], v[44:47], 0
    buffer_load_dwordx4 v[200:203], v248, s[20:23], s77 offen sc1
    s_add_u32 s77, s77, 4096
    v_mfma_f32_16x16x32_bf16 v[96:99], v[36:39], v[48:51], 0
    v_mfma_f32_16x16x32_bf16 v[116:119], v[36:39], v[52:55], 0
    buffer_load_dwordx4 v[204:207], v248, s[20:23], s78 offen sc1
    s_add_u32 s78, s78, 4096
    v_mfma_f32_16x16x32_bf16 v[136:139], v[36:39], v[56:59], 0
    v_mfma_f32_16x16x32_bf16 v[80:83], v[40:43], v[44:47], 0
    buffer_load_dwordx4 v[208:211], v248, s[20:23], s79 offen sc1
    s_add_u32 s79, s79, 4096
    s_add_u32 s70, s70, 163840
    v_mfma_f32_16x16x32_bf16 v[100:103], v[40:43], v[48:51], 0
    v_mfma_f32_16x16x32_bf16 v[120:123], v[40:43], v[52:55], 0
    v_mfma_f32_16x16x32_bf16 v[140:143], v[40:43], v[56:59], 0
    buffer_load_dwordx4 v[212:215], v248, s[20:23], s70 offen offset:0 sc1
    buffer_load_dwordx4 v[216:219], v248, s[20:23], s70 offen offset:1024 sc1
    buffer_load_dwordx4 v[220:223], v248, s[20:23], s70 offen offset:2048 sc1
    buffer_load_dwordx4 v[224:227], v248, s[20:23], s70 offen offset:3072 sc1
    buffer_load_dwordx4 v[228:231], v249, s[20:23], s70 offen offset:0 sc1
    buffer_load_dwordx4 v[232:235], v248, s[20:23], s76 offen sc1
    s_add_u32 s76, s76, 4096
    buffer_load_dwordx4 v[236:239], v248, s[20:23], s77 offen sc1
    s_add_u32 s77, s77, 4096
    buffer_load_dwordx4 v[240:243], v248, s[20:23], s78 offen sc1
    s_add_u32 s78, s78, 4096
    buffer_load_dwordx4 v[244:247], v248, s[20:23], s79 offen sc1
    s_add_u32 s79, s79, 4096
    s_add_u32 s70, s70, 163840
    s_waitcnt vmcnt(18)
    v_mfma_f32_16x16x32_bf16 v[64:67], v[60:63], v[160:163], v[64:67]
    buffer_load_dwordx4 v[24:27], v248, s[20:23], s70 offen offset:0 sc1
    v_mfma_f32_16x16x32_bf16 v[84:87], v[60:63], v[164:167], v[84:87]
    v_mfma_f32_16x16x32_bf16 v[104:107], v[60:63], v[168:171], v[104:107]
    buffer_load_dwordx4 v[28:31], v248, s[20:23], s70 offen offset:1024 sc1
    v_mfma_f32_16x16x32_bf16 v[124:127], v[60:63], v[172:175], v[124:127]
    v_mfma_f32_16x16x32_bf16 v[68:71], v[144:147], v[160:163], v[68:71]
    buffer_load_dwordx4 v[32:35], v248, s[20:23], s70 offen offset:2048 sc1
    v_mfma_f32_16x16x32_bf16 v[88:91], v[144:147], v[164:167], v[88:91]
    v_mfma_f32_16x16x32_bf16 v[108:111], v[144:147], v[168:171], v[108:111]
    buffer_load_dwordx4 v[36:39], v248, s[20:23], s70 offen offset:3072 sc1
    v_mfma_f32_16x16x32_bf16 v[128:131], v[144:147], v[172:175], v[128:131]
    v_mfma_f32_16x16x32_bf16 v[72:75], v[148:151], v[160:163], v[72:75]
    buffer_load_dwordx4 v[40:43], v249, s[20:23], s70 offen offset:0 sc1
    v_mfma_f32_16x16x32_bf16 v[92:95], v[148:151], v[164:167], v[92:95]
    v_mfma_f32_16x16x32_bf16 v[112:115], v[148:151], v[168:171], v[112:115]
    buffer_load_dwordx4 v[44:47], v248, s[20:23], s76 offen sc1
    s_add_u32 s76, s76, 4096
    v_mfma_f32_16x16x32_bf16 v[132:135], v[148:151], v[172:175], v[132:135]
    v_mfma_f32_16x16x32_bf16 v[76:79], v[152:155], v[160:163], v[76:79]
    buffer_load_dwordx4 v[48:51], v248, s[20:23], s77 offen sc1
    s_add_u32 s77, s77, 4096
    v_mfma_f32_16x16x32_bf16 v[96:99], v[152:155], v[164:167], v[96:99]
    v_mfma_f32_16x16x32_bf16 v[116:119], v[152:155], v[168:171], v[116:119]
    buffer_load_dwordx4 v[52:55], v248, s[20:23], s78 offen sc1
    s_add_u32 s78, s78, 4096
    v_mfma_f32_16x16x32_bf16 v[136:139], v[152:155], v[172:175], v[136:139]
    v_mfma_f32_16x16x32_bf16 v[80:83], v[156:159], v[160:163], v[80:83]
    buffer_load_dwordx4 v[56:59], v248, s[20:23], s79 offen sc1
    s_add_u32 s79, s79, 4096
    s_add_u32 s70, s70, 163840
    v_mfma_f32_16x16x32_bf16 v[100:103], v[156:159], v[164:167], v[100:103]
    v_mfma_f32_16x16x32_bf16 v[120:123], v[156:159], v[168:171], v[120:123]
    v_mfma_f32_16x16x32_bf16 v[140:143], v[156:159], v[172:175], v[140:143]
    s_mul_i32 s58, s74, 5120
    s_add_u32 s58, s58, s73
    s_add_u32 m0, s75, 0
    s_add_u32 s57, s58, 0
    buffer_load_dwordx4 v248, s[20:23], s57 offen sc1 lds
    s_add_u32 m0, s75, 1024
    s_add_u32 s57, s58, 1024
    buffer_load_dwordx4 v248, s[20:23], s57 offen sc1 lds
    s_add_u32 m0, s75, 3072
    s_add_u32 s57, s58, 2560
    buffer_load_dwordx4 v248, s[20:23], s57 offen sc1 lds
    s_add_u32 m0, s75, 4096
    s_add_u32 s57, s58, 3584
    buffer_load_dwordx4 v248, s[20:23], s57 offen sc1 lds
    s_mov_b32 exec_hi, 0
    s_add_u32 m0, s75, 2048
    s_add_u32 s57, s58, 2048
    buffer_load_dwordx4 v248, s[20:23], s57 offen sc1 lds
    s_add_u32 m0, s75, 5120
    s_add_u32 s57, s58, 4608
    buffer_load_dwordx4 v248, s[20:23], s57 offen sc1 lds
    s_mov_b32 exec_hi, -1
    s_add_u32 s74, s74, 4
    s_and_b32 s74, s74, 31
    s_mul_i32 s58, s74, 5120
    s_add_u32 s58, s58, s73
    s_add_u32 m0, s75, 24576
    s_add_u32 s57, s58, 0
    buffer_load_dwordx4 v248, s[20:23], s57 offen sc1 lds
    s_add_u32 m0, s75, 25600
    s_add_u32 s57, s58, 1024
    buffer_load_dwordx4 v248, s[20:23], s57 offen sc1 lds
    s_add_u32 m0, s75, 27648
    s_add_u32 s57, s58, 2560
    buffer_load_dwordx4 v248, s[20:23], s57 offen sc1 lds
    s_add_u32 m0, s75, 28672
    s_add_u32 s57, s58, 3584
    buffer_load_dwordx4 v248, s[20:23], s57 offen sc1 lds
    s_mov_b32 exec_hi, 0
    s_add_u32 m0, s75, 26624
    s_add_u32 s57, s58, 2048
    buffer_load_dwordx4 v248, s[20:23], s57 offen sc1 lds
    s_add_u32 m0, s75, 29696
    s_add_u32 s57, s58, 4608
    buffer_load_dwordx4 v248, s[20:23], s57 offen sc1 lds
    s_mov_b32 exec_hi, -1
    s_add_u32 s74, s74, 4
    s_and_b32 s74, s74, 31
    buffer_load_dword v252, v13, s[20:23], s96 offen sc1
    buffer_load_dword v253, v13, s[20:23], s97 offen sc1
    buffer_load_dword v254, v13, s[20:23], s98 offen sc1
    buffer_load_dword v255, v13, s[20:23], s99 offen sc1
    s_waitcnt vmcnt(34)
    v_mfma_f32_16x16x32_bf16 v[64:67], v[176:179], v[196:199], v[64:67]
    buffer_load_dwordx4 v[60:63], v248, s[20:23], s70 offen offset:0 sc1
    v_mfma_f32_16x16x32_bf16 v[84:87], v[176:179], v[200:203], v[84:87]
    v_mfma_f32_16x16x32_bf16 v[104:107], v[176:179], v[204:207], v[104:107]
    buffer_load_dwordx4 v[144:147], v248, s[20:23], s70 offen offset:1024 sc1
    v_mfma_f32_16x16x32_bf16 v[124:127], v[176:179], v[208:211], v[124:127]
    v_mfma_f32_16x16x32_bf16 v[68:71], v[180:183], v[196:199], v[68:71]
    buffer_load_dwordx4 v[148:151], v248, s[20:23], s70 offen offset:2048 sc1
    v_mfma_f32_16x16x32_bf16 v[88:91], v[180:183], v[200:203], v[88:91]
    v_mfma_f32_16x16x32_bf16 v[108:111], v[180:183], v[204:207], v[108:111]
    buffer_load_dwordx4 v[152:155], v248, s[20:23], s70 offen offset:3072 sc1
    v_mfma_f32_16x16x32_bf16 v[128:131], v[180:183], v[208:211], v[128:131]
    v_mfma_f32_16x16x32_bf16 v[72:75], v[184:187], v[196:199], v[72:75]
    buffer_load_dwordx4 v[156:159], v249, s[20:23], s70 offen offset:0 sc1
    v_mfma_f32_16x16x32_bf16 v[92:95], v[184:187], v[200:203], v[92:95]
    v_mfma_f32_16x16x32_bf16 v[112:115], v[184:187], v[204:207], v[112:115]
    buffer_load_dwordx4 v[160:163], v248, s[20:23], s76 offen sc1
    s_add_u32 s76, s76, 4096
    v_mfma_f32_16x16x32_bf16 v[132:135], v[184:187], v[208:211], v[132:135]
    v_mfma_f32_16x16x32_bf16 v[76:79], v[188:191], v[196:199], v[76:79]
    buffer_load_dwordx4 v[164:167], v248, s[20:23], s77 offen sc1
    s_add_u32 s77, s77, 4096
    v_mfma_f32_16x16x32_bf16 v[96:99], v[188:191], v[200:203], v[96:99]
    v_mfma_f32_16x16x32_bf16 v[116:119], v[188:191], v[204:207], v[116:119]
    buffer_load_dwordx4 v[168:171], v248, s[20:23], s78 offen sc1
    s_add_u32 s78, s78, 4096
    v_mfma_f32_16x16x32_bf16 v[136:139], v[188:191], v[208:211], v[136:139]
    v_mfma_f32_16x16x32_bf16 v[80:83], v[192:195], v[196:199], v[80:83]
    buffer_load_dwordx4 v[172:175], v248, s[20:23], s79 offen sc1
    s_add_u32 s79, s79, 4096
    s_add_u32 s70, s70, 163840
    v_mfma_f32_16x16x32_bf16 v[100:103], v[192:195], v[200:203], v[100:103]
    v_mfma_f32_16x16x32_bf16 v[120:123], v[192:195], v[204:207], v[120:123]
    v_mfma_f32_16x16x32_bf16 v[140:143], v[192:195], v[208:211], v[140:143]
    s_waitcnt vmcnt(34)
    v_mfma_f32_16x16x32_bf16 v[64:67], v[212:215], v[232:235], v[64:67]
    buffer_load_dwordx4 v[176:179], v248, s[20:23], s70 offen offset:0 sc1
    v_mfma_f32_16x16x32_bf16 v[84:87], v[212:215], v[236:239], v[84:87]
    v_mfma_f32_16x16x32_bf16 v[104:107], v[212:215], v[240:243], v[104:107]
    buffer_load_dwordx4 v[180:183], v248, s[20:23], s70 offen offset:1024 sc1
    v_mfma_f32_16x16x32_bf16 v[124:127], v[212:215], v[244:247], v[124:127]
    v_mfma_f32_16x16x32_bf16 v[68:71], v[216:219], v[232:235], v[68:71]
    buffer_load_dwordx4 v[184:187], v248, s[20:23], s70 offen offset:2048 sc1
    v_mfma_f32_16x16x32_bf16 v[88:91], v[216:219], v[236:239], v[88:91]
    v_mfma_f32_16x16x32_bf16 v[108:111], v[216:219], v[240:243], v[108:111]
    buffer_load_dwordx4 v[188:191], v248, s[20:23], s70 offen offset:3072 sc1
    v_mfma_f32_16x16x32_bf16 v[128:131], v[216:219], v[244:247], v[128:131]
    v_mfma_f32_16x16x32_bf16 v[72:75], v[220:223], v[232:235], v[72:75]
    buffer_load_dwordx4 v[192:195], v249, s[20:23], s70 offen offset:0 sc1
    v_mfma_f32_16x16x32_bf16 v[92:95], v[220:223], v[236:239], v[92:95]
    v_mfma_f32_16x16x32_bf16 v[112:115], v[220:223], v[240:243], v[112:115]
    buffer_load_dwordx4 v[196:199], v248, s[20:23], s76 offen sc1
    s_add_u32 s76, s76, 4096
    v_mfma_f32_16x16x32_bf16 v[132:135], v[220:223], v[244:247], v[132:135]
    v_mfma_f32_16x16x32_bf16 v[76:79], v[224:227], v[232:235], v[76:79]
    buffer_load_dwordx4 v[200:203], v248, s[20:23], s77 offen sc1
    s_add_u32 s77, s77, 4096
    v_mfma_f32_16x16x32_bf16 v[96:99], v[224:227], v[236:239], v[96:99]
    v_mfma_f32_16x16x32_bf16 v[116:119], v[224:227], v[240:243], v[116:119]
    buffer_load_dwordx4 v[204:207], v248, s[20:23], s78 offen sc1
    s_add_u32 s78, s78, 4096
    v_mfma_f32_16x16x32_bf16 v[136:139], v[224:227], v[244:247], v[136:139]
    v_mfma_f32_16x16x32_bf16 v[80:83], v[228:231], v[232:235], v[80:83]
    buffer_load_dwordx4 v[208:211], v248, s[20:23], s79 offen sc1
    s_add_u32 s79, s79, 4096
    s_add_u32 s70, s70, 163840
    v_mfma_f32_16x16x32_bf16 v[100:103], v[228:231], v[236:239], v[100:103]
    v_mfma_f32_16x16x32_bf16 v[120:123], v[228:231], v[240:243], v[120:123]
    v_mfma_f32_16x16x32_bf16 v[140:143], v[228:231], v[244:247], v[140:143]
    s_waitcnt vmcnt(34)
    v_mfma_f32_16x16x32_bf16 v[64:67], v[24:27], v[44:47], v[64:67]
    buffer_load_dwordx4 v[212:215], v248, s[20:23], s70 offen offset:0 sc1
    v_mfma_f32_16x16x32_bf16 v[84:87], v[24:27], v[48:51], v[84:87]
    v_mfma_f32_16x16x32_bf16 v[104:107], v[24:27], v[52:55], v[104:107]
    buffer_load_dwordx4 v[216:219], v248, s[20:23], s70 offen offset:1024 sc1
    v_mfma_f32_16x16x32_bf16 v[124:127], v[24:27], v[56:59], v[124:127]
    v_mfma_f32_16x16x32_bf16 v[68:71], v[28:31], v[44:47], v[68:71]
    buffer_load_dwordx4 v[220:223], v248, s[20:23], s70 offen offset:2048 sc1
    v_mfma_f32_16x16x32_bf16 v[88:91], v[28:31], v[48:51], v[88:91]
    v_mfma_f32_16x16x32_bf16 v[108:111], v[28:31], v[52:55], v[108:111]
    buffer_load_dwordx4 v[224:227], v248, s[20:23], s70 offen offset:3072 sc1
    v_mfma_f32_16x16x32_bf16 v[128:131], v[28:31], v[56:59], v[128:131]
    v_mfma_f32_16x16x32_bf16 v[72:75], v[32:35], v[44:47], v[72:75]
    buffer_load_dwordx4 v[228:231], v249, s[20:23], s70 offen offset:0 sc1
    v_mfma_f32_16x16x32_bf16 v[92:95], v[32:35], v[48:51], v[92:95]
    v_mfma_f32_16x16x32_bf16 v[112:115], v[32:35], v[52:55], v[112:115]
    buffer_load_dwordx4 v[232:235], v248, s[20:23], s76 offen sc1
    s_add_u32 s76, s76, 4096
    v_mfma_f32_16x16x32_bf16 v[132:135], v[32:35], v[56:59], v[132:135]
    v_mfma_f32_16x16x32_bf16 v[76:79], v[36:39], v[44:47], v[76:79]
    buffer_load_dwordx4 v[236:239], v248, s[20:23], s77 offen sc1
    s_add_u32 s77, s77, 4096
    v_mfma_f32_16x16x32_bf16 v[96:99], v[36:39], v[48:51], v[96:99]
    v_mfma_f32_16x16x32_bf16 v[116:119], v[36:39], v[52:55], v[116:119]
    buffer_load_dwordx4 v[240:243], v248, s[20:23], s78 offen sc1
    s_add_u32 s78, s78, 4096
    v_mfma_f32_16x16x32_bf16 v[136:139], v[36:39], v[56:59], v[136:139]
    v_mfma_f32_16x16x32_bf16 v[80:83], v[40:43], v[44:47], v[80:83]
    buffer_load_dwordx4 v[244:247], v248, s[20:23], s79 offen sc1
    s_add_u32 s79, s79, 4096
    s_add_u32 s70, s70, 163840
    v_mfma_f32_16x16x32_bf16 v[100:103], v[40:43], v[48:51], v[100:103]
    v_mfma_f32_16x16x32_bf16 v[120:123], v[40:43], v[52:55], v[120:123]
    v_mfma_f32_16x16x32_bf16 v[140:143], v[40:43], v[56:59], v[140:143]
    s_waitcnt vmcnt(18)
    v_mfma_f32_16x16x32_bf16 v[64:67], v[60:63], v[160:163], v[64:67]
    buffer_load_dwordx4 v[24:27], v248, s[20:23], s70 offen offset:0 sc1
    v_mfma_f32_16x16x32_bf16 v[84:87], v[60:63], v[164:167], v[84:87]
    v_mfma_f32_16x16x32_bf16 v[104:107], v[60:63], v[168:171], v[104:107]
    buffer_load_dwordx4 v[28:31], v248, s[20:23], s70 offen offset:1024 sc1
    v_mfma_f32_16x16x32_bf16 v[124:127], v[60:63], v[172:175], v[124:127]
    v_mfma_f32_16x16x32_bf16 v[68:71], v[144:147], v[160:163], v[68:71]
    buffer_load_dwordx4 v[32:35], v248, s[20:23], s70 offen offset:2048 sc1
    v_mfma_f32_16x16x32_bf16 v[88:91], v[144:147], v[164:167], v[88:91]
    v_mfma_f32_16x16x32_bf16 v[108:111], v[144:147], v[168:171], v[108:111]
    buffer_load_dwordx4 v[36:39], v248, s[20:23], s70 offen offset:3072 sc1
    v_mfma_f32_16x16x32_bf16 v[128:131], v[144:147], v[172:175], v[128:131]
    v_mfma_f32_16x16x32_bf16 v[72:75], v[148:151], v[160:163], v[72:75]
    buffer_load_dwordx4 v[40:43], v249, s[20:23], s70 offen offset:0 sc1
    v_mfma_f32_16x16x32_bf16 v[92:95], v[148:151], v[164:167], v[92:95]
    v_mfma_f32_16x16x32_bf16 v[112:115], v[148:151], v[168:171], v[112:115]
    buffer_load_dwordx4 v[44:47], v248, s[20:23], s76 offen sc1
    s_add_u32 s76, s76, 4096
    v_mfma_f32_16x16x32_bf16 v[132:135], v[148:151], v[172:175], v[132:135]
    v_mfma_f32_16x16x32_bf16 v[76:79], v[152:155], v[160:163], v[76:79]
    buffer_load_dwordx4 v[48:51], v248, s[20:23], s77 offen sc1
    s_add_u32 s77, s77, 4096
    v_mfma_f32_16x16x32_bf16 v[96:99], v[152:155], v[164:167], v[96:99]
    v_mfma_f32_16x16x32_bf16 v[116:119], v[152:155], v[168:171], v[116:119]
    buffer_load_dwordx4 v[52:55], v248, s[20:23], s78 offen sc1
    s_add_u32 s78, s78, 4096
    v_mfma_f32_16x16x32_bf16 v[136:139], v[152:155], v[172:175], v[136:139]
    v_mfma_f32_16x16x32_bf16 v[80:83], v[156:159], v[160:163], v[80:83]
    buffer_load_dwordx4 v[56:59], v248, s[20:23], s79 offen sc1
    s_add_u32 s79, s79, 4096
    s_add_u32 s70, s70, 163840
    v_mfma_f32_16x16x32_bf16 v[100:103], v[156:159], v[164:167], v[100:103]
    v_mfma_f32_16x16x32_bf16 v[120:123], v[156:159], v[168:171], v[120:123]
    v_mfma_f32_16x16x32_bf16 v[140:143], v[156:159], v[172:175], v[140:143]
    s_barrier
    s_waitcnt vmcnt(18)
    v_mfma_f32_16x16x32_bf16 v[64:67], v[176:179], v[196:199], v[64:67]
    buffer_load_dwordx4 v[60:63], v248, s[20:23], s70 offen offset:0 sc1
    v_mfma_f32_16x16x32_bf16 v[84:87], v[176:179], v[200:203], v[84:87]
    v_mfma_f32_16x16x32_bf16 v[104:107], v[176:179], v[204:207], v[104:107]
    buffer_load_dwordx4 v[144:147], v248, s[20:23], s70 offen offset:1024 sc1
    v_mfma_f32_16x16x32_bf16 v[124:127], v[176:179], v[208:211], v[124:127]
    s_add_u32 m0, s71, 49152
    s_add_u32 s57, s72, 0
    buffer_load_dwordx4 v248, s[20:23], s57 offen sc1 lds
    v_mfma_f32_16x16x32_bf16 v[68:71], v[180:183], v[196:199], v[68:71]
    buffer_load_dwordx4 v[148:151], v248, s[20:23], s70 offen offset:2048 sc1
    v_mfma_f32_16x16x32_bf16 v[88:91], v[180:183], v[200:203], v[88:91]
    v_mfma_f32_16x16x32_bf16 v[108:111], v[180:183], v[204:207], v[108:111]
    buffer_load_dwordx4 v[152:155], v248, s[20:23], s70 offen offset:3072 sc1
    v_mfma_f32_16x16x32_bf16 v[128:131], v[180:183], v[208:211], v[128:131]
    s_add_u32 m0, s71, 50176
    s_add_u32 s57, s72, 1024
    buffer_load_dwordx4 v248, s[20:23], s57 offen sc1 lds
    v_mfma_f32_16x16x32_bf16 v[72:75], v[184:187], v[196:199], v[72:75]
    buffer_load_dwordx4 v[156:159], v249, s[20:23], s70 offen offset:0 sc1
    v_mfma_f32_16x16x32_bf16 v[92:95], v[184:187], v[200:203], v[92:95]
    v_mfma_f32_16x16x32_bf16 v[112:115], v[184:187], v[204:207], v[112:115]
    buffer_load_dwordx4 v[160:163], v248, s[20:23], s76 offen sc1
    s_add_u32 s76, s76, 4096
    v_mfma_f32_16x16x32_bf16 v[132:135], v[184:187], v[208:211], v[132:135]
    s_add_u32 m0, s71, 51200
    s_add_u32 s57, s72, 2048
    buffer_load_dwordx4 v248, s[20:23], s57 offen sc1 lds
    v_mfma_f32_16x16x32_bf16 v[76:79], v[188:191], v[196:199], v[76:79]
    buffer_load_dwordx4 v[164:167], v248, s[20:23], s77 offen sc1
    s_add_u32 s77, s77, 4096
    v_mfma_f32_16x16x32_bf16 v[96:99], v[188:191], v[200:203], v[96:99]
    v_mfma_f32_16x16x32_bf16 v[116:119], v[188:191], v[204:207], v[116:119]
    buffer_load_dwordx4 v[168:171], v248, s[20:23], s78 offen sc1
    s_add_u32 s78, s78, 4096
    v_mfma_f32_16x16x32_bf16 v[136:139], v[188:191], v[208:211], v[136:139]
    s_add_u32 m0, s71, 52224
    s_add_u32 s57, s72, 3072
    buffer_load_dwordx4 v248, s[20:23], s57 offen sc1 lds
    v_mfma_f32_16x16x32_bf16 v[80:83], v[192:195], v[196:199], v[80:83]
    buffer_load_dwordx4 v[172:175], v248, s[20:23], s79 offen sc1
    s_add_u32 s79, s79, 4096
    s_add_u32 s70, s70, 163840
    v_mfma_f32_16x16x32_bf16 v[100:103], v[192:195], v[200:203], v[100:103]
    v_mfma_f32_16x16x32_bf16 v[120:123], v[192:195], v[204:207], v[120:123]
    v_mfma_f32_16x16x32_bf16 v[140:143], v[192:195], v[208:211], v[140:143]
    s_add_u32 m0, s71, 53248
    s_add_u32 s57, s72, 4096
    buffer_load_dwordx4 v248, s[20:23], s57 offen sc1 lds
    s_waitcnt vmcnt(23)
    v_mfma_f32_16x16x32_bf16 v[64:67], v[212:215], v[232:235], v[64:67]
    buffer_load_dwordx4 v[176:179], v248, s[20:23], s70 offen offset:0 sc1
    v_mfma_f32_16x16x32_bf16 v[84:87], v[212:215], v[236:239], v[84:87]
    v_mfma_f32_16x16x32_bf16 v[104:107], v[212:215], v[240:243], v[104:107]
    buffer_load_dwordx4 v[180:183], v248, s[20:23], s70 offen offset:1024 sc1
    v_mfma_f32_16x16x32_bf16 v[124:127], v[212:215], v[244:247], v[124:127]
    s_add_u32 m0, s71, 54272
    s_add_u32 s57, s72, 40960
    buffer_load_dwordx4 v248, s[20:23], s57 offen sc1 lds
    v_mfma_f32_16x16x32_bf16 v[68:71], v[216:219], v[232:235], v[68:71]
    buffer_load_dwordx4 v[184:187], v248, s[20:23], s70 offen offset:2048 sc1
    v_mfma_f32_16x16x32_bf16 v[88:91], v[216:219], v[236:239], v[88:91]
    v_mfma_f32_16x16x32_bf16 v[108:111], v[216:219], v[240:243], v[108:111]
    buffer_load_dwordx4 v[188:191], v248, s[20:23], s70 offen offset:3072 sc1
    v_mfma_f32_16x16x32_bf16 v[128:131], v[216:219], v[244:247], v[128:131]
    s_add_u32 m0, s71, 55296
    s_add_u32 s57, s72, 41984
    buffer_load_dwordx4 v248, s[20:23], s57 offen sc1 lds
    v_mfma_f32_16x16x32_bf16 v[72:75], v[220:223], v[232:235], v[72:75]
    buffer_load_dwordx4 v[192:195], v249, s[20:23], s70 offen offset:0 sc1
    v_mfma_f32_16x16x32_bf16 v[92:95], v[220:223], v[236:239], v[92:95]
    v_mfma_f32_16x16x32_bf16 v[112:115], v[220:223], v[240:243], v[112:115]
    buffer_load_dwordx4 v[196:199], v248, s[20:23], s76 offen sc1
    s_add_u32 s76, s76, 4096
    v_mfma_f32_16x16x32_bf16 v[132:135], v[220:223], v[244:247], v[132:135]
    s_add_u32 m0, s71, 56320
    s_add_u32 s57, s72, 43008
    buffer_load_dwordx4 v248, s[20:23], s57 offen sc1 lds
    v_mfma_f32_16x16x32_bf16 v[76:79], v[224:227], v[232:235], v[76:79]
    buffer_load_dwordx4 v[200:203], v248, s[20:23], s77 offen sc1
    s_add_u32 s77, s77, 4096
    v_mfma_f32_16x16x32_bf16 v[96:99], v[224:227], v[236:239], v[96:99]
    v_mfma_f32_16x16x32_bf16 v[116:119], v[224:227], v[240:243], v[116:119]
    buffer_load_dwordx4 v[204:207], v248, s[20:23], s78 offen sc1
    s_add_u32 s78, s78, 4096
    v_mfma_f32_16x16x32_bf16 v[136:139], v[224:227], v[244:247], v[136:139]
    s_add_u32 m0, s71, 57344
    s_add_u32 s57, s72, 44032
    buffer_load_dwordx4 v248, s[20:23], s57 offen sc1 lds
    v_mfma_f32_16x16x32_bf16 v[80:83], v[228:231], v[232:235], v[80:83]
    buffer_load_dwordx4 v[208:211], v248, s[20:23], s79 offen sc1
    s_add_u32 s79, s79, 4096
    s_add_u32 s70, s70, 163840
    v_mfma_f32_16x16x32_bf16 v[100:103], v[228:231], v[236:239], v[100:103]
    v_mfma_f32_16x16x32_bf16 v[120:123], v[228:231], v[240:243], v[120:123]
    v_mfma_f32_16x16x32_bf16 v[140:143], v[228:231], v[244:247], v[140:143]
    s_add_u32 m0, s71, 58368
    s_add_u32 s57, s72, 45056
    buffer_load_dwordx4 v248, s[20:23], s57 offen sc1 lds
    s_waitcnt vmcnt(28)
    v_mfma_f32_16x16x32_bf16 v[64:67], v[24:27], v[44:47], v[64:67]
    buffer_load_dwordx4 v[212:215], v248, s[20:23], s70 offen offset:0 sc1
    v_mfma_f32_16x16x32_bf16 v[84:87], v[24:27], v[48:51], v[84:87]
    v_mfma_f32_16x16x32_bf16 v[104:107], v[24:27], v[52:55], v[104:107]
    buffer_load_dwordx4 v[216:219], v248, s[20:23], s70 offen offset:1024 sc1
    v_mfma_f32_16x16x32_bf16 v[124:127], v[24:27], v[56:59], v[124:127]
    s_add_u32 m0, s71, 59392
    s_add_u32 s57, s72, 81920
    buffer_load_dwordx4 v248, s[20:23], s57 offen sc1 lds
    v_mfma_f32_16x16x32_bf16 v[68:71], v[28:31], v[44:47], v[68:71]
    buffer_load_dwordx4 v[220:223], v248, s[20:23], s70 offen offset:2048 sc1
    v_mfma_f32_16x16x32_bf16 v[88:91], v[28:31], v[48:51], v[88:91]
    v_mfma_f32_16x16x32_bf16 v[108:111], v[28:31], v[52:55], v[108:111]
    buffer_load_dwordx4 v[224:227], v248, s[20:23], s70 offen offset:3072 sc1
    v_mfma_f32_16x16x32_bf16 v[128:131], v[28:31], v[56:59], v[128:131]
    s_add_u32 m0, s71, 60416
    s_add_u32 s57, s72, 82944
    buffer_load_dwordx4 v248, s[20:23], s57 offen sc1 lds
    v_mfma_f32_16x16x32_bf16 v[72:75], v[32:35], v[44:47], v[72:75]
    buffer_load_dwordx4 v[228:231], v249, s[20:23], s70 offen offset:0 sc1
    v_mfma_f32_16x16x32_bf16 v[92:95], v[32:35], v[48:51], v[92:95]
    v_mfma_f32_16x16x32_bf16 v[112:115], v[32:35], v[52:55], v[112:115]
    buffer_load_dwordx4 v[232:235], v248, s[20:23], s76 offen sc1
    s_add_u32 s76, s76, 4096
    v_mfma_f32_16x16x32_bf16 v[132:135], v[32:35], v[56:59], v[132:135]
    s_add_u32 m0, s71, 61440
    s_add_u32 s57, s72, 83968
    buffer_load_dwordx4 v248, s[20:23], s57 offen sc1 lds
    v_mfma_f32_16x16x32_bf16 v[76:79], v[36:39], v[44:47], v[76:79]
    buffer_load_dwordx4 v[236:239], v248, s[20:23], s77 offen sc1
    s_add_u32 s77, s77, 4096
    v_mfma_f32_16x16x32_bf16 v[96:99], v[36:39], v[48:51], v[96:99]
    v_mfma_f32_16x16x32_bf16 v[116:119], v[36:39], v[52:55], v[116:119]
    buffer_load_dwordx4 v[240:243], v248, s[20:23], s78 offen sc1
    s_add_u32 s78, s78, 4096
    v_mfma_f32_16x16x32_bf16 v[136:139], v[36:39], v[56:59], v[136:139]
    s_add_u32 m0, s71, 62464
    s_add_u32 s57, s72, 84992
    buffer_load_dwordx4 v248, s[20:23], s57 offen sc1 lds
    v_mfma_f32_16x16x32_bf16 v[80:83], v[40:43], v[44:47], v[80:83]
    buffer_load_dwordx4 v[244:247], v248, s[20:23], s79 offen sc1
    s_add_u32 s79, s79, 4096
    s_add_u32 s70, s70, 163840
    v_mfma_f32_16x16x32_bf16 v[100:103], v[40:43], v[48:51], v[100:103]
    v_mfma_f32_16x16x32_bf16 v[120:123], v[40:43], v[52:55], v[120:123]
    v_mfma_f32_16x16x32_bf16 v[140:143], v[40:43], v[56:59], v[140:143]
    s_add_u32 m0, s71, 63488
    s_add_u32 s57, s72, 86016
    buffer_load_dwordx4 v248, s[20:23], s57 offen sc1 lds
    s_waitcnt vmcnt(29)
    v_mfma_f32_16x16x32_bf16 v[64:67], v[60:63], v[160:163], v[64:67]
    buffer_load_dwordx4 v[24:27], v248, s[20:23], s70 offen offset:0 sc1
    v_mfma_f32_16x16x32_bf16 v[84:87], v[60:63], v[164:167], v[84:87]
    v_mfma_f32_16x16x32_bf16 v[104:107], v[60:63], v[168:171], v[104:107]
    buffer_load_dwordx4 v[28:31], v248, s[20:23], s70 offen offset:1024 sc1
    v_mfma_f32_16x16x32_bf16 v[124:127], v[60:63], v[172:175], v[124:127]
    s_add_u32 m0, s71, 64512
    s_add_u32 s57, s72, 122880
    buffer_load_dwordx4 v248, s[20:23], s57 offen sc1 lds
    v_mfma_f32_16x16x32_bf16 v[68:71], v[144:147], v[160:163], v[68:71]
    buffer_load_dwordx4 v[32:35], v248, s[20:23], s70 offen offset:2048 sc1
    v_mfma_f32_16x16x32_bf16 v[88:91], v[144:147], v[164:167], v[88:91]
    v_mfma_f32_16x16x32_bf16 v[108:111], v[144:147], v[168:171], v[108:111]
    buffer_load_dwordx4 v[36:39], v248, s[20:23], s70 offen offset:3072 sc1
    v_mfma_f32_16x16x32_bf16 v[128:131], v[144:147], v[172:175], v[128:131]
    s_add_u32 m0, s71, 65536
    s_add_u32 s57, s72, 123904
    buffer_load_dwordx4 v248, s[20:23], s57 offen sc1 lds
    v_mfma_f32_16x16x32_bf16 v[72:75], v[148:151], v[160:163], v[72:75]
    buffer_load_dwordx4 v[40:43], v249, s[20:23], s70 offen offset:0 sc1
    v_mfma_f32_16x16x32_bf16 v[92:95], v[148:151], v[164:167], v[92:95]
    v_mfma_f32_16x16x32_bf16 v[112:115], v[148:151], v[168:171], v[112:115]
    buffer_load_dwordx4 v[44:47], v248, s[20:23], s76 offen sc1
    s_add_u32 s76, s76, 4096
    v_mfma_f32_16x16x32_bf16 v[132:135], v[148:151], v[172:175], v[132:135]
    s_add_u32 m0, s71, 66560
    s_add_u32 s57, s72, 124928
    buffer_load_dwordx4 v248, s[20:23], s57 offen sc1 lds
    v_mfma_f32_16x16x32_bf16 v[76:79], v[152:155], v[160:163], v[76:79]
    buffer_load_dwordx4 v[48:51], v248, s[20:23], s77 offen sc1
    s_add_u32 s77, s77, 4096
    v_mfma_f32_16x16x32_bf16 v[96:99], v[152:155], v[164:167], v[96:99]
    v_mfma_f32_16x16x32_bf16 v[116:119], v[152:155], v[168:171], v[116:119]
    buffer_load_dwordx4 v[52:55], v248, s[20:23], s78 offen sc1
    s_add_u32 s78, s78, 4096
    v_mfma_f32_16x16x32_bf16 v[136:139], v[152:155], v[172:175], v[136:139]
    s_add_u32 m0, s71, 67584
    s_add_u32 s57, s72, 125952
    buffer_load_dwordx4 v248, s[20:23], s57 offen sc1 lds
    v_mfma_f32_16x16x32_bf16 v[80:83], v[156:159], v[160:163], v[80:83]
    buffer_load_dwordx4 v[56:59], v248, s[20:23], s79 offen sc1
    s_add_u32 s79, s79, 4096
    s_add_u32 s70, s70, 163840
    v_mfma_f32_16x16x32_bf16 v[100:103], v[156:159], v[164:167], v[100:103]
    v_mfma_f32_16x16x32_bf16 v[120:123], v[156:159], v[168:171], v[120:123]
    v_mfma_f32_16x16x32_bf16 v[140:143], v[156:159], v[172:175], v[140:143]
    s_add_u32 m0, s71, 68608
    s_add_u32 s57, s72, 126976
    buffer_load_dwordx4 v248, s[20:23], s57 offen sc1 lds
    buffer_load_dwordx4 v[60:63], v248, s[20:23], s70 offen offset:0 sc1
    buffer_load_dwordx4 v[144:147], v248, s[20:23], s70 offen offset:1024 sc1
    buffer_load_dwordx4 v[148:151], v248, s[20:23], s70 offen offset:2048 sc1
    buffer_load_dwordx4 v[152:155], v248, s[20:23], s70 offen offset:3072 sc1
    buffer_load_dwordx4 v[156:159], v249, s[20:23], s70 offen offset:0 sc1
    buffer_load_dwordx4 v[160:163], v248, s[20:23], s76 offen sc1
    s_add_u32 s76, s76, 4096
    buffer_load_dwordx4 v[164:167], v248, s[20:23], s77 offen sc1
    s_add_u32 s77, s77, 4096
    buffer_load_dwordx4 v[168:171], v248, s[20:23], s78 offen sc1
    s_add_u32 s78, s78, 4096
    buffer_load_dwordx4 v[172:175], v248, s[20:23], s79 offen sc1
    s_add_u32 s79, s79, 4096
    s_add_u32 s70, s70, 163840
    s_add_u32 s57, s72, 163840
    buffer_load_dwordx4 v[4:7], v248, s[20:23], s57 offen sc1
    s_add_u32 s57, s72, 164864
    buffer_load_dwordx4 v[8:11], v248, s[20:23], s57 offen sc1
    s_add_u32 s57, s72, 165888
    buffer_load_dwordx4 v[12:15], v248, s[20:23], s57 offen sc1
    s_add_u32 s57, s72, 166912
    buffer_load_dwordx4 v[16:19], v248, s[20:23], s57 offen sc1
    s_add_u32 s57, s72, 167936
    buffer_load_dwordx4 v[20:23], v248, s[20:23], s57 offen sc1
    s_mul_i32 s58, s61, 160
    s_lshl_b32 s59, s62, 11
    s_mov_b64 exec, 0x3ff
    s_add_u32 m0, s59, 156672
    s_add_u32 s57, s58, 0
    buffer_load_dwordx4 v248, s[40:43], s57 offen  lds
    s_mov_b64 exec, -1
    s_mov_b32 s64, 524288
    s_setprio 3
Lpoll_28:
    buffer_load_dword v249, v0, s[20:23], 0 offen sc1
    s_sub_u32 s64, s64, 1
    s_cbranch_scc1 Lpolld_29
    s_waitcnt vmcnt(0)
    v_cmp_ne_u32 vcc, 1, v249
    s_cbranch_vccz Lpolld_29
    s_sleep 4
    s_branch Lpoll_28
Lpolld_29:
    s_waitcnt vmcnt(0)
    v_lshrrev_b32 v249, 1, v248
    v_add_u32 v249, 4096, v249
    s_setprio 0
    s_branch Ltail
.fill 865, 4, 0xbf800000
Ltail:
    s_barrier
    s_cmp_ge_u32 s62, 2
    s_cbranch_scc1 Lskip_30
    v_mfma_f32_16x16x32_bf16 v[64:67], v[60:63], v[160:163], v[64:67]
    v_mfma_f32_16x16x32_bf16 v[84:87], v[60:63], v[164:167], v[84:87]
    v_mfma_f32_16x16x32_bf16 v[104:107], v[60:63], v[168:171], v[104:107]
    v_mfma_f32_16x16x32_bf16 v[124:127], v[60:63], v[172:175], v[124:127]
    v_mfma_f32_16x16x32_bf16 v[68:71], v[144:147], v[160:163], v[68:71]
    v_mfma_f32_16x16x32_bf16 v[88:91], v[144:147], v[164:167], v[88:91]
    v_mfma_f32_16x16x32_bf16 v[108:111], v[144:147], v[168:171], v[108:111]
    v_mfma_f32_16x16x32_bf16 v[128:131], v[144:147], v[172:175], v[128:131]
    v_mfma_f32_16x16x32_bf16 v[72:75], v[148:151], v[160:163], v[72:75]
    v_mfma_f32_16x16x32_bf16 v[92:95], v[148:151], v[164:167], v[92:95]
    v_mfma_f32_16x16x32_bf16 v[112:115], v[148:151], v[168:171], v[112:115]
    v_mfma_f32_16x16x32_bf16 v[132:135], v[148:151], v[172:175], v[132:135]
    v_mfma_f32_16x16x32_bf16 v[76:79], v[152:155], v[160:163], v[76:79]
    v_mfma_f32_16x16x32_bf16 v[96:99], v[152:155], v[164:167], v[96:99]
    v_mfma_f32_16x16x32_bf16 v[116:119], v[152:155], v[168:171], v[116:119]
    v_mfma_f32_16x16x32_bf16 v[136:139], v[152:155], v[172:175], v[136:139]
    v_mfma_f32_16x16x32_bf16 v[80:83], v[156:159], v[160:163], v[80:83]
    v_mfma_f32_16x16x32_bf16 v[100:103], v[156:159], v[164:167], v[100:103]
    v_mfma_f32_16x16x32_bf16 v[120:123], v[156:159], v[168:171], v[120:123]
    v_mfma_f32_16x16x32_bf16 v[140:143], v[156:159], v[172:175], v[140:143]
Lskip_30:
    v_mfma_f32_16x16x32_bf16 v[64:67], v[176:179], v[196:199], v[64:67]
    v_mfma_f32_16x16x32_bf16 v[64:67], v[212:215], v[232:235], v[64:67]
    v_mfma_f32_16x16x32_bf16 v[64:67], v[24:27], v[44:47], v[64:67]
    v_mfma_f32_16x16x32_bf16 v[68:71], v[180:183], v[196:199], v[68:71]
    v_mfma_f32_16x16x32_bf16 v[68:71], v[216:219], v[232:235], v[68:71]
    v_mfma_f32_16x16x32_bf16 v[68:71], v[28:31], v[44:47], v[68:71]
    v_mfma_f32_16x16x32_bf16 v[72:75], v[184:187], v[196:199], v[72:75]
    v_mfma_f32_16x16x32_bf16 v[72:75], v[220:223], v[232:235], v[72:75]
    v_mfma_f32_16x16x32_bf16 v[72:75], v[32:35], v[44:47], v[72:75]
    v_mfma_f32_16x16x32_bf16 v[76:79], v[188:191], v[196:199], v[76:79]
    v_mfma_f32_16x16x32_bf16 v[76:79], v[224:227], v[232:235], v[76:79]
    v_mfma_f32_16x16x32_bf16 v[76:79], v[36:39], v[44:47], v[76:79]
    v_mfma_f32_16x16x32_bf16 v[80:83], v[192:195], v[196:199], v[80:83]
    v_mfma_f32_16x16x32_bf16 v[80:83], v[228:231], v[232:235], v[80:83]
    v_mfma_f32_16x16x32_bf16 v[80:83], v[40:43], v[44:47], v[80:83]
    v_mfma_f32_16x16x32_bf16 v[84:87], v[176:179], v[200:203], v[84:87]
    v_mfma_f32_16x16x32_bf16 v[84:87], v[212:215], v[236:239], v[84:87]
    v_mfma_f32_16x16x32_bf16 v[84:87], v[24:27], v[48:51], v[84:87]
    v_mfma_f32_16x16x32_bf16 v[88:91], v[180:183], v[200:203], v[88:91]
    v_mfma_f32_16x16x32_bf16 v[88:91], v[216:219], v[236:239], v[88:91]
    v_mfma_f32_16x16x32_bf16 v[88:91], v[28:31], v[48:51], v[88:91]
    v_mfma_f32_16x16x32_bf16 v[92:95], v[184:187], v[200:203], v[92:95]
    v_mfma_f32_16x16x32_bf16 v[92:95], v[220:223], v[236:239], v[92:95]
    v_mfma_f32_16x16x32_bf16 v[92:95], v[32:35], v[48:51], v[92:95]
    v_mfma_f32_16x16x32_bf16 v[96:99], v[188:191], v[200:203], v[96:99]
    v_mfma_f32_16x16x32_bf16 v[96:99], v[224:227], v[236:239], v[96:99]
    v_mfma_f32_16x16x32_bf16 v[96:99], v[36:39], v[48:51], v[96:99]
    v_mfma_f32_16x16x32_bf16 v[100:103], v[192:195], v[200:203], v[100:103]
    v_mfma_f32_16x16x32_bf16 v[100:103], v[228:231], v[236:239], v[100:103]
    v_mfma_f32_16x16x32_bf16 v[100:103], v[40:43], v[48:51], v[100:103]
    v_mfma_f32_16x16x32_bf16 v[104:107], v[176:179], v[204:207], v[104:107]
    v_mfma_f32_16x16x32_bf16 v[104:107], v[212:215], v[240:243], v[104:107]
    v_mfma_f32_16x16x32_bf16 v[104:107], v[24:27], v[52:55], v[104:107]
    v_mfma_f32_16x16x32_bf16 v[108:111], v[180:183], v[204:207], v[108:111]
    v_mfma_f32_16x16x32_bf16 v[108:111], v[216:219], v[240:243], v[108:111]
    v_mfma_f32_16x16x32_bf16 v[108:111], v[28:31], v[52:55], v[108:111]
    v_mfma_f32_16x16x32_bf16 v[112:115], v[184:187], v[204:207], v[112:115]
    v_mfma_f32_16x16x32_bf16 v[112:115], v[220:223], v[240:243], v[112:115]
    v_mfma_f32_16x16x32_bf16 v[112:115], v[32:35], v[52:55], v[112:115]
    v_mfma_f32_16x16x32_bf16 v[116:119], v[188:191], v[204:207], v[116:119]
    v_mfma_f32_16x16x32_bf16 v[116:119], v[224:227], v[240:243], v[116:119]
    v_mfma_f32_16x16x32_bf16 v[116:119], v[36:39], v[52:55], v[116:119]
    v_mfma_f32_16x16x32_bf16 v[120:123], v[192:195], v[204:207], v[120:123]
    v_mfma_f32_16x16x32_bf16 v[120:123], v[228:231], v[240:243], v[120:123]
    v_mfma_f32_16x16x32_bf16 v[120:123], v[40:43], v[52:55], v[120:123]
    v_mfma_f32_16x16x32_bf16 v[124:127], v[176:179], v[208:211], v[124:127]
    v_mfma_f32_16x16x32_bf16 v[124:127], v[212:215], v[244:247], v[124:127]
    v_mfma_f32_16x16x32_bf16 v[124:127], v[24:27], v[56:59], v[124:127]
    v_mfma_f32_16x16x32_bf16 v[128:131], v[180:183], v[208:211], v[128:131]
    v_mfma_f32_16x16x32_bf16 v[128:131], v[216:219], v[244:247], v[128:131]
    v_mfma_f32_16x16x32_bf16 v[128:131], v[28:31], v[56:59], v[128:131]
    v_mfma_f32_16x16x32_bf16 v[132:135], v[184:187], v[208:211], v[132:135]
    v_mfma_f32_16x16x32_bf16 v[132:135], v[220:223], v[244:247], v[132:135]
    v_mfma_f32_16x16x32_bf16 v[132:135], v[32:35], v[56:59], v[132:135]
    v_mfma_f32_16x16x32_bf16 v[136:139], v[188:191], v[208:211], v[136:139]
    v_mfma_f32_16x16x32_bf16 v[136:139], v[224:227], v[244:247], v[136:139]
    v_mfma_f32_16x16x32_bf16 v[136:139], v[36:39], v[56:59], v[136:139]
    v_mfma_f32_16x16x32_bf16 v[140:143], v[192:195], v[208:211], v[140:143]
    v_mfma_f32_16x16x32_bf16 v[140:143], v[228:231], v[244:247], v[140:143]
    v_mfma_f32_16x16x32_bf16 v[140:143], v[40:43], v[56:59], v[140:143]
    buffer_load_dwordx4 v[24:27], v248, s[20:23], s36 offen offset:0 sc1
    buffer_load_dwordx4 v[28:31], v248, s[20:23], s36 offen offset:1024 sc1
    buffer_load_dwordx4 v[32:35], v248, s[20:23], s36 offen offset:2048 sc1
    buffer_load_dwordx4 v[36:39], v248, s[20:23], s36 offen offset:3072 sc1
    buffer_load_dwordx2 v[40:41], v249, s[20:23], s36 offen offset:0 sc1
    buffer_load_dwordx2 v[42:43], v249, s[20:23], s36 offen offset:512 sc1
    buffer_load_dwordx4 v[44:47], v248, s[20:23], s37 offen offset:0 sc1
    buffer_load_dwordx4 v[48:51], v248, s[20:23], s37 offen offset:1024 sc1
    buffer_load_dwordx4 v[52:55], v248, s[20:23], s37 offen offset:2048 sc1
    buffer_load_dwordx4 v[56:59], v248, s[20:23], s37 offen offset:3072 sc1
    buffer_load_dwordx2 v[60:61], v249, s[20:23], s37 offen offset:0 sc1
    buffer_load_dwordx2 v[62:63], v249, s[20:23], s37 offen offset:512 sc1
    v_lshrrev_b32 v246, 8, v248
    v_lshlrev_b32 v246, 3, v246
    s_add_u32 s59, s59, 156672
    v_add_u32 v246, s59, v246
    ds_read_b64 v[204:205], v246 offset:0
    ds_read_b64 v[206:207], v246 offset:32
    ds_read_b64 v[208:209], v246 offset:64
    ds_read_b64 v[210:211], v246 offset:96
    ds_read_b64 v[212:213], v246 offset:128
    ds_read_b128 v[144:147], v250 offset:0
    ds_read_b128 v[148:151], v250 offset:1024
    ds_read_b128 v[152:155], v250 offset:2048
    ds_read_b128 v[156:159], v250 offset:3072
    ds_read_b128 v[160:163], v250 offset:4096
    ds_read_b128 v[164:167], v250 offset:5120
    ds_read_b128 v[168:171], v250 offset:6144
    ds_read_b128 v[172:175], v250 offset:7168
    ds_read_b128 v[176:179], v250 offset:8192
    ds_read_b128 v[180:183], v250 offset:9216
    ds_read_b128 v[184:187], v250 offset:10240
    ds_read_b128 v[188:191], v250 offset:11264
    ds_read_b128 v[192:195], v250 offset:12288
    ds_read_b128 v[196:199], v250 offset:13312
    ds_read_b128 v[200:203], v250 offset:14336
    s_waitcnt lgkmcnt(15)
    v_lshlrev_b32 v244, 16, v204
    v_and_b32 v245, 0xffff0000, v204
    v_pk_add_f32 v[124:125], v[124:125], v[244:245]
    v_lshlrev_b32 v244, 16, v205
    v_and_b32 v245, 0xffff0000, v205
    v_pk_add_f32 v[126:127], v[126:127], v[244:245]
    v_lshlrev_b32 v244, 16, v206
    v_and_b32 v245, 0xffff0000, v206
    v_pk_add_f32 v[128:129], v[128:129], v[244:245]
    v_lshlrev_b32 v244, 16, v207
    v_and_b32 v245, 0xffff0000, v207
    v_pk_add_f32 v[130:131], v[130:131], v[244:245]
    v_lshlrev_b32 v244, 16, v208
    v_and_b32 v245, 0xffff0000, v208
    v_pk_add_f32 v[132:133], v[132:133], v[244:245]
    v_lshlrev_b32 v244, 16, v209
    v_and_b32 v245, 0xffff0000, v209
    v_pk_add_f32 v[134:135], v[134:135], v[244:245]
    v_lshlrev_b32 v244, 16, v210
    v_and_b32 v245, 0xffff0000, v210
    v_pk_add_f32 v[136:137], v[136:137], v[244:245]
    v_lshlrev_b32 v244, 16, v211
    v_and_b32 v245, 0xffff0000, v211
    v_pk_add_f32 v[138:139], v[138:139], v[244:245]
    v_lshlrev_b32 v244, 16, v212
    v_and_b32 v245, 0xffff0000, v212
    v_pk_add_f32 v[140:141], v[140:141], v[244:245]
    v_lshlrev_b32 v244, 16, v213
    v_and_b32 v245, 0xffff0000, v213
    v_pk_add_f32 v[142:143], v[142:143], v[244:245]
    ds_read_b128 v[204:207], v250 offset:15360
    ds_read_b128 v[208:211], v250 offset:16384
    ds_read_b128 v[212:215], v250 offset:17408
    ds_read_b128 v[216:219], v250 offset:18432
    ds_read_b128 v[220:223], v250 offset:19456
    v_sub_f32 v244, 1.0, v252
    v_pk_mul_f32 v[64:65], v[64:65], v[244:245] op_sel_hi:[1,0]
    v_pk_mul_f32 v[66:67], v[66:67], v[244:245] op_sel_hi:[1,0]
    v_pk_mul_f32 v[68:69], v[68:69], v[244:245] op_sel_hi:[1,0]
    v_pk_mul_f32 v[70:71], v[70:71], v[244:245] op_sel_hi:[1,0]
    v_pk_mul_f32 v[72:73], v[72:73], v[244:245] op_sel_hi:[1,0]
    v_pk_mul_f32 v[74:75], v[74:75], v[244:245] op_sel_hi:[1,0]
    v_pk_mul_f32 v[76:77], v[76:77], v[244:245] op_sel_hi:[1,0]
    v_pk_mul_f32 v[78:79], v[78:79], v[244:245] op_sel_hi:[1,0]
    v_pk_mul_f32 v[80:81], v[80:81], v[244:245] op_sel_hi:[1,0]
    v_pk_mul_f32 v[82:83], v[82:83], v[244:245] op_sel_hi:[1,0]
    v_sub_f32 v244, 1.0, v253
    v_pk_mul_f32 v[84:85], v[84:85], v[244:245] op_sel_hi:[1,0]
    v_pk_mul_f32 v[86:87], v[86:87], v[244:245] op_sel_hi:[1,0]
    v_pk_mul_f32 v[88:89], v[88:89], v[244:245] op_sel_hi:[1,0]
    v_pk_mul_f32 v[90:91], v[90:91], v[244:245] op_sel_hi:[1,0]
    v_pk_mul_f32 v[92:93], v[92:93], v[244:245] op_sel_hi:[1,0]
    v_pk_mul_f32 v[94:95], v[94:95], v[244:245] op_sel_hi:[1,0]
    v_pk_mul_f32 v[96:97], v[96:97], v[244:245] op_sel_hi:[1,0]
    v_pk_mul_f32 v[98:99], v[98:99], v[244:245] op_sel_hi:[1,0]
    v_pk_mul_f32 v[100:101], v[100:101], v[244:245] op_sel_hi:[1,0]
    v_pk_mul_f32 v[102:103], v[102:103], v[244:245] op_sel_hi:[1,0]
    v_sub_f32 v244, 1.0, v254
    v_pk_mul_f32 v[104:105], v[104:105], v[244:245] op_sel_hi:[1,0]
    v_pk_mul_f32 v[106:107], v[106:107], v[244:245] op_sel_hi:[1,0]
    v_pk_mul_f32 v[108:109], v[108:109], v[244:245] op_sel_hi:[1,0]
    v_pk_mul_f32 v[110:111], v[110:111], v[244:245] op_sel_hi:[1,0]
    v_pk_mul_f32 v[112:113], v[112:113], v[244:245] op_sel_hi:[1,0]
    v_pk_mul_f32 v[114:115], v[114:115], v[244:245] op_sel_hi:[1,0]
    v_pk_mul_f32 v[116:117], v[116:117], v[244:245] op_sel_hi:[1,0]
    v_pk_mul_f32 v[118:119], v[118:119], v[244:245] op_sel_hi:[1,0]
    v_pk_mul_f32 v[120:121], v[120:121], v[244:245] op_sel_hi:[1,0]
    v_pk_mul_f32 v[122:123], v[122:123], v[244:245] op_sel_hi:[1,0]
    v_sub_f32 v244, 1.0, v255
    v_pk_mul_f32 v[124:125], v[124:125], v[244:245] op_sel_hi:[1,0]
    v_pk_mul_f32 v[126:127], v[126:127], v[244:245] op_sel_hi:[1,0]
    v_pk_mul_f32 v[128:129], v[128:129], v[244:245] op_sel_hi:[1,0]
    v_pk_mul_f32 v[130:131], v[130:131], v[244:245] op_sel_hi:[1,0]
    v_pk_mul_f32 v[132:133], v[132:133], v[244:245] op_sel_hi:[1,0]
    v_pk_mul_f32 v[134:135], v[134:135], v[244:245] op_sel_hi:[1,0]
    v_pk_mul_f32 v[136:137], v[136:137], v[244:245] op_sel_hi:[1,0]
    v_pk_mul_f32 v[138:139], v[138:139], v[244:245] op_sel_hi:[1,0]
    v_pk_mul_f32 v[140:141], v[140:141], v[244:245] op_sel_hi:[1,0]
    v_pk_mul_f32 v[142:143], v[142:143], v[244:245] op_sel_hi:[1,0]
    s_waitcnt lgkmcnt(0)
    s_waitcnt vmcnt(6)
    v_max3_u32 v247, v24, v25, v26
    v_max3_u32 v247, v247, v27, v28
    v_max3_u32 v247, v247, v29, v30
    v_max3_u32 v247, v247, v31, v32
    v_max3_u32 v247, v247, v33, v34
    v_max3_u32 v247, v247, v35, v36
    v_max3_u32 v247, v247, v37, v38
    v_max3_u32 v247, v247, v39, v40
    v_max3_u32 v247, v247, v41, v42
    v_max_u32 v247, v247, v43
    v_cmp_eq_u32 vcc, -1, v247
    s_cbranch_vccnz Loretry_31
Loback_32:
    v_mfma_f32_16x16x32_bf16 v[64:67], v[144:147], v[24:27], v[64:67]
    buffer_load_dwordx4 v[224:227], v248, s[20:23], s38 offen offset:0 sc1
    v_mfma_f32_16x16x32_bf16 v[64:67], v[164:167], v[28:31], v[64:67]
    buffer_load_dwordx4 v[228:231], v248, s[20:23], s38 offen offset:1024 sc1
    v_mfma_f32_16x16x32_bf16 v[64:67], v[184:187], v[32:35], v[64:67]
    buffer_load_dwordx4 v[232:235], v248, s[20:23], s38 offen offset:2048 sc1
    v_mfma_f32_16x16x32_bf16 v[64:67], v[204:207], v[36:39], v[64:67]
    buffer_load_dwordx4 v[236:239], v248, s[20:23], s38 offen offset:3072 sc1
    v_mfma_f32_16x16x32_bf16 v[64:67], v[4:7], v[40:43], v[64:67]
    buffer_load_dwordx2 v[240:241], v249, s[20:23], s38 offen offset:0 sc1
    v_mfma_f32_16x16x32_bf16 v[68:71], v[148:151], v[24:27], v[68:71]
    buffer_load_dwordx2 v[242:243], v249, s[20:23], s38 offen offset:512 sc1
    v_mfma_f32_16x16x32_bf16 v[68:71], v[168:171], v[28:31], v[68:71]
    v_mfma_f32_16x16x32_bf16 v[68:71], v[188:191], v[32:35], v[68:71]
    v_mfma_f32_16x16x32_bf16 v[68:71], v[208:211], v[36:39], v[68:71]
    v_mfma_f32_16x16x32_bf16 v[68:71], v[8:11], v[40:43], v[68:71]
    v_mfma_f32_16x16x32_bf16 v[72:75], v[152:155], v[24:27], v[72:75]
    ds_write_b128 v250, v[64:67] offset:0
    v_mfma_f32_16x16x32_bf16 v[72:75], v[172:175], v[28:31], v[72:75]
    v_mfma_f32_16x16x32_bf16 v[72:75], v[192:195], v[32:35], v[72:75]
    v_mfma_f32_16x16x32_bf16 v[72:75], v[212:215], v[36:39], v[72:75]
    s_waitcnt vmcnt(6)
    v_max3_u32 v247, v44, v45, v46
    v_max3_u32 v247, v247, v47, v48
    v_mfma_f32_16x16x32_bf16 v[72:75], v[12:15], v[40:43], v[72:75]
    ds_write_b128 v250, v[68:71] offset:1024
    v_mfma_f32_16x16x32_bf16 v[76:79], v[156:159], v[24:27], v[76:79]
    v_max3_u32 v247, v247, v49, v50
    v_max3_u32 v247, v247, v51, v52
    v_mfma_f32_16x16x32_bf16 v[76:79], v[176:179], v[28:31], v[76:79]
    v_max3_u32 v247, v247, v53, v54
    v_max3_u32 v247, v247, v55, v56
    v_mfma_f32_16x16x32_bf16 v[76:79], v[196:199], v[32:35], v[76:79]
    ds_write_b128 v250, v[72:75] offset:2048
    v_mfma_f32_16x16x32_bf16 v[76:79], v[216:219], v[36:39], v[76:79]
    v_max3_u32 v247, v247, v57, v58
    v_max3_u32 v247, v247, v59, v60
    v_mfma_f32_16x16x32_bf16 v[76:79], v[16:19], v[40:43], v[76:79]
    v_max3_u32 v247, v247, v61, v62
    v_max_u32 v247, v247, v63
    v_mfma_f32_16x16x32_bf16 v[80:83], v[160:163], v[24:27], v[80:83]
    v_cmp_eq_u32 vcc, -1, v247
    v_mfma_f32_16x16x32_bf16 v[80:83], v[180:183], v[28:31], v[80:83]
    v_mfma_f32_16x16x32_bf16 v[80:83], v[200:203], v[32:35], v[80:83]
    v_mfma_f32_16x16x32_bf16 v[80:83], v[220:223], v[36:39], v[80:83]
    v_mfma_f32_16x16x32_bf16 v[80:83], v[20:23], v[40:43], v[80:83]
    ds_write_b128 v250, v[76:79] offset:3072
    s_cbranch_vccnz Loretry_33
Loback_34:
    v_mfma_f32_16x16x32_bf16 v[84:87], v[144:147], v[44:47], v[84:87]
    buffer_load_dwordx4 v[24:27], v248, s[20:23], s39 offen offset:0 sc1
    v_mfma_f32_16x16x32_bf16 v[84:87], v[164:167], v[48:51], v[84:87]
    buffer_load_dwordx4 v[28:31], v248, s[20:23], s39 offen offset:1024 sc1
    v_mfma_f32_16x16x32_bf16 v[84:87], v[184:187], v[52:55], v[84:87]
    buffer_load_dwordx4 v[32:35], v248, s[20:23], s39 offen offset:2048 sc1
    v_mfma_f32_16x16x32_bf16 v[84:87], v[204:207], v[56:59], v[84:87]
    ds_write_b128 v250, v[80:83] offset:4096
    v_mfma_f32_16x16x32_bf16 v[84:87], v[4:7], v[60:63], v[84:87]
    buffer_load_dwordx4 v[36:39], v248, s[20:23], s39 offen offset:3072 sc1
    v_mfma_f32_16x16x32_bf16 v[88:91], v[148:151], v[44:47], v[88:91]
    buffer_load_dwordx2 v[40:41], v249, s[20:23], s39 offen offset:0 sc1
    v_mfma_f32_16x16x32_bf16 v[88:91], v[168:171], v[48:51], v[88:91]
    buffer_load_dwordx2 v[42:43], v249, s[20:23], s39 offen offset:512 sc1
    v_mfma_f32_16x16x32_bf16 v[88:91], v[188:191], v[52:55], v[88:91]
    v_mfma_f32_16x16x32_bf16 v[88:91], v[208:211], v[56:59], v[88:91]
    v_mfma_f32_16x16x32_bf16 v[88:91], v[8:11], v[60:63], v[88:91]
    ds_write_b128 v250, v[84:87] offset:5120
    v_mfma_f32_16x16x32_bf16 v[92:95], v[152:155], v[44:47], v[92:95]
    v_mfma_f32_16x16x32_bf16 v[92:95], v[172:175], v[48:51], v[92:95]
    v_mfma_f32_16x16x32_bf16 v[92:95], v[192:195], v[52:55], v[92:95]
    v_mfma_f32_16x16x32_bf16 v[92:95], v[212:215], v[56:59], v[92:95]
    s_waitcnt vmcnt(6)
    v_max3_u32 v247, v224, v225, v226
    v_max3_u32 v247, v247, v227, v228
    v_mfma_f32_16x16x32_bf16 v[92:95], v[12:15], v[60:63], v[92:95]
    ds_write_b128 v250, v[88:91] offset:6144
    v_mfma_f32_16x16x32_bf16 v[96:99], v[156:159], v[44:47], v[96:99]
    v_max3_u32 v247, v247, v229, v230
    v_max3_u32 v247, v247, v231, v232
    v_mfma_f32_16x16x32_bf16 v[96:99], v[176:179], v[48:51], v[96:99]
    v_max3_u32 v247, v247, v233, v234
    v_max3_u32 v247, v247, v235, v236
    v_mfma_f32_16x16x32_bf16 v[96:99], v[196:199], v[52:55], v[96:99]
    ds_write_b128 v250, v[92:95] offset:7168
    v_mfma_f32_16x16x32_bf16 v[96:99], v[216:219], v[56:59], v[96:99]
    v_max3_u32 v247, v247, v237, v238
    v_max3_u32 v247, v247, v239, v240
    v_mfma_f32_16x16x32_bf16 v[96:99], v[16:19], v[60:63], v[96:99]
    v_max3_u32 v247, v247, v241, v242
    v_max_u32 v247, v247, v243
    v_mfma_f32_16x16x32_bf16 v[100:103], v[160:163], v[44:47], v[100:103]
    v_cmp_eq_u32 vcc, -1, v247
    v_mfma_f32_16x16x32_bf16 v[100:103], v[180:183], v[48:51], v[100:103]
    v_mfma_f32_16x16x32_bf16 v[100:103], v[200:203], v[52:55], v[100:103]
    v_mfma_f32_16x16x32_bf16 v[100:103], v[220:223], v[56:59], v[100:103]
    v_mfma_f32_16x16x32_bf16 v[100:103], v[20:23], v[60:63], v[100:103]
    ds_write_b128 v250, v[96:99] offset:8192
    s_cbranch_vccnz Loretry_35
Loback_36:
    v_mfma_f32_16x16x32_bf16 v[104:107], v[144:147], v[224:227], v[104:107]
    v_mfma_f32_16x16x32_bf16 v[104:107], v[164:167], v[228:231], v[104:107]
    v_mfma_f32_16x16x32_bf16 v[104:107], v[184:187], v[232:235], v[104:107]
    v_mfma_f32_16x16x32_bf16 v[104:107], v[204:207], v[236:239], v[104:107]
    v_mfma_f32_16x16x32_bf16 v[104:107], v[4:7], v[240:243], v[104:107]
    v_mfma_f32_16x16x32_bf16 v[108:111], v[148:151], v[224:227], v[108:111]
    ds_write_b128 v250, v[100:103] offset:9216
    v_mfma_f32_16x16x32_bf16 v[108:111], v[168:171], v[228:231], v[108:111]
    v_mfma_f32_16x16x32_bf16 v[108:111], v[188:191], v[232:235], v[108:111]
    v_mfma_f32_16x16x32_bf16 v[108:111], v[208:211], v[236:239], v[108:111]
    v_mfma_f32_16x16x32_bf16 v[108:111], v[8:11], v[240:243], v[108:111]
    v_mfma_f32_16x16x32_bf16 v[112:115], v[152:155], v[224:227], v[112:115]
    v_mfma_f32_16x16x32_bf16 v[112:115], v[172:175], v[228:231], v[112:115]
    ds_write_b128 v250, v[104:107] offset:10240
    v_mfma_f32_16x16x32_bf16 v[112:115], v[192:195], v[232:235], v[112:115]
    v_mfma_f32_16x16x32_bf16 v[112:115], v[212:215], v[236:239], v[112:115]
    s_waitcnt vmcnt(0)
    v_max3_u32 v247, v24, v25, v26
    v_max3_u32 v247, v247, v27, v28
    v_mfma_f32_16x16x32_bf16 v[112:115], v[12:15], v[240:243], v[112:115]
    ds_write_b128 v250, v[108:111] offset:11264
    v_mfma_f32_16x16x32_bf16 v[116:119], v[156:159], v[224:227], v[116:119]
    v_max3_u32 v247, v247, v29, v30
    v_max3_u32 v247, v247, v31, v32
    v_mfma_f32_16x16x32_bf16 v[116:119], v[176:179], v[228:231], v[116:119]
    v_max3_u32 v247, v247, v33, v34
    v_max3_u32 v247, v247, v35, v36
    v_mfma_f32_16x16x32_bf16 v[116:119], v[196:199], v[232:235], v[116:119]
    ds_write_b128 v250, v[112:115] offset:12288
    v_mfma_f32_16x16x32_bf16 v[116:119], v[216:219], v[236:239], v[116:119]
    v_max3_u32 v247, v247, v37, v38
    v_max3_u32 v247, v247, v39, v40
    v_mfma_f32_16x16x32_bf16 v[116:119], v[16:19], v[240:243], v[116:119]
    v_max3_u32 v247, v247, v41, v42
    v_max_u32 v247, v247, v43
    v_mfma_f32_16x16x32_bf16 v[120:123], v[160:163], v[224:227], v[120:123]
    v_cmp_eq_u32 vcc, -1, v247
    v_mfma_f32_16x16x32_bf16 v[120:123], v[180:183], v[228:231], v[120:123]
    v_mfma_f32_16x16x32_bf16 v[120:123], v[200:203], v[232:235], v[120:123]
    v_mfma_f32_16x16x32_bf16 v[120:123], v[220:223], v[236:239], v[120:123]
    v_mfma_f32_16x16x32_bf16 v[120:123], v[20:23], v[240:243], v[120:123]
    ds_write_b128 v250, v[116:119] offset:13312
    s_cbranch_vccnz Loretry_37
Loback_38:
    v_mfma_f32_16x16x32_bf16 v[124:127], v[144:147], v[24:27], v[124:127]
    v_mfma_f32_16x16x32_bf16 v[124:127], v[164:167], v[28:31], v[124:127]
    v_mfma_f32_16x16x32_bf16 v[124:127], v[184:187], v[32:35], v[124:127]
    v_mfma_f32_16x16x32_bf16 v[124:127], v[204:207], v[36:39], v[124:127]
    v_mfma_f32_16x16x32_bf16 v[124:127], v[4:7], v[40:43], v[124:127]
    v_mfma_f32_16x16x32_bf16 v[128:131], v[148:151], v[24:27], v[128:131]
    ds_write_b128 v250, v[120:123] offset:14336
    v_mfma_f32_16x16x32_bf16 v[128:131], v[168:171], v[28:31], v[128:131]
    v_mfma_f32_16x16x32_bf16 v[128:131], v[188:191], v[32:35], v[128:131]
    v_mfma_f32_16x16x32_bf16 v[128:131], v[208:211], v[36:39], v[128:131]
    s_waitcnt lgkmcnt(0)
    s_barrier
    ds_read_b128 v[64:67], v1 offset:0
    v_mfma_f32_16x16x32_bf16 v[128:131], v[8:11], v[40:43], v[128:131]
    ds_read_b128 v[84:87], v2 offset:0
    v_mfma_f32_16x16x32_bf16 v[132:135], v[152:155], v[24:27], v[132:135]
    ds_read_b128 v[104:107], v3 offset:0
    v_mfma_f32_16x16x32_bf16 v[132:135], v[172:175], v[28:31], v[132:135]
    ds_read_b128 v[68:71], v1 offset:1024
    v_mfma_f32_16x16x32_bf16 v[132:135], v[192:195], v[32:35], v[132:135]
    ds_read_b128 v[88:91], v2 offset:1024
    v_mfma_f32_16x16x32_bf16 v[132:135], v[212:215], v[36:39], v[132:135]
    ds_read_b128 v[108:111], v3 offset:1024
    v_mfma_f32_16x16x32_bf16 v[132:135], v[12:15], v[40:43], v[132:135]
    ds_read_b128 v[72:75], v1 offset:2048
    v_mfma_f32_16x16x32_bf16 v[136:139], v[156:159], v[24:27], v[136:139]
    ds_read_b128 v[92:95], v2 offset:2048
    v_mfma_f32_16x16x32_bf16 v[136:139], v[176:179], v[28:31], v[136:139]
    ds_read_b128 v[112:115], v3 offset:2048
    v_mfma_f32_16x16x32_bf16 v[136:139], v[196:199], v[32:35], v[136:139]
    ds_read_b128 v[76:79], v1 offset:3072
    v_mfma_f32_16x16x32_bf16 v[136:139], v[216:219], v[36:39], v[136:139]
    ds_read_b128 v[96:99], v2 offset:3072
    v_mfma_f32_16x16x32_bf16 v[136:139], v[16:19], v[40:43], v[136:139]
    ds_read_b128 v[116:119], v3 offset:3072
    v_mfma_f32_16x16x32_bf16 v[140:143], v[160:163], v[24:27], v[140:143]
    ds_read_b128 v[80:83], v1 offset:4096
    v_mfma_f32_16x16x32_bf16 v[140:143], v[180:183], v[28:31], v[140:143]
    ds_read_b128 v[100:103], v2 offset:4096
    v_mfma_f32_16x16x32_bf16 v[140:143], v[200:203], v[32:35], v[140:143]
    ds_read_b128 v[120:123], v3 offset:4096
    v_mfma_f32_16x16x32_bf16 v[140:143], v[220:223], v[36:39], v[140:143]
    v_mfma_f32_16x16x32_bf16 v[140:143], v[20:23], v[40:43], v[140:143]
    s_waitcnt lgkmcnt(12)
    v_pk_add_f32 v[64:65], v[64:65], v[84:85]
    v_pk_add_f32 v[104:105], v[104:105], v[124:125]
    v_pk_add_f32 v[66:67], v[66:67], v[86:87]
    v_pk_add_f32 v[106:107], v[106:107], v[126:127]
    v_pk_add_f32 v[64:65], v[64:65], v[104:105]
    v_pk_add_f32 v[66:67], v[66:67], v[106:107]
    v_cvt_pk_bf16_f32 v64, v64, v65
    v_cvt_pk_bf16_f32 v65, v66, v67
    buffer_store_dwordx2 v[64:65], v251, s[32:35], 0 offen offset:0
    s_waitcnt lgkmcnt(9)
    v_pk_add_f32 v[68:69], v[68:69], v[88:89]
    v_pk_add_f32 v[108:109], v[108:109], v[128:129]
    v_pk_add_f32 v[70:71], v[70:71], v[90:91]
    v_pk_add_f32 v[110:111], v[110:111], v[130:131]
    v_pk_add_f32 v[68:69], v[68:69], v[108:109]
    v_pk_add_f32 v[70:71], v[70:71], v[110:111]
    v_cvt_pk_bf16_f32 v68, v68, v69
    v_cvt_pk_bf16_f32 v69, v70, v71
    buffer_store_dwordx2 v[68:69], v251, s[32:35], 0 offen offset:32
    s_waitcnt lgkmcnt(6)
    v_pk_add_f32 v[72:73], v[72:73], v[92:93]
    v_pk_add_f32 v[112:113], v[112:113], v[132:133]
    v_pk_add_f32 v[74:75], v[74:75], v[94:95]
    v_pk_add_f32 v[114:115], v[114:115], v[134:135]
    v_pk_add_f32 v[72:73], v[72:73], v[112:113]
    v_pk_add_f32 v[74:75], v[74:75], v[114:115]
    v_cvt_pk_bf16_f32 v72, v72, v73
    v_cvt_pk_bf16_f32 v73, v74, v75
    buffer_store_dwordx2 v[72:73], v251, s[32:35], 0 offen offset:64
    s_waitcnt lgkmcnt(3)
    v_pk_add_f32 v[76:77], v[76:77], v[96:97]
    v_pk_add_f32 v[116:117], v[116:117], v[136:137]
    v_pk_add_f32 v[78:79], v[78:79], v[98:99]
    v_pk_add_f32 v[118:119], v[118:119], v[138:139]
    v_pk_add_f32 v[76:77], v[76:77], v[116:117]
    v_pk_add_f32 v[78:79], v[78:79], v[118:119]
    v_cvt_pk_bf16_f32 v76, v76, v77
    v_cvt_pk_bf16_f32 v77, v78, v79
    buffer_store_dwordx2 v[76:77], v251, s[32:35], 0 offen offset:96
    s_waitcnt lgkmcnt(0)
    v_pk_add_f32 v[80:81], v[80:81], v[100:101]
    v_pk_add_f32 v[120:121], v[120:121], v[140:141]
    v_pk_add_f32 v[82:83], v[82:83], v[102:103]
    v_pk_add_f32 v[122:123], v[122:123], v[142:143]
    v_pk_add_f32 v[80:81], v[80:81], v[120:121]
    v_pk_add_f32 v[82:83], v[82:83], v[122:123]
    v_cvt_pk_bf16_f32 v80, v80, v81
    v_cvt_pk_bf16_f32 v81, v82, v83
    buffer_store_dwordx2 v[80:81], v251, s[32:35], 0 offen offset:128
    s_endpgm
.fill 176, 4, 0xbf800000
Lattn0:
    s_setprio 1
    s_waitcnt vmcnt(0)
    buffer_load_dword v3, v18, s[20:23], 0 offen sc1
    s_barrier
Lattn:
    s_waitcnt vmcnt(0)
    v_cmp_ne_u32 vcc, 1, v3
    s_cbranch_vccz Lqok_17
    s_mov_b32 s64, 524288
Lpoll_18:
    buffer_load_dword v3, v18, s[20:23], 0 offen sc1
    s_sub_u32 s64, s64, 1
    s_cbranch_scc1 Lpolld_19
    s_waitcnt vmcnt(0)
    v_cmp_ne_u32 vcc, 1, v3
    s_cbranch_vccz Lpolld_19
    s_sleep 1
    s_branch Lpoll_18
Lpolld_19:
    s_waitcnt vmcnt(0)
Lqok_17:
    buffer_load_dwordx4 v[128:131], v19, s[20:23], s76 offen offset:0 sc1
    buffer_load_dwordx4 v[132:135], v19, s[20:23], s76 offen offset:512 sc1
    buffer_load_dwordx4 v[136:139], v20, s[20:23], s76 offen offset:1024 sc1
    s_mul_i32 s58, s79, 5120
    s_add_u32 s58, s58, s78
    s_add_u32 m0, s96, 0
    s_add_u32 s57, s58, 0
    buffer_load_dwordx4 v22, s[20:23], s57 offen sc1 lds
    s_add_u32 m0, s96, 1024
    s_add_u32 s57, s58, 1024
    buffer_load_dwordx4 v22, s[20:23], s57 offen sc1 lds
    s_add_u32 m0, s96, 3072
    s_add_u32 s57, s58, 2560
    buffer_load_dwordx4 v22, s[20:23], s57 offen sc1 lds
    s_add_u32 m0, s96, 4096
    s_add_u32 s57, s58, 3584
    buffer_load_dwordx4 v22, s[20:23], s57 offen sc1 lds
    s_mov_b32 exec_hi, 0
    s_add_u32 m0, s96, 2048
    s_add_u32 s57, s58, 2048
    buffer_load_dwordx4 v22, s[20:23], s57 offen sc1 lds
    s_add_u32 m0, s96, 5120
    s_add_u32 s57, s58, 4608
    buffer_load_dwordx4 v22, s[20:23], s57 offen sc1 lds
    s_mov_b32 exec_hi, -1
    s_add_u32 s79, s79, 4
    s_and_b32 s79, s79, 31
    ds_write_b128 v23, v[24:27] offset:2560
    ds_write_b128 v23, v[24:27] offset:27136
    ds_write_b128 v23, v[24:27] offset:51712
    v_add_u32 v23, 73728, v23
    v_add_u32 v6, s96, v28
    v_add_u32 v7, s96, v29
    s_waitcnt vmcnt(6)
    v_swap_b32 v130, v132
    v_swap_b32 v131, v133
    s_mov_b32 exec_lo, 0
    v_mov_b32 v136, 0
    v_mov_b32 v137, 0
    v_mov_b32 v138, 0
    v_mov_b32 v139, 0
    s_mov_b32 exec_lo, -1
    s_waitcnt vmcnt(4) lgkmcnt(0)
    ds_read2st64_b64 v[148:151], v7 offset0:0 offset1:6
    ds_read2st64_b64 v[140:143], v6 offset0:0 offset1:1
    s_waitcnt lgkmcnt(0)
    v_mfma_f32_32x32x8_bf16 v[64:79], v[148:149], v[136:137], 0
    v_mfma_f32_32x32x8_bf16 v[80:95], v[148:149], v[138:139], 0
    v_mfma_f32_32x32x16_bf16 v[64:79], v[140:143], v[128:131], v[64:79]
    v_mfma_f32_32x32x16_bf16 v[80:95], v[140:143], v[132:135], v[80:95]
    s_nop 10
    v_max3_f32 v6, v64, v65, v66
    v_max3_f32 v6, v6, v67, v68
    v_max3_f32 v6, v6, v69, v70
    v_max3_f32 v6, v6, v71, v72
    v_max3_f32 v6, v6, v73, v74
    v_max3_f32 v6, v6, v75, v76
    v_max3_f32 v6, v6, v77, v78
    v_max_f32 v6, v6, v79
    v_mov_b32 v7, v6
    v_max3_f32 v8, v80, v81, v82
    v_max3_f32 v8, v8, v83, v84
    v_max3_f32 v8, v8, v85, v86
    v_max3_f32 v8, v8, v87, v88
    v_max3_f32 v8, v8, v89, v90
    v_max3_f32 v8, v8, v91, v92
    v_max3_f32 v8, v8, v93, v94
    v_max_f32 v8, v8, v95
    v_mov_b32 v9, v8
    v_permlane32_swap_b32 v6, v7
    s_nop 0
    v_permlane32_swap_b32 v8, v9
    s_mov_b32 exec_lo, 0
    v_max_f32 v6, v6, v7
    v_max_f32 v8, v8, v9
    v_cvt_pk_bf16_f32 v136, -v6, 0
    v_cvt_pk_bf16_f32 v138, -v8, 0
    s_mov_b32 exec_lo, -1
    s_waitcnt vmcnt(0)
    s_barrier
    s_setprio 1
    ds_read2st64_b64 v[148:151], v29 offset0:0 offset1:6
    ds_read2st64_b64 v[140:143], v28 offset0:0 offset1:1
    ds_read2st64_b64 v[144:147], v28 offset0:6 offset1:7
    ds_write_b128 v23, v[24:27] offset:2560
    ds_write_b128 v23, v[24:27] offset:27136
    ds_write_b128 v23, v[24:27] offset:51712
    ds_write_b128 v1, v[40:43] offset:0
    ds_write_b128 v1, v[44:47] offset:1024
    ds_write_b64 v1, v[4:5] offset:8192
    s_waitcnt lgkmcnt(7)
    v_mfma_f32_32x32x8_bf16 v[64:79], v[148:149], v[136:137], 0
    v_mfma_f32_32x32x16_bf16 v[64:79], v[140:143], v[128:131], v[64:79]
    s_waitcnt lgkmcnt(0)
    v_mov_b32 v40, 0
    v_mov_b32 v41, 0
    v_mov_b32 v42, 0
    v_mov_b32 v43, 0
    v_mov_b32 v44, 0
    v_mov_b32 v45, 0
    v_mov_b32 v46, 0
    v_mov_b32 v47, 0
    s_nop 1
    s_cmp_lg_u32 0, 0
    v_mfma_f32_32x32x8_bf16 v[80:95], v[148:149], v[138:139], 0
    v_exp_f32 v64, v64
    v_exp_f32 v65, v65
    v_exp_f32 v66, v66
    v_exp_f32 v67, v67
    v_mfma_f32_32x32x16_bf16 v[80:95], v[140:143], v[132:135], v[80:95]
    ds_read_b128 v[160:163], v30 offset:0
    v_exp_f32 v68, v68
    v_exp_f32 v69, v69
    v_exp_f32 v70, v70
    ds_read_b128 v[164:167], v31 offset:0
    v_exp_f32 v71, v71
    v_exp_f32 v72, v72
    v_exp_f32 v73, v73
    v_exp_f32 v74, v74
    v_exp_f32 v75, v75
    v_exp_f32 v76, v76
    v_exp_f32 v77, v77
    v_exp_f32 v78, v78
    v_exp_f32 v79, v79
    v_mfma_f32_32x32x8_bf16 v[96:111], v[150:151], v[136:137], 0
    v_exp_f32 v80, v80
    v_exp_f32 v81, v81
    v_exp_f32 v82, v82
    v_exp_f32 v83, v83
    v_mfma_f32_32x32x16_bf16 v[96:111], v[144:147], v[128:131], v[96:111]
    s_waitcnt lgkmcnt(0)
    ds_read2st64_b64 v[140:143], v28 offset0:12 offset1:13
    v_exp_f32 v84, v84
    v_exp_f32 v85, v85
    v_exp_f32 v86, v86
    v_smfmac_f32_32x32x32_bf16 v[32:47], v[160:163], v[64:71], v17
    ds_read2st64_b64 v[152:155], v29 offset0:12 offset1:18
    v_exp_f32 v87, v87
    v_exp_f32 v88, v88
    v_exp_f32 v89, v89
    v_exp_f32 v90, v90
    v_smfmac_f32_32x32x32_bf16 v[32:47], v[164:167], v[72:79], v17
    v_exp_f32 v91, v91
    v_exp_f32 v92, v92
    v_exp_f32 v93, v93
    v_exp_f32 v94, v94
    v_exp_f32 v95, v95
    v_mfma_f32_32x32x8_bf16 v[112:127], v[150:151], v[138:139], 0
    v_exp_f32 v96, v96
    v_exp_f32 v97, v97
    v_exp_f32 v98, v98
    v_exp_f32 v99, v99
    v_mfma_f32_32x32x16_bf16 v[112:127], v[144:147], v[132:135], v[112:127]
    ds_read_b128 v[168:171], v30 offset:3072
    v_exp_f32 v100, v100
    v_exp_f32 v101, v101
    v_exp_f32 v102, v102
    v_smfmac_f32_32x32x32_bf16 v[48:63], v[160:163], v[80:87], v17
    ds_read_b128 v[172:175], v31 offset:3072
    v_exp_f32 v103, v103
    v_exp_f32 v104, v104
    v_exp_f32 v105, v105
    v_exp_f32 v106, v106
    v_smfmac_f32_32x32x32_bf16 v[48:63], v[164:167], v[88:95], v17
    s_waitcnt lgkmcnt(2)
    v_exp_f32 v107, v107
    v_exp_f32 v108, v108
    v_exp_f32 v109, v109
    v_exp_f32 v110, v110
    v_exp_f32 v111, v111
    v_mfma_f32_32x32x8_bf16 v[64:79], v[152:153], v[136:137], 0
    v_exp_f32 v112, v112
    v_exp_f32 v113, v113
    v_exp_f32 v114, v114
    v_exp_f32 v115, v115
    v_mfma_f32_32x32x16_bf16 v[64:79], v[140:143], v[128:131], v[64:79]
    s_waitcnt lgkmcnt(0)
    ds_read2st64_b64 v[144:147], v28 offset0:18 offset1:19
    v_exp_f32 v116, v116
    v_exp_f32 v117, v117
    v_exp_f32 v118, v118
    v_smfmac_f32_32x32x32_bf16 v[32:47], v[168:171], v[96:103], v17
    v_exp_f32 v119, v119
    v_exp_f32 v120, v120
    v_exp_f32 v121, v121
    v_exp_f32 v122, v122
    v_smfmac_f32_32x32x32_bf16 v[32:47], v[172:175], v[104:111], v17
    v_exp_f32 v123, v123
    v_exp_f32 v124, v124
    v_exp_f32 v125, v125
    v_exp_f32 v126, v126
    v_exp_f32 v127, v127
    v_mfma_f32_32x32x8_bf16 v[80:95], v[152:153], v[138:139], 0
    v_exp_f32 v64, v64
    v_exp_f32 v65, v65
    v_exp_f32 v66, v66
    v_exp_f32 v67, v67
    v_mfma_f32_32x32x16_bf16 v[80:95], v[140:143], v[132:135], v[80:95]
    ds_read_b128 v[160:163], v30 offset:6144
    v_exp_f32 v68, v68
    v_exp_f32 v69, v69
    v_exp_f32 v70, v70
    v_smfmac_f32_32x32x32_bf16 v[48:63], v[168:171], v[112:119], v17
    ds_read_b128 v[164:167], v31 offset:6144
    v_exp_f32 v71, v71
    v_exp_f32 v72, v72
    v_exp_f32 v73, v73
    v_exp_f32 v74, v74
    v_smfmac_f32_32x32x32_bf16 v[48:63], v[172:175], v[120:127], v17
    s_waitcnt lgkmcnt(2)
    v_exp_f32 v75, v75
    v_exp_f32 v76, v76
    v_exp_f32 v77, v77
    v_exp_f32 v78, v78
    v_exp_f32 v79, v79
    v_mfma_f32_32x32x8_bf16 v[96:111], v[154:155], v[136:137], 0
    v_exp_f32 v80, v80
    v_exp_f32 v81, v81
    v_exp_f32 v82, v82
    v_exp_f32 v83, v83
    v_mfma_f32_32x32x16_bf16 v[96:111], v[144:147], v[128:131], v[96:111]
    s_waitcnt lgkmcnt(0)
    ds_read2st64_b64 v[140:143], v28 offset0:24 offset1:25
    v_exp_f32 v84, v84
    v_exp_f32 v85, v85
    v_exp_f32 v86, v86
    v_smfmac_f32_32x32x32_bf16 v[32:47], v[160:163], v[64:71], v17
    ds_read2st64_b64 v[148:151], v29 offset0:24 offset1:30
    v_exp_f32 v87, v87
    v_exp_f32 v88, v88
    v_exp_f32 v89, v89
    v_exp_f32 v90, v90
    v_smfmac_f32_32x32x32_bf16 v[32:47], v[164:167], v[72:79], v17
    v_exp_f32 v91, v91
    v_exp_f32 v92, v92
    v_exp_f32 v93, v93
    v_exp_f32 v94, v94
    v_exp_f32 v95, v95
    v_mfma_f32_32x32x8_bf16 v[112:127], v[154:155], v[138:139], 0
    v_exp_f32 v96, v96
    v_exp_f32 v97, v97
    v_exp_f32 v98, v98
    v_exp_f32 v99, v99
    v_mfma_f32_32x32x16_bf16 v[112:127], v[144:147], v[132:135], v[112:127]
    ds_read_b128 v[168:171], v30 offset:9216
    v_exp_f32 v100, v100
    v_exp_f32 v101, v101
    v_exp_f32 v102, v102
    v_smfmac_f32_32x32x32_bf16 v[48:63], v[160:163], v[80:87], v17
    ds_read_b128 v[172:175], v31 offset:9216
    v_exp_f32 v103, v103
    v_exp_f32 v104, v104
    v_exp_f32 v105, v105
    v_exp_f32 v106, v106
    v_smfmac_f32_32x32x32_bf16 v[48:63], v[164:167], v[88:95], v17
    s_waitcnt lgkmcnt(2)
    v_exp_f32 v107, v107
    v_exp_f32 v108, v108
    v_exp_f32 v109, v109
    v_exp_f32 v110, v110
    v_exp_f32 v111, v111
    v_mfma_f32_32x32x8_bf16 v[64:79], v[148:149], v[136:137], 0
    v_exp_f32 v112, v112
    v_exp_f32 v113, v113
    v_exp_f32 v114, v114
    v_exp_f32 v115, v115
    v_mfma_f32_32x32x16_bf16 v[64:79], v[140:143], v[128:131], v[64:79]
    s_waitcnt lgkmcnt(0)
    ds_read2st64_b64 v[144:147], v28 offset0:30 offset1:31
    v_exp_f32 v116, v116
    v_exp_f32 v117, v117
    v_exp_f32 v118, v118
    v_smfmac_f32_32x32x32_bf16 v[32:47], v[168:171], v[96:103], v17
    v_exp_f32 v119, v119
    v_exp_f32 v120, v120
    v_exp_f32 v121, v121
    v_exp_f32 v122, v122
    v_smfmac_f32_32x32x32_bf16 v[32:47], v[172:175], v[104:111], v17
    v_exp_f32 v123, v123
    v_exp_f32 v124, v124
    v_exp_f32 v125, v125
    v_exp_f32 v126, v126
    v_exp_f32 v127, v127
    v_mfma_f32_32x32x8_bf16 v[80:95], v[148:149], v[138:139], 0
    v_exp_f32 v64, v64
    v_exp_f32 v65, v65
    v_exp_f32 v66, v66
    v_exp_f32 v67, v67
    v_mfma_f32_32x32x16_bf16 v[80:95], v[140:143], v[132:135], v[80:95]
    ds_read_b128 v[160:163], v30 offset:12288
    v_exp_f32 v68, v68
    v_exp_f32 v69, v69
    v_exp_f32 v70, v70
    v_smfmac_f32_32x32x32_bf16 v[48:63], v[168:171], v[112:119], v17
    ds_read_b128 v[164:167], v31 offset:12288
    v_exp_f32 v71, v71
    v_exp_f32 v72, v72
    v_exp_f32 v73, v73
    v_exp_f32 v74, v74
    v_smfmac_f32_32x32x32_bf16 v[48:63], v[172:175], v[120:127], v17
    s_waitcnt lgkmcnt(2)
    v_exp_f32 v75, v75
    v_exp_f32 v76, v76
    v_exp_f32 v77, v77
    v_exp_f32 v78, v78
    v_exp_f32 v79, v79
    v_mfma_f32_32x32x8_bf16 v[96:111], v[150:151], v[136:137], 0
    v_exp_f32 v80, v80
    v_exp_f32 v81, v81
    v_exp_f32 v82, v82
    v_exp_f32 v83, v83
    v_mfma_f32_32x32x16_bf16 v[96:111], v[144:147], v[128:131], v[96:111]
    s_waitcnt lgkmcnt(0)
    ds_read2st64_b64 v[140:143], v28 offset0:36 offset1:37
    v_exp_f32 v84, v84
    v_exp_f32 v85, v85
    v_exp_f32 v86, v86
    v_smfmac_f32_32x32x32_bf16 v[32:47], v[160:163], v[64:71], v17
    ds_read2st64_b64 v[152:155], v29 offset0:36 offset1:42
    v_exp_f32 v87, v87
    v_exp_f32 v88, v88
    v_exp_f32 v89, v89
    v_exp_f32 v90, v90
    v_smfmac_f32_32x32x32_bf16 v[32:47], v[164:167], v[72:79], v17
    v_exp_f32 v91, v91
    v_exp_f32 v92, v92
    v_exp_f32 v93, v93
    v_exp_f32 v94, v94
    v_exp_f32 v95, v95
    v_mfma_f32_32x32x8_bf16 v[112:127], v[150:151], v[138:139], 0
    v_exp_f32 v96, v96
    v_exp_f32 v97, v97
    v_exp_f32 v98, v98
    v_exp_f32 v99, v99
    v_mfma_f32_32x32x16_bf16 v[112:127], v[144:147], v[132:135], v[112:127]
    ds_read_b128 v[168:171], v30 offset:15360
    v_exp_f32 v100, v100
    v_exp_f32 v101, v101
    v_exp_f32 v102, v102
    v_smfmac_f32_32x32x32_bf16 v[48:63], v[160:163], v[80:87], v17
    ds_read_b128 v[172:175], v31 offset:15360
    v_exp_f32 v103, v103
    v_exp_f32 v104, v104
    v_exp_f32 v105, v105
    v_exp_f32 v106, v106
    v_smfmac_f32_32x32x32_bf16 v[48:63], v[164:167], v[88:95], v17
    s_waitcnt lgkmcnt(2)
    v_exp_f32 v107, v107
    v_exp_f32 v108, v108
    v_exp_f32 v109, v109
    v_exp_f32 v110, v110
    v_exp_f32 v111, v111
    v_mfma_f32_32x32x8_bf16 v[64:79], v[152:153], v[136:137], 0
    v_exp_f32 v112, v112
    v_exp_f32 v113, v113
    v_exp_f32 v114, v114
    v_exp_f32 v115, v115
    v_mfma_f32_32x32x16_bf16 v[64:79], v[140:143], v[128:131], v[64:79]
    s_waitcnt lgkmcnt(0)
    ds_read2st64_b64 v[144:147], v28 offset0:42 offset1:43
    v_exp_f32 v116, v116
    v_exp_f32 v117, v117
    v_exp_f32 v118, v118
    v_smfmac_f32_32x32x32_bf16 v[32:47], v[168:171], v[96:103], v17
    v_exp_f32 v119, v119
    v_exp_f32 v120, v120
    v_exp_f32 v121, v121
    v_exp_f32 v122, v122
    v_smfmac_f32_32x32x32_bf16 v[32:47], v[172:175], v[104:111], v17
    v_exp_f32 v123, v123
    v_exp_f32 v124, v124
    v_exp_f32 v125, v125
    v_exp_f32 v126, v126
    v_exp_f32 v127, v127
    v_mfma_f32_32x32x8_bf16 v[80:95], v[152:153], v[138:139], 0
    v_exp_f32 v64, v64
    v_exp_f32 v65, v65
    v_exp_f32 v66, v66
    v_exp_f32 v67, v67
    v_mfma_f32_32x32x16_bf16 v[80:95], v[140:143], v[132:135], v[80:95]
    ds_read_b128 v[160:163], v30 offset:18432
    v_exp_f32 v68, v68
    v_exp_f32 v69, v69
    v_exp_f32 v70, v70
    v_smfmac_f32_32x32x32_bf16 v[48:63], v[168:171], v[112:119], v17
    ds_read_b128 v[164:167], v31 offset:18432
    v_exp_f32 v71, v71
    v_exp_f32 v72, v72
    v_exp_f32 v73, v73
    v_exp_f32 v74, v74
    v_smfmac_f32_32x32x32_bf16 v[48:63], v[172:175], v[120:127], v17
    s_waitcnt lgkmcnt(2)
    v_exp_f32 v75, v75
    v_exp_f32 v76, v76
    v_exp_f32 v77, v77
    v_exp_f32 v78, v78
    v_exp_f32 v79, v79
    v_mfma_f32_32x32x8_bf16 v[96:111], v[154:155], v[136:137], 0
    v_exp_f32 v80, v80
    v_exp_f32 v81, v81
    v_exp_f32 v82, v82
    v_exp_f32 v83, v83
    v_mfma_f32_32x32x16_bf16 v[96:111], v[144:147], v[128:131], v[96:111]
    s_waitcnt lgkmcnt(0)
    s_barrier
    ds_read2st64_b64 v[140:143], v28 offset0:48 offset1:49
    v_exp_f32 v84, v84
    v_exp_f32 v85, v85
    v_exp_f32 v86, v86
    v_smfmac_f32_32x32x32_bf16 v[32:47], v[160:163], v[64:71], v17
    ds_read2st64_b64 v[148:151], v29 offset0:48 offset1:54
    v_exp_f32 v87, v87
    v_exp_f32 v88, v88
    v_exp_f32 v89, v89
    v_exp_f32 v90, v90
    v_smfmac_f32_32x32x32_bf16 v[32:47], v[164:167], v[72:79], v17
    v_exp_f32 v91, v91
    v_exp_f32 v92, v92
    v_exp_f32 v93, v93
    v_exp_f32 v94, v94
    v_exp_f32 v95, v95
    v_mfma_f32_32x32x8_bf16 v[112:127], v[154:155], v[138:139], 0
    v_exp_f32 v96, v96
    v_exp_f32 v97, v97
    v_exp_f32 v98, v98
    v_exp_f32 v99, v99
    v_mfma_f32_32x32x16_bf16 v[112:127], v[144:147], v[132:135], v[112:127]
    ds_read_b128 v[168:171], v30 offset:21504
    v_exp_f32 v100, v100
    v_exp_f32 v101, v101
    v_exp_f32 v102, v102
    v_smfmac_f32_32x32x32_bf16 v[48:63], v[160:163], v[80:87], v17
    ds_read_b128 v[172:175], v31 offset:21504
    v_exp_f32 v103, v103
    v_exp_f32 v104, v104
    v_exp_f32 v105, v105
    v_exp_f32 v106, v106
    v_smfmac_f32_32x32x32_bf16 v[48:63], v[164:167], v[88:95], v17
    s_waitcnt lgkmcnt(2)
    v_exp_f32 v107, v107
    v_exp_f32 v108, v108
    v_exp_f32 v109, v109
    v_exp_f32 v110, v110
    v_exp_f32 v111, v111
    v_mfma_f32_32x32x8_bf16 v[64:79], v[148:149], v[136:137], 0
    v_exp_f32 v112, v112
    v_exp_f32 v113, v113
    v_exp_f32 v114, v114
    v_exp_f32 v115, v115
    v_mfma_f32_32x32x16_bf16 v[64:79], v[140:143], v[128:131], v[64:79]
    s_waitcnt lgkmcnt(0)
    ds_read2st64_b64 v[144:147], v28 offset0:54 offset1:55
    v_exp_f32 v116, v116
    v_exp_f32 v117, v117
    v_exp_f32 v118, v118
    v_smfmac_f32_32x32x32_bf16 v[32:47], v[168:171], v[96:103], v17
    v_exp_f32 v119, v119
    v_exp_f32 v120, v120
    v_exp_f32 v121, v121
    v_exp_f32 v122, v122
    v_smfmac_f32_32x32x32_bf16 v[32:47], v[172:175], v[104:111], v17
    v_exp_f32 v123, v123
    v_exp_f32 v124, v124
    v_exp_f32 v125, v125
    v_exp_f32 v126, v126
    v_exp_f32 v127, v127
    v_mfma_f32_32x32x8_bf16 v[80:95], v[148:149], v[138:139], 0
    v_exp_f32 v64, v64
    v_exp_f32 v65, v65
    v_exp_f32 v66, v66
    v_exp_f32 v67, v67
    v_mfma_f32_32x32x16_bf16 v[80:95], v[140:143], v[132:135], v[80:95]
    ds_read_b128 v[160:163], v30 offset:24576
    v_exp_f32 v68, v68
    v_exp_f32 v69, v69
    v_exp_f32 v70, v70
    v_smfmac_f32_32x32x32_bf16 v[48:63], v[168:171], v[112:119], v17
    ds_read_b128 v[164:167], v31 offset:24576
    v_exp_f32 v71, v71
    v_exp_f32 v72, v72
    v_exp_f32 v73, v73
    v_exp_f32 v74, v74
    v_smfmac_f32_32x32x32_bf16 v[48:63], v[172:175], v[120:127], v17
    s_waitcnt lgkmcnt(2)
    v_exp_f32 v75, v75
    v_exp_f32 v76, v76
    v_exp_f32 v77, v77
    v_exp_f32 v78, v78
    v_exp_f32 v79, v79
    v_mfma_f32_32x32x8_bf16 v[96:111], v[150:151], v[136:137], 0
    v_exp_f32 v80, v80
    v_exp_f32 v81, v81
    v_exp_f32 v82, v82
    v_exp_f32 v83, v83
    v_mfma_f32_32x32x16_bf16 v[96:111], v[144:147], v[128:131], v[96:111]
    s_waitcnt lgkmcnt(0)
    ds_read2st64_b64 v[140:143], v28 offset0:60 offset1:61
    v_exp_f32 v84, v84
    v_exp_f32 v85, v85
    v_exp_f32 v86, v86
    v_smfmac_f32_32x32x32_bf16 v[32:47], v[160:163], v[64:71], v17
    ds_read2st64_b64 v[152:155], v29 offset0:60 offset1:66
    v_exp_f32 v87, v87
    v_exp_f32 v88, v88
    v_exp_f32 v89, v89
    v_exp_f32 v90, v90
    v_smfmac_f32_32x32x32_bf16 v[32:47], v[164:167], v[72:79], v17
    v_exp_f32 v91, v91
    v_exp_f32 v92, v92
    v_exp_f32 v93, v93
    v_exp_f32 v94, v94
    v_exp_f32 v95, v95
    v_mfma_f32_32x32x8_bf16 v[112:127], v[150:151], v[138:139], 0
    v_exp_f32 v96, v96
    v_exp_f32 v97, v97
    v_exp_f32 v98, v98
    v_exp_f32 v99, v99
    v_mfma_f32_32x32x16_bf16 v[112:127], v[144:147], v[132:135], v[112:127]
    ds_read_b128 v[168:171], v30 offset:27648
    v_exp_f32 v100, v100
    v_exp_f32 v101, v101
    v_exp_f32 v102, v102
    v_smfmac_f32_32x32x32_bf16 v[48:63], v[160:163], v[80:87], v17
    ds_read_b128 v[172:175], v31 offset:27648
    v_exp_f32 v103, v103
    v_exp_f32 v104, v104
    v_exp_f32 v105, v105
    v_exp_f32 v106, v106
    v_smfmac_f32_32x32x32_bf16 v[48:63], v[164:167], v[88:95], v17
    s_waitcnt lgkmcnt(2)
    v_exp_f32 v107, v107
    v_exp_f32 v108, v108
    v_exp_f32 v109, v109
    v_exp_f32 v110, v110
    v_exp_f32 v111, v111
    v_mfma_f32_32x32x8_bf16 v[64:79], v[152:153], v[136:137], 0
    v_exp_f32 v112, v112
    v_exp_f32 v113, v113
    v_exp_f32 v114, v114
    v_exp_f32 v115, v115
    v_mfma_f32_32x32x16_bf16 v[64:79], v[140:143], v[128:131], v[64:79]
    s_waitcnt lgkmcnt(0)
    ds_read2st64_b64 v[144:147], v28 offset0:66 offset1:67
    v_exp_f32 v116, v116
    v_exp_f32 v117, v117
    v_exp_f32 v118, v118
    v_smfmac_f32_32x32x32_bf16 v[32:47], v[168:171], v[96:103], v17
    v_exp_f32 v119, v119
    v_exp_f32 v120, v120
    v_exp_f32 v121, v121
    v_exp_f32 v122, v122
    v_smfmac_f32_32x32x32_bf16 v[32:47], v[172:175], v[104:111], v17
    v_exp_f32 v123, v123
    v_exp_f32 v124, v124
    v_exp_f32 v125, v125
    v_exp_f32 v126, v126
    v_exp_f32 v127, v127
    v_mfma_f32_32x32x8_bf16 v[80:95], v[152:153], v[138:139], 0
    v_exp_f32 v64, v64
    v_exp_f32 v65, v65
    v_exp_f32 v66, v66
    v_exp_f32 v67, v67
    v_mfma_f32_32x32x16_bf16 v[80:95], v[140:143], v[132:135], v[80:95]
    ds_read_b128 v[160:163], v30 offset:30720
    v_exp_f32 v68, v68
    v_exp_f32 v69, v69
    v_exp_f32 v70, v70
    v_smfmac_f32_32x32x32_bf16 v[48:63], v[168:171], v[112:119], v17
    ds_read_b128 v[164:167], v31 offset:30720
    v_exp_f32 v71, v71
    v_exp_f32 v72, v72
    v_exp_f32 v73, v73
    v_exp_f32 v74, v74
    v_smfmac_f32_32x32x32_bf16 v[48:63], v[172:175], v[120:127], v17
    s_waitcnt lgkmcnt(2)
    v_exp_f32 v75, v75
    v_exp_f32 v76, v76
    v_exp_f32 v77, v77
    v_exp_f32 v78, v78
    v_exp_f32 v79, v79
    v_mfma_f32_32x32x8_bf16 v[96:111], v[154:155], v[136:137], 0
    v_exp_f32 v80, v80
    v_exp_f32 v81, v81
    v_exp_f32 v82, v82
    v_exp_f32 v83, v83
    v_mfma_f32_32x32x16_bf16 v[96:111], v[144:147], v[128:131], v[96:111]
    s_waitcnt lgkmcnt(0)
    ds_read2st64_b64 v[140:143], v28 offset0:72 offset1:73
    v_exp_f32 v84, v84
    v_exp_f32 v85, v85
    v_exp_f32 v86, v86
    v_smfmac_f32_32x32x32_bf16 v[32:47], v[160:163], v[64:71], v17
    ds_read2st64_b64 v[148:151], v29 offset0:72 offset1:78
    v_exp_f32 v87, v87
    v_exp_f32 v88, v88
    v_exp_f32 v89, v89
    v_exp_f32 v90, v90
    v_smfmac_f32_32x32x32_bf16 v[32:47], v[164:167], v[72:79], v17
    v_exp_f32 v91, v91
    v_exp_f32 v92, v92
    v_exp_f32 v93, v93
    v_exp_f32 v94, v94
    v_exp_f32 v95, v95
    v_mfma_f32_32x32x8_bf16 v[112:127], v[154:155], v[138:139], 0
    v_exp_f32 v96, v96
    v_exp_f32 v97, v97
    v_exp_f32 v98, v98
    v_exp_f32 v99, v99
    v_mfma_f32_32x32x16_bf16 v[112:127], v[144:147], v[132:135], v[112:127]
    ds_read_b128 v[168:171], v30 offset:33792
    v_exp_f32 v100, v100
    v_exp_f32 v101, v101
    v_exp_f32 v102, v102
    v_smfmac_f32_32x32x32_bf16 v[48:63], v[160:163], v[80:87], v17
    ds_read_b128 v[172:175], v31 offset:33792
    v_exp_f32 v103, v103
    v_exp_f32 v104, v104
    v_exp_f32 v105, v105
    v_exp_f32 v106, v106
    v_smfmac_f32_32x32x32_bf16 v[48:63], v[164:167], v[88:95], v17
    s_waitcnt lgkmcnt(2)
    v_exp_f32 v107, v107
    v_exp_f32 v108, v108
    v_exp_f32 v109, v109
    v_exp_f32 v110, v110
    v_exp_f32 v111, v111
    v_mfma_f32_32x32x8_bf16 v[64:79], v[148:149], v[136:137], 0
    v_exp_f32 v112, v112
    v_exp_f32 v113, v113
    v_exp_f32 v114, v114
    v_exp_f32 v115, v115
    v_mfma_f32_32x32x16_bf16 v[64:79], v[140:143], v[128:131], v[64:79]
    s_waitcnt lgkmcnt(0)
    ds_read2st64_b64 v[144:147], v28 offset0:78 offset1:79
    v_exp_f32 v116, v116
    v_exp_f32 v117, v117
    v_exp_f32 v118, v118
    v_smfmac_f32_32x32x32_bf16 v[32:47], v[168:171], v[96:103], v17
    v_exp_f32 v119, v119
    v_exp_f32 v120, v120
    v_exp_f32 v121, v121
    v_exp_f32 v122, v122
    v_smfmac_f32_32x32x32_bf16 v[32:47], v[172:175], v[104:111], v17
    v_exp_f32 v123, v123
    v_exp_f32 v124, v124
    v_exp_f32 v125, v125
    v_exp_f32 v126, v126
    v_exp_f32 v127, v127
    v_mfma_f32_32x32x8_bf16 v[80:95], v[148:149], v[138:139], 0
    v_exp_f32 v64, v64
    v_exp_f32 v65, v65
    v_exp_f32 v66, v66
    v_exp_f32 v67, v67
    v_mfma_f32_32x32x16_bf16 v[80:95], v[140:143], v[132:135], v[80:95]
    ds_read_b128 v[160:163], v30 offset:36864
    v_exp_f32 v68, v68
    v_exp_f32 v69, v69
    v_exp_f32 v70, v70
    v_smfmac_f32_32x32x32_bf16 v[48:63], v[168:171], v[112:119], v17
    ds_read_b128 v[164:167], v31 offset:36864
    v_exp_f32 v71, v71
    v_exp_f32 v72, v72
    v_exp_f32 v73, v73
    v_exp_f32 v74, v74
    v_smfmac_f32_32x32x32_bf16 v[48:63], v[172:175], v[120:127], v17
    s_waitcnt lgkmcnt(2)
    v_exp_f32 v75, v75
    v_exp_f32 v76, v76
    v_exp_f32 v77, v77
    v_exp_f32 v78, v78
    v_exp_f32 v79, v79
    v_mfma_f32_32x32x8_bf16 v[96:111], v[150:151], v[136:137], 0
    v_exp_f32 v80, v80
    v_exp_f32 v81, v81
    v_exp_f32 v82, v82
    v_exp_f32 v83, v83
    v_mfma_f32_32x32x16_bf16 v[96:111], v[144:147], v[128:131], v[96:111]
    s_waitcnt lgkmcnt(0)
    ds_read2st64_b64 v[140:143], v28 offset0:84 offset1:85
    v_exp_f32 v84, v84
    v_exp_f32 v85, v85
    v_exp_f32 v86, v86
    v_smfmac_f32_32x32x32_bf16 v[32:47], v[160:163], v[64:71], v17
    ds_read2st64_b64 v[152:155], v29 offset0:84 offset1:90
    v_exp_f32 v87, v87
    v_exp_f32 v88, v88
    v_exp_f32 v89, v89
    v_exp_f32 v90, v90
    v_smfmac_f32_32x32x32_bf16 v[32:47], v[164:167], v[72:79], v17
    v_exp_f32 v91, v91
    v_exp_f32 v92, v92
    v_exp_f32 v93, v93
    v_exp_f32 v94, v94
    v_exp_f32 v95, v95
    v_mfma_f32_32x32x8_bf16 v[112:127], v[150:151], v[138:139], 0
    v_exp_f32 v96, v96
    v_exp_f32 v97, v97
    v_exp_f32 v98, v98
    v_exp_f32 v99, v99
    v_mfma_f32_32x32x16_bf16 v[112:127], v[144:147], v[132:135], v[112:127]
    ds_read_b128 v[168:171], v30 offset:39936
    v_exp_f32 v100, v100
    v_exp_f32 v101, v101
    v_exp_f32 v102, v102
    v_smfmac_f32_32x32x32_bf16 v[48:63], v[160:163], v[80:87], v17
    ds_read_b128 v[172:175], v31 offset:39936
    v_exp_f32 v103, v103
    v_exp_f32 v104, v104
    v_exp_f32 v105, v105
    v_exp_f32 v106, v106
    v_smfmac_f32_32x32x32_bf16 v[48:63], v[164:167], v[88:95], v17
    s_waitcnt lgkmcnt(2)
    v_exp_f32 v107, v107
    v_exp_f32 v108, v108
    v_exp_f32 v109, v109
    v_exp_f32 v110, v110
    v_exp_f32 v111, v111
    v_mfma_f32_32x32x8_bf16 v[64:79], v[152:153], v[136:137], 0
    v_exp_f32 v112, v112
    v_exp_f32 v113, v113
    v_exp_f32 v114, v114
    v_exp_f32 v115, v115
    v_mfma_f32_32x32x16_bf16 v[64:79], v[140:143], v[128:131], v[64:79]
    s_waitcnt lgkmcnt(0)
    ds_read2st64_b64 v[144:147], v28 offset0:90 offset1:91
    v_exp_f32 v116, v116
    v_exp_f32 v117, v117
    v_exp_f32 v118, v118
    v_smfmac_f32_32x32x32_bf16 v[32:47], v[168:171], v[96:103], v17
    v_exp_f32 v119, v119
    v_exp_f32 v120, v120
    v_exp_f32 v121, v121
    v_exp_f32 v122, v122
    v_smfmac_f32_32x32x32_bf16 v[32:47], v[172:175], v[104:111], v17
    v_exp_f32 v123, v123
    v_exp_f32 v124, v124
    v_exp_f32 v125, v125
    v_exp_f32 v126, v126
    v_exp_f32 v127, v127
    v_mfma_f32_32x32x8_bf16 v[80:95], v[152:153], v[138:139], 0
    v_exp_f32 v64, v64
    v_exp_f32 v65, v65
    v_exp_f32 v66, v66
    v_exp_f32 v67, v67
    v_mfma_f32_32x32x16_bf16 v[80:95], v[140:143], v[132:135], v[80:95]
    ds_read_b128 v[160:163], v30 offset:43008
    v_exp_f32 v68, v68
    v_exp_f32 v69, v69
    v_exp_f32 v70, v70
    v_smfmac_f32_32x32x32_bf16 v[48:63], v[168:171], v[112:119], v17
    ds_read_b128 v[164:167], v31 offset:43008
    v_exp_f32 v71, v71
    v_exp_f32 v72, v72
    v_exp_f32 v73, v73
    v_exp_f32 v74, v74
    v_smfmac_f32_32x32x32_bf16 v[48:63], v[172:175], v[120:127], v17
    s_waitcnt lgkmcnt(2)
    v_exp_f32 v75, v75
    v_exp_f32 v76, v76
    v_exp_f32 v77, v77
    v_exp_f32 v78, v78
    v_exp_f32 v79, v79
    v_mfma_f32_32x32x8_bf16 v[96:111], v[154:155], v[136:137], 0
    v_exp_f32 v80, v80
    v_exp_f32 v81, v81
    v_exp_f32 v82, v82
    v_exp_f32 v83, v83
    v_mfma_f32_32x32x16_bf16 v[96:111], v[144:147], v[128:131], v[96:111]
    s_waitcnt lgkmcnt(0)
    ds_read2st64_b64 v[140:143], v28 offset0:96 offset1:97
    v_exp_f32 v84, v84
    v_exp_f32 v85, v85
    v_exp_f32 v86, v86
    v_smfmac_f32_32x32x32_bf16 v[32:47], v[160:163], v[64:71], v17
    ds_read2st64_b64 v[148:151], v29 offset0:96 offset1:102
    v_exp_f32 v87, v87
    v_exp_f32 v88, v88
    v_exp_f32 v89, v89
    v_exp_f32 v90, v90
    v_smfmac_f32_32x32x32_bf16 v[32:47], v[164:167], v[72:79], v17
Lpad_at_0:
    s_cbranch_scc1 Lpad_at_1
    v_exp_f32 v91, v91
    v_exp_f32 v92, v92
    v_exp_f32 v93, v93
    v_exp_f32 v94, v94
    v_exp_f32 v95, v95
    v_mfma_f32_32x32x8_bf16 v[112:127], v[154:155], v[138:139], 0
    v_exp_f32 v96, v96
    v_exp_f32 v97, v97
    v_exp_f32 v98, v98
    v_exp_f32 v99, v99
    v_mfma_f32_32x32x16_bf16 v[112:127], v[144:147], v[132:135], v[112:127]
    ds_read_b128 v[168:171], v30 offset:46080
    v_exp_f32 v100, v100
    v_exp_f32 v101, v101
    v_exp_f32 v102, v102
    v_smfmac_f32_32x32x32_bf16 v[48:63], v[160:163], v[80:87], v17
    ds_read_b128 v[172:175], v31 offset:46080
    v_exp_f32 v103, v103
    v_exp_f32 v104, v104
    v_exp_f32 v105, v105
    v_exp_f32 v106, v106
    v_smfmac_f32_32x32x32_bf16 v[48:63], v[164:167], v[88:95], v17
    s_waitcnt lgkmcnt(2)
    v_exp_f32 v107, v107
    v_exp_f32 v108, v108
    v_exp_f32 v109, v109
    v_exp_f32 v110, v110
    v_exp_f32 v111, v111
    v_mfma_f32_32x32x8_bf16 v[64:79], v[148:149], v[136:137], 0
    v_exp_f32 v112, v112
    v_exp_f32 v113, v113
    v_exp_f32 v114, v114
    v_exp_f32 v115, v115
    v_mfma_f32_32x32x16_bf16 v[64:79], v[140:143], v[128:131], v[64:79]
    s_waitcnt lgkmcnt(0)
    ds_read2st64_b64 v[144:147], v28 offset0:102 offset1:103
    v_exp_f32 v116, v116
    v_exp_f32 v117, v117
    v_exp_f32 v118, v118
    v_smfmac_f32_32x32x32_bf16 v[32:47], v[168:171], v[96:103], v17
    v_exp_f32 v119, v119
    v_exp_f32 v120, v120
    v_exp_f32 v121, v121
    v_exp_f32 v122, v122
    v_smfmac_f32_32x32x32_bf16 v[32:47], v[172:175], v[104:111], v17
    v_exp_f32 v123, v123
    v_exp_f32 v124, v124
    v_exp_f32 v125, v125
    v_exp_f32 v126, v126
    v_exp_f32 v127, v127
    v_mfma_f32_32x32x8_bf16 v[80:95], v[148:149], v[138:139], 0
    v_exp_f32 v64, v64
    v_exp_f32 v65, v65
    v_exp_f32 v66, v66
    v_exp_f32 v67, v67
    v_mfma_f32_32x32x16_bf16 v[80:95], v[140:143], v[132:135], v[80:95]
    ds_read_b128 v[160:163], v30 offset:49152
    v_exp_f32 v68, v68
    v_exp_f32 v69, v69
    v_exp_f32 v70, v70
    v_smfmac_f32_32x32x32_bf16 v[48:63], v[168:171], v[112:119], v17
    ds_read_b128 v[164:167], v31 offset:49152
    v_exp_f32 v71, v71
    v_exp_f32 v72, v72
    v_exp_f32 v73, v73
    v_exp_f32 v74, v74
    v_smfmac_f32_32x32x32_bf16 v[48:63], v[172:175], v[120:127], v17
    s_waitcnt lgkmcnt(2)
    v_exp_f32 v75, v75
    v_exp_f32 v76, v76
    v_exp_f32 v77, v77
    v_exp_f32 v78, v78
    v_exp_f32 v79, v79
    v_mfma_f32_32x32x8_bf16 v[96:111], v[150:151], v[136:137], 0
    v_exp_f32 v80, v80
    v_exp_f32 v81, v81
    v_exp_f32 v82, v82
    v_exp_f32 v83, v83
    v_mfma_f32_32x32x16_bf16 v[96:111], v[144:147], v[128:131], v[96:111]
    s_waitcnt lgkmcnt(0)
    ds_read2st64_b64 v[140:143], v28 offset0:108 offset1:109
    v_exp_f32 v84, v84
    v_exp_f32 v85, v85
    v_exp_f32 v86, v86
    v_smfmac_f32_32x32x32_bf16 v[32:47], v[160:163], v[64:71], v17
    ds_read2st64_b64 v[152:155], v29 offset0:108 offset1:114
    v_exp_f32 v87, v87
    v_exp_f32 v88, v88
    v_exp_f32 v89, v89
    v_exp_f32 v90, v90
    v_smfmac_f32_32x32x32_bf16 v[32:47], v[164:167], v[72:79], v17
    v_exp_f32 v91, v91
    v_exp_f32 v92, v92
    v_exp_f32 v93, v93
    v_exp_f32 v94, v94
    v_exp_f32 v95, v95
    v_mfma_f32_32x32x8_bf16 v[112:127], v[150:151], v[138:139], 0
    v_exp_f32 v96, v96
    v_exp_f32 v97, v97
    v_exp_f32 v98, v98
    v_exp_f32 v99, v99
    v_mfma_f32_32x32x16_bf16 v[112:127], v[144:147], v[132:135], v[112:127]
    ds_read_b128 v[168:171], v30 offset:52224
    v_exp_f32 v100, v100
    v_exp_f32 v101, v101
    v_exp_f32 v102, v102
    v_smfmac_f32_32x32x32_bf16 v[48:63], v[160:163], v[80:87], v17
    ds_read_b128 v[172:175], v31 offset:52224
    v_exp_f32 v103, v103
    v_exp_f32 v104, v104
    v_exp_f32 v105, v105
    v_exp_f32 v106, v106
    v_smfmac_f32_32x32x32_bf16 v[48:63], v[164:167], v[88:95], v17
    s_waitcnt lgkmcnt(2)
    v_exp_f32 v107, v107
    v_exp_f32 v108, v108
    v_exp_f32 v109, v109
    v_exp_f32 v110, v110
    v_exp_f32 v111, v111
    v_mfma_f32_32x32x8_bf16 v[64:79], v[152:153], v[136:137], 0
    v_exp_f32 v112, v112
    v_exp_f32 v113, v113
    v_exp_f32 v114, v114
    v_exp_f32 v115, v115
    v_mfma_f32_32x32x16_bf16 v[64:79], v[140:143], v[128:131], v[64:79]
    s_waitcnt lgkmcnt(0)
    ds_read2st64_b64 v[144:147], v28 offset0:114 offset1:115
    v_exp_f32 v116, v116
    v_exp_f32 v117, v117
    v_exp_f32 v118, v118
    v_smfmac_f32_32x32x32_bf16 v[32:47], v[168:171], v[96:103], v17
    v_exp_f32 v119, v119
    v_exp_f32 v120, v120
    v_exp_f32 v121, v121
    v_exp_f32 v122, v122
    v_smfmac_f32_32x32x32_bf16 v[32:47], v[172:175], v[104:111], v17
    v_exp_f32 v123, v123
    v_exp_f32 v124, v124
    v_exp_f32 v125, v125
    v_exp_f32 v126, v126
    v_exp_f32 v127, v127
    v_mfma_f32_32x32x8_bf16 v[80:95], v[152:153], v[138:139], 0
    v_exp_f32 v64, v64
    v_exp_f32 v65, v65
    v_exp_f32 v66, v66
    v_exp_f32 v67, v67
    v_mfma_f32_32x32x16_bf16 v[80:95], v[140:143], v[132:135], v[80:95]
    ds_read_b128 v[160:163], v30 offset:55296
    v_exp_f32 v68, v68
    v_exp_f32 v69, v69
    v_exp_f32 v70, v70
    v_smfmac_f32_32x32x32_bf16 v[48:63], v[168:171], v[112:119], v17
    ds_read_b128 v[164:167], v31 offset:55296
    v_exp_f32 v71, v71
    v_exp_f32 v72, v72
    v_exp_f32 v73, v73
    v_exp_f32 v74, v74
    v_smfmac_f32_32x32x32_bf16 v[48:63], v[172:175], v[120:127], v17
    s_waitcnt lgkmcnt(2)
    v_exp_f32 v75, v75
    v_exp_f32 v76, v76
    v_exp_f32 v77, v77
    v_exp_f32 v78, v78
    v_exp_f32 v79, v79
    v_mfma_f32_32x32x8_bf16 v[96:111], v[154:155], v[136:137], 0
    v_exp_f32 v80, v80
    v_exp_f32 v81, v81
    v_exp_f32 v82, v82
    v_exp_f32 v83, v83
    v_mfma_f32_32x32x16_bf16 v[96:111], v[144:147], v[128:131], v[96:111]
    s_waitcnt lgkmcnt(0)
    ds_read2st64_b64 v[140:143], v28 offset0:120 offset1:121
    v_exp_f32 v84, v84
    v_exp_f32 v85, v85
    v_exp_f32 v86, v86
    v_smfmac_f32_32x32x32_bf16 v[32:47], v[160:163], v[64:71], v17
    ds_read2st64_b64 v[148:151], v29 offset0:120 offset1:126
    v_exp_f32 v87, v87
    v_exp_f32 v88, v88
    v_exp_f32 v89, v89
    v_exp_f32 v90, v90
    v_smfmac_f32_32x32x32_bf16 v[32:47], v[164:167], v[72:79], v17
    v_exp_f32 v91, v91
    v_exp_f32 v92, v92
    v_exp_f32 v93, v93
    v_exp_f32 v94, v94
    v_exp_f32 v95, v95
    v_mfma_f32_32x32x8_bf16 v[112:127], v[154:155], v[138:139], 0
    v_exp_f32 v96, v96
    v_exp_f32 v97, v97
    v_exp_f32 v98, v98
    v_exp_f32 v99, v99
    v_mfma_f32_32x32x16_bf16 v[112:127], v[144:147], v[132:135], v[112:127]
    ds_read_b128 v[168:171], v30 offset:58368
    v_exp_f32 v100, v100
    v_exp_f32 v101, v101
    v_exp_f32 v102, v102
    v_smfmac_f32_32x32x32_bf16 v[48:63], v[160:163], v[80:87], v17
    ds_read_b128 v[172:175], v31 offset:58368
    v_exp_f32 v103, v103
    v_exp_f32 v104, v104
    v_exp_f32 v105, v105
    v_exp_f32 v106, v106
    v_smfmac_f32_32x32x32_bf16 v[48:63], v[164:167], v[88:95], v17
    s_waitcnt lgkmcnt(2)
    v_exp_f32 v107, v107
    v_exp_f32 v108, v108
    v_exp_f32 v109, v109
    v_exp_f32 v110, v110
    v_exp_f32 v111, v111
    v_mfma_f32_32x32x8_bf16 v[64:79], v[148:149], v[136:137], 0
    v_exp_f32 v112, v112
    v_exp_f32 v113, v113
    v_exp_f32 v114, v114
    v_exp_f32 v115, v115
    v_mfma_f32_32x32x16_bf16 v[64:79], v[140:143], v[128:131], v[64:79]
    s_waitcnt lgkmcnt(0)
    ds_read2st64_b64 v[144:147], v28 offset0:126 offset1:127
    v_exp_f32 v116, v116
    v_exp_f32 v117, v117
    v_exp_f32 v118, v118
    v_smfmac_f32_32x32x32_bf16 v[32:47], v[168:171], v[96:103], v17
    v_exp_f32 v119, v119
    v_exp_f32 v120, v120
    v_exp_f32 v121, v121
    v_exp_f32 v122, v122
    v_smfmac_f32_32x32x32_bf16 v[32:47], v[172:175], v[104:111], v17
    v_exp_f32 v123, v123
    v_exp_f32 v124, v124
    v_exp_f32 v125, v125
    v_exp_f32 v126, v126
    v_exp_f32 v127, v127
    v_mfma_f32_32x32x8_bf16 v[80:95], v[148:149], v[138:139], 0
    v_exp_f32 v64, v64
    v_exp_f32 v65, v65
    v_exp_f32 v66, v66
    v_exp_f32 v67, v67
    v_mfma_f32_32x32x16_bf16 v[80:95], v[140:143], v[132:135], v[80:95]
    ds_read_b128 v[160:163], v30 offset:61440
    v_exp_f32 v68, v68
    v_exp_f32 v69, v69
    v_exp_f32 v70, v70
    v_smfmac_f32_32x32x32_bf16 v[48:63], v[168:171], v[112:119], v17
    ds_read_b128 v[164:167], v31 offset:61440
    v_exp_f32 v71, v71
    v_exp_f32 v72, v72
    v_exp_f32 v73, v73
    v_exp_f32 v74, v74
    v_smfmac_f32_32x32x32_bf16 v[48:63], v[172:175], v[120:127], v17
    s_waitcnt lgkmcnt(2)
    v_exp_f32 v75, v75
    v_exp_f32 v76, v76
    v_exp_f32 v77, v77
    v_exp_f32 v78, v78
    v_exp_f32 v79, v79
    v_mfma_f32_32x32x8_bf16 v[96:111], v[150:151], v[136:137], 0
    v_exp_f32 v80, v80
    v_exp_f32 v81, v81
    v_exp_f32 v82, v82
    v_exp_f32 v83, v83
    v_mfma_f32_32x32x16_bf16 v[96:111], v[144:147], v[128:131], v[96:111]
    s_waitcnt lgkmcnt(0)
    ds_read2st64_b64 v[140:143], v28 offset0:132 offset1:133
    v_exp_f32 v84, v84
    v_exp_f32 v85, v85
    v_exp_f32 v86, v86
    v_smfmac_f32_32x32x32_bf16 v[32:47], v[160:163], v[64:71], v17
    ds_read2st64_b64 v[152:155], v29 offset0:132 offset1:138
    v_exp_f32 v87, v87
    v_exp_f32 v88, v88
    v_exp_f32 v89, v89
    v_exp_f32 v90, v90
    v_smfmac_f32_32x32x32_bf16 v[32:47], v[164:167], v[72:79], v17
    v_exp_f32 v91, v91
    v_exp_f32 v92, v92
    v_exp_f32 v93, v93
    v_exp_f32 v94, v94
    v_exp_f32 v95, v95
    v_mfma_f32_32x32x8_bf16 v[112:127], v[150:151], v[138:139], 0
    v_exp_f32 v96, v96
    v_exp_f32 v97, v97
    v_exp_f32 v98, v98
    v_exp_f32 v99, v99
    v_mfma_f32_32x32x16_bf16 v[112:127], v[144:147], v[132:135], v[112:127]
    ds_read_b128 v[168:171], v30 offset:64512
    v_exp_f32 v100, v100
    v_exp_f32 v101, v101
    v_exp_f32 v102, v102
    v_smfmac_f32_32x32x32_bf16 v[48:63], v[160:163], v[80:87], v17
    ds_read_b128 v[172:175], v31 offset:64512
    v_exp_f32 v103, v103
    v_exp_f32 v104, v104
    v_exp_f32 v105, v105
    v_exp_f32 v106, v106
    v_smfmac_f32_32x32x32_bf16 v[48:63], v[164:167], v[88:95], v17
    s_waitcnt lgkmcnt(2)
    v_exp_f32 v107, v107
    v_exp_f32 v108, v108
    v_exp_f32 v109, v109
    v_exp_f32 v110, v110
    v_exp_f32 v111, v111
    v_mfma_f32_32x32x8_bf16 v[64:79], v[152:153], v[136:137], 0
    v_exp_f32 v112, v112
    v_exp_f32 v113, v113
    v_exp_f32 v114, v114
    v_exp_f32 v115, v115
    v_mfma_f32_32x32x16_bf16 v[64:79], v[140:143], v[128:131], v[64:79]
    s_waitcnt lgkmcnt(0)
    ds_read2st64_b64 v[144:147], v28 offset0:138 offset1:139
    v_exp_f32 v116, v116
    v_exp_f32 v117, v117
    v_exp_f32 v118, v118
    v_smfmac_f32_32x32x32_bf16 v[32:47], v[168:171], v[96:103], v17
    v_exp_f32 v119, v119
    v_exp_f32 v120, v120
    v_exp_f32 v121, v121
    v_exp_f32 v122, v122
    v_smfmac_f32_32x32x32_bf16 v[32:47], v[172:175], v[104:111], v17
    v_exp_f32 v123, v123
    v_exp_f32 v124, v124
    v_exp_f32 v125, v125
    v_exp_f32 v126, v126
    v_exp_f32 v127, v127
    v_mfma_f32_32x32x8_bf16 v[80:95], v[152:153], v[138:139], 0
    v_exp_f32 v64, v64
    v_exp_f32 v65, v65
    v_exp_f32 v66, v66
    v_exp_f32 v67, v67
    v_mfma_f32_32x32x16_bf16 v[80:95], v[140:143], v[132:135], v[80:95]
    v_add_u32 v30, 67584, v30
    ds_read_b128 v[160:163], v30 offset:0
    v_exp_f32 v68, v68
    v_exp_f32 v69, v69
    v_exp_f32 v70, v70
    v_smfmac_f32_32x32x32_bf16 v[48:63], v[168:171], v[112:119], v17
    v_add_u32 v31, 67584, v31
    ds_read_b128 v[164:167], v31 offset:0
    v_exp_f32 v71, v71
    v_exp_f32 v72, v72
    v_exp_f32 v73, v73
    v_exp_f32 v74, v74
    v_smfmac_f32_32x32x32_bf16 v[48:63], v[172:175], v[120:127], v17
    s_waitcnt lgkmcnt(2)
    v_exp_f32 v75, v75
    v_exp_f32 v76, v76
    v_exp_f32 v77, v77
    v_exp_f32 v78, v78
    v_exp_f32 v79, v79
    v_mfma_f32_32x32x8_bf16 v[96:111], v[154:155], v[136:137], 0
    v_exp_f32 v80, v80
    v_exp_f32 v81, v81
    v_exp_f32 v82, v82
    v_exp_f32 v83, v83
    v_mfma_f32_32x32x16_bf16 v[96:111], v[144:147], v[128:131], v[96:111]
    s_waitcnt lgkmcnt(0)
    s_barrier
    ds_read2st64_b64 v[140:143], v28 offset0:144 offset1:145
    v_exp_f32 v84, v84
    v_exp_f32 v85, v85
    v_exp_f32 v86, v86
    v_smfmac_f32_32x32x32_bf16 v[32:47], v[160:163], v[64:71], v17
    ds_read2st64_b64 v[148:151], v29 offset0:144 offset1:150
    v_exp_f32 v87, v87
    v_exp_f32 v88, v88
    v_exp_f32 v89, v89
    v_exp_f32 v90, v90
    v_smfmac_f32_32x32x32_bf16 v[32:47], v[164:167], v[72:79], v17
    v_exp_f32 v91, v91
    v_exp_f32 v92, v92
    v_exp_f32 v93, v93
    v_exp_f32 v94, v94
    v_exp_f32 v95, v95
    v_mfma_f32_32x32x8_bf16 v[112:127], v[154:155], v[138:139], 0
    v_exp_f32 v96, v96
    v_exp_f32 v97, v97
    v_exp_f32 v98, v98
    v_exp_f32 v99, v99
    v_mfma_f32_32x32x16_bf16 v[112:127], v[144:147], v[132:135], v[112:127]
    ds_read_b128 v[168:171], v30 offset:3072
    v_exp_f32 v100, v100
    v_exp_f32 v101, v101
    v_exp_f32 v102, v102
    v_smfmac_f32_32x32x32_bf16 v[48:63], v[160:163], v[80:87], v17
    ds_read_b128 v[172:175], v31 offset:3072
    v_exp_f32 v103, v103
    v_exp_f32 v104, v104
    v_exp_f32 v105, v105
    v_exp_f32 v106, v106
    v_smfmac_f32_32x32x32_bf16 v[48:63], v[164:167], v[88:95], v17
    s_waitcnt lgkmcnt(2)
    v_exp_f32 v107, v107
    v_exp_f32 v108, v108
    v_exp_f32 v109, v109
    v_exp_f32 v110, v110
    v_exp_f32 v111, v111
    v_mfma_f32_32x32x8_bf16 v[64:79], v[148:149], v[136:137], 0
    v_exp_f32 v112, v112
    v_exp_f32 v113, v113
    v_exp_f32 v114, v114
    v_exp_f32 v115, v115
    v_mfma_f32_32x32x16_bf16 v[64:79], v[140:143], v[128:131], v[64:79]
    s_waitcnt lgkmcnt(0)
    ds_read2st64_b64 v[144:147], v28 offset0:150 offset1:151
    v_exp_f32 v116, v116
    v_exp_f32 v117, v117
    v_exp_f32 v118, v118
    v_smfmac_f32_32x32x32_bf16 v[32:47], v[168:171], v[96:103], v17
    v_exp_f32 v119, v119
    v_exp_f32 v120, v120
    v_exp_f32 v121, v121
    v_exp_f32 v122, v122
    v_smfmac_f32_32x32x32_bf16 v[32:47], v[172:175], v[104:111], v17
    v_exp_f32 v123, v123
    v_exp_f32 v124, v124
    v_exp_f32 v125, v125
    v_exp_f32 v126, v126
    v_exp_f32 v127, v127
    v_mfma_f32_32x32x8_bf16 v[80:95], v[148:149], v[138:139], 0
    v_exp_f32 v64, v64
    v_exp_f32 v65, v65
    v_exp_f32 v66, v66
    v_exp_f32 v67, v67
    v_mfma_f32_32x32x16_bf16 v[80:95], v[140:143], v[132:135], v[80:95]
    ds_read_b128 v[160:163], v30 offset:6144
    v_exp_f32 v68, v68
    v_exp_f32 v69, v69
    v_exp_f32 v70, v70
    v_smfmac_f32_32x32x32_bf16 v[48:63], v[168:171], v[112:119], v17
    ds_read_b128 v[164:167], v31 offset:6144
    v_exp_f32 v71, v71
    v_exp_f32 v72, v72
    v_exp_f32 v73, v73
    v_exp_f32 v74, v74
    v_smfmac_f32_32x32x32_bf16 v[48:63], v[172:175], v[120:127], v17
    s_waitcnt lgkmcnt(2)
    v_exp_f32 v75, v75
    v_exp_f32 v76, v76
    v_exp_f32 v77, v77
    v_exp_f32 v78, v78
    v_exp_f32 v79, v79
    v_mfma_f32_32x32x8_bf16 v[96:111], v[150:151], v[136:137], 0
    v_exp_f32 v80, v80
    v_exp_f32 v81, v81
    v_exp_f32 v82, v82
    v_exp_f32 v83, v83
    v_mfma_f32_32x32x16_bf16 v[96:111], v[144:147], v[128:131], v[96:111]
    s_waitcnt lgkmcnt(0)
    ds_read2st64_b64 v[140:143], v28 offset0:156 offset1:157
    v_exp_f32 v84, v84
    v_exp_f32 v85, v85
    v_exp_f32 v86, v86
    v_smfmac_f32_32x32x32_bf16 v[32:47], v[160:163], v[64:71], v17
    ds_read2st64_b64 v[152:155], v29 offset0:156 offset1:162
    v_exp_f32 v87, v87
    v_exp_f32 v88, v88
    v_exp_f32 v89, v89
    v_exp_f32 v90, v90
    v_smfmac_f32_32x32x32_bf16 v[32:47], v[164:167], v[72:79], v17
    v_exp_f32 v91, v91
    v_exp_f32 v92, v92
    v_exp_f32 v93, v93
    v_exp_f32 v94, v94
    v_exp_f32 v95, v95
    v_mfma_f32_32x32x8_bf16 v[112:127], v[150:151], v[138:139], 0
    v_exp_f32 v96, v96
    v_exp_f32 v97, v97
    v_exp_f32 v98, v98
    v_exp_f32 v99, v99
    v_mfma_f32_32x32x16_bf16 v[112:127], v[144:147], v[132:135], v[112:127]
    ds_read_b128 v[168:171], v30 offset:9216
    v_exp_f32 v100, v100
    v_exp_f32 v101, v101
    v_exp_f32 v102, v102
    v_smfmac_f32_32x32x32_bf16 v[48:63], v[160:163], v[80:87], v17
    ds_read_b128 v[172:175], v31 offset:9216
    v_exp_f32 v103, v103
    v_exp_f32 v104, v104
    v_exp_f32 v105, v105
    v_exp_f32 v106, v106
    v_smfmac_f32_32x32x32_bf16 v[48:63], v[164:167], v[88:95], v17
    s_waitcnt lgkmcnt(2)
    v_exp_f32 v107, v107
    v_exp_f32 v108, v108
    v_exp_f32 v109, v109
    v_exp_f32 v110, v110
    v_exp_f32 v111, v111
    v_mfma_f32_32x32x8_bf16 v[64:79], v[152:153], v[136:137], 0
    v_exp_f32 v112, v112
    v_exp_f32 v113, v113
    v_exp_f32 v114, v114
    v_exp_f32 v115, v115
    v_mfma_f32_32x32x16_bf16 v[64:79], v[140:143], v[128:131], v[64:79]
    s_waitcnt lgkmcnt(0)
    ds_read2st64_b64 v[144:147], v28 offset0:162 offset1:163
    v_exp_f32 v116, v116
    v_exp_f32 v117, v117
    v_exp_f32 v118, v118
    v_smfmac_f32_32x32x32_bf16 v[32:47], v[168:171], v[96:103], v17
    v_exp_f32 v119, v119
    v_exp_f32 v120, v120
    v_exp_f32 v121, v121
    v_exp_f32 v122, v122
    v_smfmac_f32_32x32x32_bf16 v[32:47], v[172:175], v[104:111], v17
    v_exp_f32 v123, v123
    v_exp_f32 v124, v124
    v_exp_f32 v125, v125
    v_exp_f32 v126, v126
    v_exp_f32 v127, v127
    v_mfma_f32_32x32x8_bf16 v[80:95], v[152:153], v[138:139], 0
    v_exp_f32 v64, v64
    v_exp_f32 v65, v65
    v_exp_f32 v66, v66
    v_exp_f32 v67, v67
    v_mfma_f32_32x32x16_bf16 v[80:95], v[140:143], v[132:135], v[80:95]
    ds_read_b128 v[160:163], v30 offset:12288
    v_exp_f32 v68, v68
    v_exp_f32 v69, v69
    v_exp_f32 v70, v70
    v_smfmac_f32_32x32x32_bf16 v[48:63], v[168:171], v[112:119], v17
    ds_read_b128 v[164:167], v31 offset:12288
    v_exp_f32 v71, v71
    v_exp_f32 v72, v72
    v_exp_f32 v73, v73
    v_exp_f32 v74, v74
    v_smfmac_f32_32x32x32_bf16 v[48:63], v[172:175], v[120:127], v17
    s_waitcnt lgkmcnt(2)
    v_exp_f32 v75, v75
    v_exp_f32 v76, v76
    v_exp_f32 v77, v77
    v_exp_f32 v78, v78
    v_exp_f32 v79, v79
    v_mfma_f32_32x32x8_bf16 v[96:111], v[154:155], v[136:137], 0
    v_exp_f32 v80, v80
    v_exp_f32 v81, v81
    v_exp_f32 v82, v82
    v_exp_f32 v83, v83
    v_mfma_f32_32x32x16_bf16 v[96:111], v[144:147], v[128:131], v[96:111]
    s_waitcnt lgkmcnt(0)
    ds_read2st64_b64 v[140:143], v28 offset0:168 offset1:169
    v_exp_f32 v84, v84
    v_exp_f32 v85, v85
    v_exp_f32 v86, v86
    v_smfmac_f32_32x32x32_bf16 v[32:47], v[160:163], v[64:71], v17
    ds_read2st64_b64 v[148:151], v29 offset0:168 offset1:174
    v_exp_f32 v87, v87
    v_exp_f32 v88, v88
    v_exp_f32 v89, v89
    v_exp_f32 v90, v90
    v_smfmac_f32_32x32x32_bf16 v[32:47], v[164:167], v[72:79], v17
    v_exp_f32 v91, v91
    v_exp_f32 v92, v92
    v_exp_f32 v93, v93
    v_exp_f32 v94, v94
    v_exp_f32 v95, v95
    v_mfma_f32_32x32x8_bf16 v[112:127], v[154:155], v[138:139], 0
    v_exp_f32 v96, v96
    v_exp_f32 v97, v97
    v_exp_f32 v98, v98
    v_exp_f32 v99, v99
    v_mfma_f32_32x32x16_bf16 v[112:127], v[144:147], v[132:135], v[112:127]
    ds_read_b128 v[168:171], v30 offset:15360
    v_exp_f32 v100, v100
    v_exp_f32 v101, v101
    v_exp_f32 v102, v102
    v_smfmac_f32_32x32x32_bf16 v[48:63], v[160:163], v[80:87], v17
    ds_read_b128 v[172:175], v31 offset:15360
    v_exp_f32 v103, v103
    v_exp_f32 v104, v104
    v_exp_f32 v105, v105
    v_exp_f32 v106, v106
    v_smfmac_f32_32x32x32_bf16 v[48:63], v[164:167], v[88:95], v17
    s_waitcnt lgkmcnt(2)
    v_exp_f32 v107, v107
    v_exp_f32 v108, v108
    v_exp_f32 v109, v109
    v_exp_f32 v110, v110
    v_exp_f32 v111, v111
    v_mfma_f32_32x32x8_bf16 v[64:79], v[148:149], v[136:137], 0
    v_exp_f32 v112, v112
    v_exp_f32 v113, v113
    v_exp_f32 v114, v114
    v_exp_f32 v115, v115
    v_mfma_f32_32x32x16_bf16 v[64:79], v[140:143], v[128:131], v[64:79]
    s_waitcnt lgkmcnt(0)
    ds_read2st64_b64 v[144:147], v28 offset0:174 offset1:175
    v_exp_f32 v116, v116
    v_exp_f32 v117, v117
    v_exp_f32 v118, v118
    v_smfmac_f32_32x32x32_bf16 v[32:47], v[168:171], v[96:103], v17
    v_exp_f32 v119, v119
    v_exp_f32 v120, v120
    v_exp_f32 v121, v121
    v_exp_f32 v122, v122
    v_smfmac_f32_32x32x32_bf16 v[32:47], v[172:175], v[104:111], v17
    v_exp_f32 v123, v123
    v_exp_f32 v124, v124
    v_exp_f32 v125, v125
    v_exp_f32 v126, v126
    v_exp_f32 v127, v127
    v_mfma_f32_32x32x8_bf16 v[80:95], v[148:149], v[138:139], 0
    v_exp_f32 v64, v64
    v_exp_f32 v65, v65
    v_exp_f32 v66, v66
    v_exp_f32 v67, v67
    v_mfma_f32_32x32x16_bf16 v[80:95], v[140:143], v[132:135], v[80:95]
    ds_read_b128 v[160:163], v30 offset:18432
    v_exp_f32 v68, v68
    v_exp_f32 v69, v69
    v_exp_f32 v70, v70
    v_smfmac_f32_32x32x32_bf16 v[48:63], v[168:171], v[112:119], v17
    ds_read_b128 v[164:167], v31 offset:18432
    v_exp_f32 v71, v71
    v_exp_f32 v72, v72
    v_exp_f32 v73, v73
    v_exp_f32 v74, v74
    v_smfmac_f32_32x32x32_bf16 v[48:63], v[172:175], v[120:127], v17
    s_waitcnt lgkmcnt(2)
    v_exp_f32 v75, v75
    v_exp_f32 v76, v76
    v_exp_f32 v77, v77
    v_exp_f32 v78, v78
    v_exp_f32 v79, v79
    v_mfma_f32_32x32x8_bf16 v[96:111], v[150:151], v[136:137], 0
    v_exp_f32 v80, v80
    v_exp_f32 v81, v81
    v_exp_f32 v82, v82
    v_exp_f32 v83, v83
    v_mfma_f32_32x32x16_bf16 v[96:111], v[144:147], v[128:131], v[96:111]
    s_waitcnt lgkmcnt(0)
    ds_read2st64_b64 v[140:143], v28 offset0:180 offset1:181
    v_exp_f32 v84, v84
    v_exp_f32 v85, v85
    v_exp_f32 v86, v86
    v_smfmac_f32_32x32x32_bf16 v[32:47], v[160:163], v[64:71], v17
    ds_read2st64_b64 v[152:155], v29 offset0:180 offset1:186
    v_exp_f32 v87, v87
    v_exp_f32 v88, v88
    v_exp_f32 v89, v89
    v_exp_f32 v90, v90
    v_smfmac_f32_32x32x32_bf16 v[32:47], v[164:167], v[72:79], v17
    v_exp_f32 v91, v91
    v_exp_f32 v92, v92
    v_exp_f32 v93, v93
    v_exp_f32 v94, v94
    v_exp_f32 v95, v95
    v_mfma_f32_32x32x8_bf16 v[112:127], v[150:151], v[138:139], 0
    v_exp_f32 v96, v96
    v_exp_f32 v97, v97
    v_exp_f32 v98, v98
    v_exp_f32 v99, v99
    v_mfma_f32_32x32x16_bf16 v[112:127], v[144:147], v[132:135], v[112:127]
    ds_read_b128 v[168:171], v30 offset:21504
    v_exp_f32 v100, v100
    v_exp_f32 v101, v101
    v_exp_f32 v102, v102
    v_smfmac_f32_32x32x32_bf16 v[48:63], v[160:163], v[80:87], v17
    ds_read_b128 v[172:175], v31 offset:21504
    v_exp_f32 v103, v103
    v_exp_f32 v104, v104
    v_exp_f32 v105, v105
    v_exp_f32 v106, v106
    v_smfmac_f32_32x32x32_bf16 v[48:63], v[164:167], v[88:95], v17
    s_waitcnt lgkmcnt(2)
    v_exp_f32 v107, v107
    v_exp_f32 v108, v108
    v_exp_f32 v109, v109
    v_exp_f32 v110, v110
    v_exp_f32 v111, v111
    v_mfma_f32_32x32x8_bf16 v[64:79], v[152:153], v[136:137], 0
    v_exp_f32 v112, v112
    v_exp_f32 v113, v113
    v_exp_f32 v114, v114
    v_exp_f32 v115, v115
    v_mfma_f32_32x32x16_bf16 v[64:79], v[140:143], v[128:131], v[64:79]
    s_waitcnt lgkmcnt(0)
    ds_read2st64_b64 v[144:147], v28 offset0:186 offset1:187
    v_exp_f32 v116, v116
    v_exp_f32 v117, v117
    v_exp_f32 v118, v118
    v_smfmac_f32_32x32x32_bf16 v[32:47], v[168:171], v[96:103], v17
    v_exp_f32 v119, v119
    v_exp_f32 v120, v120
    v_exp_f32 v121, v121
    v_exp_f32 v122, v122
    v_smfmac_f32_32x32x32_bf16 v[32:47], v[172:175], v[104:111], v17
    v_exp_f32 v123, v123
    v_exp_f32 v124, v124
    v_exp_f32 v125, v125
    v_exp_f32 v126, v126
    v_exp_f32 v127, v127
    v_mfma_f32_32x32x8_bf16 v[80:95], v[152:153], v[138:139], 0
    v_exp_f32 v64, v64
    v_exp_f32 v65, v65
    v_exp_f32 v66, v66
    v_exp_f32 v67, v67
    v_mfma_f32_32x32x16_bf16 v[80:95], v[140:143], v[132:135], v[80:95]
    ds_read_b128 v[160:163], v30 offset:24576
    v_exp_f32 v68, v68
    v_exp_f32 v69, v69
    v_exp_f32 v70, v70
    v_smfmac_f32_32x32x32_bf16 v[48:63], v[168:171], v[112:119], v17
    ds_read_b128 v[164:167], v31 offset:24576
    v_exp_f32 v71, v71
    v_exp_f32 v72, v72
    v_exp_f32 v73, v73
    v_exp_f32 v74, v74
    v_smfmac_f32_32x32x32_bf16 v[48:63], v[172:175], v[120:127], v17
    s_waitcnt lgkmcnt(2)
    v_exp_f32 v75, v75
    v_exp_f32 v76, v76
    v_exp_f32 v77, v77
    v_exp_f32 v78, v78
    v_exp_f32 v79, v79
    v_mfma_f32_32x32x8_bf16 v[96:111], v[154:155], v[136:137], 0
    v_exp_f32 v80, v80
    v_exp_f32 v81, v81
    v_exp_f32 v82, v82
    v_exp_f32 v83, v83
    v_mfma_f32_32x32x16_bf16 v[96:111], v[144:147], v[128:131], v[96:111]
    s_waitcnt lgkmcnt(0)
    ds_read2st64_b64 v[140:143], v28 offset0:192 offset1:193
    v_exp_f32 v84, v84
    v_exp_f32 v85, v85
    v_exp_f32 v86, v86
    v_smfmac_f32_32x32x32_bf16 v[32:47], v[160:163], v[64:71], v17
    ds_read2st64_b64 v[148:151], v29 offset0:192 offset1:198
    v_exp_f32 v87, v87
    v_exp_f32 v88, v88
    v_exp_f32 v89, v89
    v_exp_f32 v90, v90
    v_smfmac_f32_32x32x32_bf16 v[32:47], v[164:167], v[72:79], v17
    v_exp_f32 v91, v91
    v_exp_f32 v92, v92
    v_exp_f32 v93, v93
    v_exp_f32 v94, v94
    v_exp_f32 v95, v95
    v_mfma_f32_32x32x8_bf16 v[112:127], v[154:155], v[138:139], 0
    v_exp_f32 v96, v96
    v_exp_f32 v97, v97
    v_exp_f32 v98, v98
    v_exp_f32 v99, v99
    v_mfma_f32_32x32x16_bf16 v[112:127], v[144:147], v[132:135], v[112:127]
    ds_read_b128 v[168:171], v30 offset:27648
    v_exp_f32 v100, v100
    v_exp_f32 v101, v101
    v_exp_f32 v102, v102
    v_smfmac_f32_32x32x32_bf16 v[48:63], v[160:163], v[80:87], v17
    ds_read_b128 v[172:175], v31 offset:27648
    v_exp_f32 v103, v103
    v_exp_f32 v104, v104
    v_exp_f32 v105, v105
    v_exp_f32 v106, v106
    v_smfmac_f32_32x32x32_bf16 v[48:63], v[164:167], v[88:95], v17
    s_waitcnt lgkmcnt(2)
    v_exp_f32 v107, v107
    v_exp_f32 v108, v108
    v_exp_f32 v109, v109
    v_exp_f32 v110, v110
    v_exp_f32 v111, v111
    v_mfma_f32_32x32x8_bf16 v[64:79], v[148:149], v[136:137], 0
    v_exp_f32 v112, v112
    v_exp_f32 v113, v113
    v_exp_f32 v114, v114
    v_exp_f32 v115, v115
    v_mfma_f32_32x32x16_bf16 v[64:79], v[140:143], v[128:131], v[64:79]
    s_waitcnt lgkmcnt(0)
    ds_read2st64_b64 v[144:147], v28 offset0:198 offset1:199
    v_exp_f32 v116, v116
    v_exp_f32 v117, v117
    v_exp_f32 v118, v118
    v_smfmac_f32_32x32x32_bf16 v[32:47], v[168:171], v[96:103], v17
    v_exp_f32 v119, v119
    v_exp_f32 v120, v120
    v_exp_f32 v121, v121
    v_exp_f32 v122, v122
    v_smfmac_f32_32x32x32_bf16 v[32:47], v[172:175], v[104:111], v17
    v_exp_f32 v123, v123
    v_exp_f32 v124, v124
    v_exp_f32 v125, v125
    v_exp_f32 v126, v126
    v_exp_f32 v127, v127
    v_mfma_f32_32x32x8_bf16 v[80:95], v[148:149], v[138:139], 0
    v_exp_f32 v64, v64
    v_exp_f32 v65, v65
    v_exp_f32 v66, v66
    v_exp_f32 v67, v67
    v_mfma_f32_32x32x16_bf16 v[80:95], v[140:143], v[132:135], v[80:95]
    ds_read_b128 v[160:163], v30 offset:30720
    v_exp_f32 v68, v68
    v_exp_f32 v69, v69
    v_exp_f32 v70, v70
    v_smfmac_f32_32x32x32_bf16 v[48:63], v[168:171], v[112:119], v17
    ds_read_b128 v[164:167], v31 offset:30720
    v_exp_f32 v71, v71
    v_exp_f32 v72, v72
    v_exp_f32 v73, v73
    v_exp_f32 v74, v74
    v_smfmac_f32_32x32x32_bf16 v[48:63], v[172:175], v[120:127], v17
    s_waitcnt lgkmcnt(2)
    v_exp_f32 v75, v75
    v_exp_f32 v76, v76
    v_exp_f32 v77, v77
    v_exp_f32 v78, v78
    v_exp_f32 v79, v79
    v_mfma_f32_32x32x8_bf16 v[96:111], v[150:151], v[136:137], 0
    v_exp_f32 v80, v80
    v_exp_f32 v81, v81
    v_exp_f32 v82, v82
    v_exp_f32 v83, v83
    v_mfma_f32_32x32x16_bf16 v[96:111], v[144:147], v[128:131], v[96:111]
    s_waitcnt lgkmcnt(0)
    ds_read2st64_b64 v[140:143], v28 offset0:204 offset1:205
    v_exp_f32 v84, v84
    v_exp_f32 v85, v85
    v_exp_f32 v86, v86
    v_smfmac_f32_32x32x32_bf16 v[32:47], v[160:163], v[64:71], v17
Lpad_at_1:
    s_cbranch_scc1 Lpad_at_2
    ds_read2st64_b64 v[152:155], v29 offset0:204 offset1:210
    v_exp_f32 v87, v87
    v_exp_f32 v88, v88
    v_exp_f32 v89, v89
    v_exp_f32 v90, v90
    v_smfmac_f32_32x32x32_bf16 v[32:47], v[164:167], v[72:79], v17
    v_exp_f32 v91, v91
    v_exp_f32 v92, v92
    v_exp_f32 v93, v93
    v_exp_f32 v94, v94
    v_exp_f32 v95, v95
    v_mfma_f32_32x32x8_bf16 v[112:127], v[150:151], v[138:139], 0
    v_exp_f32 v96, v96
    v_exp_f32 v97, v97
    v_exp_f32 v98, v98
    v_exp_f32 v99, v99
    v_mfma_f32_32x32x16_bf16 v[112:127], v[144:147], v[132:135], v[112:127]
    ds_read_b128 v[168:171], v30 offset:33792
    v_exp_f32 v100, v100
    v_exp_f32 v101, v101
    v_exp_f32 v102, v102
    v_smfmac_f32_32x32x32_bf16 v[48:63], v[160:163], v[80:87], v17
    ds_read_b128 v[172:175], v31 offset:33792
    v_exp_f32 v103, v103
    v_exp_f32 v104, v104
    v_exp_f32 v105, v105
    v_exp_f32 v106, v106
    v_smfmac_f32_32x32x32_bf16 v[48:63], v[164:167], v[88:95], v17
    s_waitcnt lgkmcnt(2)
    v_exp_f32 v107, v107
    v_exp_f32 v108, v108
    v_exp_f32 v109, v109
    v_exp_f32 v110, v110
    v_exp_f32 v111, v111
    v_mfma_f32_32x32x8_bf16 v[64:79], v[152:153], v[136:137], 0
    v_exp_f32 v112, v112
    v_exp_f32 v113, v113
    v_exp_f32 v114, v114
    v_exp_f32 v115, v115
    v_mfma_f32_32x32x16_bf16 v[64:79], v[140:143], v[128:131], v[64:79]
    s_waitcnt lgkmcnt(0)
    ds_read2st64_b64 v[144:147], v28 offset0:210 offset1:211
    v_exp_f32 v116, v116
    v_exp_f32 v117, v117
    v_exp_f32 v118, v118
    v_smfmac_f32_32x32x32_bf16 v[32:47], v[168:171], v[96:103], v17
    v_exp_f32 v119, v119
    v_exp_f32 v120, v120
    v_exp_f32 v121, v121
    v_exp_f32 v122, v122
    v_smfmac_f32_32x32x32_bf16 v[32:47], v[172:175], v[104:111], v17
    v_exp_f32 v123, v123
    v_exp_f32 v124, v124
    v_exp_f32 v125, v125
    v_exp_f32 v126, v126
    v_exp_f32 v127, v127
    v_mfma_f32_32x32x8_bf16 v[80:95], v[152:153], v[138:139], 0
    v_exp_f32 v64, v64
    v_exp_f32 v65, v65
    v_exp_f32 v66, v66
    v_exp_f32 v67, v67
    v_mfma_f32_32x32x16_bf16 v[80:95], v[140:143], v[132:135], v[80:95]
    ds_read_b128 v[160:163], v30 offset:36864
    v_exp_f32 v68, v68
    v_exp_f32 v69, v69
    v_exp_f32 v70, v70
    v_smfmac_f32_32x32x32_bf16 v[48:63], v[168:171], v[112:119], v17
    ds_read_b128 v[164:167], v31 offset:36864
    v_exp_f32 v71, v71
    v_exp_f32 v72, v72
    v_exp_f32 v73, v73
    v_exp_f32 v74, v74
    v_smfmac_f32_32x32x32_bf16 v[48:63], v[172:175], v[120:127], v17
    s_waitcnt lgkmcnt(2)
    v_exp_f32 v75, v75
    v_exp_f32 v76, v76
    v_exp_f32 v77, v77
    v_exp_f32 v78, v78
    v_exp_f32 v79, v79
    v_mfma_f32_32x32x8_bf16 v[96:111], v[154:155], v[136:137], 0
    v_exp_f32 v80, v80
    v_exp_f32 v81, v81
    v_exp_f32 v82, v82
    v_exp_f32 v83, v83
    v_mfma_f32_32x32x16_bf16 v[96:111], v[144:147], v[128:131], v[96:111]
    s_waitcnt lgkmcnt(0)
    ds_read2st64_b64 v[140:143], v28 offset0:216 offset1:217
    v_exp_f32 v84, v84
    v_exp_f32 v85, v85
    v_exp_f32 v86, v86
    v_smfmac_f32_32x32x32_bf16 v[32:47], v[160:163], v[64:71], v17
    ds_read2st64_b64 v[148:151], v29 offset0:216 offset1:222
    v_exp_f32 v87, v87
    v_exp_f32 v88, v88
    v_exp_f32 v89, v89
    v_exp_f32 v90, v90
    v_smfmac_f32_32x32x32_bf16 v[32:47], v[164:167], v[72:79], v17
    v_exp_f32 v91, v91
    v_exp_f32 v92, v92
    v_exp_f32 v93, v93
    v_exp_f32 v94, v94
    v_exp_f32 v95, v95
    v_mfma_f32_32x32x8_bf16 v[112:127], v[154:155], v[138:139], 0
    v_exp_f32 v96, v96
    v_exp_f32 v97, v97
    v_exp_f32 v98, v98
    v_exp_f32 v99, v99
    v_mfma_f32_32x32x16_bf16 v[112:127], v[144:147], v[132:135], v[112:127]
    ds_read_b128 v[168:171], v30 offset:39936
    v_exp_f32 v100, v100
    v_exp_f32 v101, v101
    v_exp_f32 v102, v102
    v_smfmac_f32_32x32x32_bf16 v[48:63], v[160:163], v[80:87], v17
    ds_read_b128 v[172:175], v31 offset:39936
    v_exp_f32 v103, v103
    v_exp_f32 v104, v104
    v_exp_f32 v105, v105
    v_exp_f32 v106, v106
    v_smfmac_f32_32x32x32_bf16 v[48:63], v[164:167], v[88:95], v17
    s_waitcnt lgkmcnt(2)
    v_exp_f32 v107, v107
    v_exp_f32 v108, v108
    v_exp_f32 v109, v109
    v_exp_f32 v110, v110
    v_exp_f32 v111, v111
    v_mfma_f32_32x32x8_bf16 v[64:79], v[148:149], v[136:137], 0
    v_exp_f32 v112, v112
    v_exp_f32 v113, v113
    v_exp_f32 v114, v114
    v_exp_f32 v115, v115
    v_mfma_f32_32x32x16_bf16 v[64:79], v[140:143], v[128:131], v[64:79]
    s_waitcnt lgkmcnt(0)
    ds_read2st64_b64 v[144:147], v28 offset0:222 offset1:223
    v_exp_f32 v116, v116
    v_exp_f32 v117, v117
    v_exp_f32 v118, v118
    v_smfmac_f32_32x32x32_bf16 v[32:47], v[168:171], v[96:103], v17
    v_exp_f32 v119, v119
    v_exp_f32 v120, v120
    v_exp_f32 v121, v121
    v_exp_f32 v122, v122
    v_smfmac_f32_32x32x32_bf16 v[32:47], v[172:175], v[104:111], v17
    v_exp_f32 v123, v123
    v_exp_f32 v124, v124
    v_exp_f32 v125, v125
    v_exp_f32 v126, v126
    v_exp_f32 v127, v127
    v_mfma_f32_32x32x8_bf16 v[80:95], v[148:149], v[138:139], 0
    v_exp_f32 v64, v64
    v_exp_f32 v65, v65
    v_exp_f32 v66, v66
    v_exp_f32 v67, v67
    v_mfma_f32_32x32x16_bf16 v[80:95], v[140:143], v[132:135], v[80:95]
    ds_read_b128 v[160:163], v30 offset:43008
    v_exp_f32 v68, v68
    v_exp_f32 v69, v69
    v_exp_f32 v70, v70
    v_smfmac_f32_32x32x32_bf16 v[48:63], v[168:171], v[112:119], v17
    ds_read_b128 v[164:167], v31 offset:43008
    v_exp_f32 v71, v71
    v_exp_f32 v72, v72
    v_exp_f32 v73, v73
    v_exp_f32 v74, v74
    v_smfmac_f32_32x32x32_bf16 v[48:63], v[172:175], v[120:127], v17
    s_waitcnt lgkmcnt(2)
    v_exp_f32 v75, v75
    v_exp_f32 v76, v76
    v_exp_f32 v77, v77
    v_exp_f32 v78, v78
    v_exp_f32 v79, v79
    v_mfma_f32_32x32x8_bf16 v[96:111], v[150:151], v[136:137], 0
    v_exp_f32 v80, v80
    v_exp_f32 v81, v81
    v_exp_f32 v82, v82
    v_exp_f32 v83, v83
    v_mfma_f32_32x32x16_bf16 v[96:111], v[144:147], v[128:131], v[96:111]
    s_waitcnt lgkmcnt(0)
    ds_read2st64_b64 v[140:143], v28 offset0:228 offset1:229
    v_exp_f32 v84, v84
    v_exp_f32 v85, v85
    v_exp_f32 v86, v86
    v_smfmac_f32_32x32x32_bf16 v[32:47], v[160:163], v[64:71], v17
    ds_read2st64_b64 v[152:155], v29 offset0:228 offset1:234
    v_exp_f32 v87, v87
    v_exp_f32 v88, v88
    v_exp_f32 v89, v89
    v_exp_f32 v90, v90
    v_smfmac_f32_32x32x32_bf16 v[32:47], v[164:167], v[72:79], v17
    v_exp_f32 v91, v91
    v_exp_f32 v92, v92
    v_exp_f32 v93, v93
    v_exp_f32 v94, v94
    v_exp_f32 v95, v95
    v_mfma_f32_32x32x8_bf16 v[112:127], v[150:151], v[138:139], 0
    v_exp_f32 v96, v96
    v_exp_f32 v97, v97
    v_exp_f32 v98, v98
    v_exp_f32 v99, v99
    v_mfma_f32_32x32x16_bf16 v[112:127], v[144:147], v[132:135], v[112:127]
    ds_read_b128 v[168:171], v30 offset:46080
    v_exp_f32 v100, v100
    v_exp_f32 v101, v101
    v_exp_f32 v102, v102
    v_smfmac_f32_32x32x32_bf16 v[48:63], v[160:163], v[80:87], v17
    ds_read_b128 v[172:175], v31 offset:46080
    v_exp_f32 v103, v103
    v_exp_f32 v104, v104
    v_exp_f32 v105, v105
    v_exp_f32 v106, v106
    v_smfmac_f32_32x32x32_bf16 v[48:63], v[164:167], v[88:95], v17
    s_waitcnt lgkmcnt(2)
    v_exp_f32 v107, v107
    v_exp_f32 v108, v108
    v_exp_f32 v109, v109
    v_exp_f32 v110, v110
    v_exp_f32 v111, v111
    v_mfma_f32_32x32x8_bf16 v[64:79], v[152:153], v[136:137], 0
    v_exp_f32 v112, v112
    v_exp_f32 v113, v113
    v_exp_f32 v114, v114
    v_exp_f32 v115, v115
    v_mfma_f32_32x32x16_bf16 v[64:79], v[140:143], v[128:131], v[64:79]
    s_waitcnt lgkmcnt(0)
    ds_read2st64_b64 v[144:147], v28 offset0:234 offset1:235
    v_exp_f32 v116, v116
    v_exp_f32 v117, v117
    v_exp_f32 v118, v118
    v_smfmac_f32_32x32x32_bf16 v[32:47], v[168:171], v[96:103], v17
    v_exp_f32 v119, v119
    v_exp_f32 v120, v120
    v_exp_f32 v121, v121
    v_exp_f32 v122, v122
    v_smfmac_f32_32x32x32_bf16 v[32:47], v[172:175], v[104:111], v17
    v_exp_f32 v123, v123
    v_exp_f32 v124, v124
    v_exp_f32 v125, v125
    v_exp_f32 v126, v126
    v_exp_f32 v127, v127
    v_mfma_f32_32x32x8_bf16 v[80:95], v[152:153], v[138:139], 0
    v_exp_f32 v64, v64
    v_exp_f32 v65, v65
    v_exp_f32 v66, v66
    v_exp_f32 v67, v67
    v_mfma_f32_32x32x16_bf16 v[80:95], v[140:143], v[132:135], v[80:95]
    ds_read_b128 v[160:163], v30 offset:49152
    v_exp_f32 v68, v68
    v_exp_f32 v69, v69
    v_exp_f32 v70, v70
    v_smfmac_f32_32x32x32_bf16 v[48:63], v[168:171], v[112:119], v17
    ds_read_b128 v[164:167], v31 offset:49152
    v_exp_f32 v71, v71
    v_exp_f32 v72, v72
    v_exp_f32 v73, v73
    v_exp_f32 v74, v74
    v_smfmac_f32_32x32x32_bf16 v[48:63], v[172:175], v[120:127], v17
    s_waitcnt lgkmcnt(2)
    v_exp_f32 v75, v75
    v_exp_f32 v76, v76
    v_exp_f32 v77, v77
    v_exp_f32 v78, v78
    v_exp_f32 v79, v79
    v_mfma_f32_32x32x8_bf16 v[96:111], v[154:155], v[136:137], 0
    v_exp_f32 v80, v80
    v_exp_f32 v81, v81
    v_exp_f32 v82, v82
    v_exp_f32 v83, v83
    v_mfma_f32_32x32x16_bf16 v[96:111], v[144:147], v[128:131], v[96:111]
    s_waitcnt lgkmcnt(0)
    ds_read2st64_b64 v[140:143], v28 offset0:240 offset1:241
    v_exp_f32 v84, v84
    v_exp_f32 v85, v85
    v_exp_f32 v86, v86
    v_smfmac_f32_32x32x32_bf16 v[32:47], v[160:163], v[64:71], v17
    ds_read2st64_b64 v[148:151], v29 offset0:240 offset1:246
    v_exp_f32 v87, v87
    v_exp_f32 v88, v88
    v_exp_f32 v89, v89
    v_exp_f32 v90, v90
    v_smfmac_f32_32x32x32_bf16 v[32:47], v[164:167], v[72:79], v17
    v_exp_f32 v91, v91
    v_exp_f32 v92, v92
    v_exp_f32 v93, v93
    v_exp_f32 v94, v94
    v_exp_f32 v95, v95
    v_mfma_f32_32x32x8_bf16 v[112:127], v[154:155], v[138:139], 0
    v_exp_f32 v96, v96
    v_exp_f32 v97, v97
    v_exp_f32 v98, v98
    v_exp_f32 v99, v99
    v_mfma_f32_32x32x16_bf16 v[112:127], v[144:147], v[132:135], v[112:127]
    ds_read_b128 v[168:171], v30 offset:52224
    v_exp_f32 v100, v100
    v_exp_f32 v101, v101
    v_exp_f32 v102, v102
    v_smfmac_f32_32x32x32_bf16 v[48:63], v[160:163], v[80:87], v17
    ds_read_b128 v[172:175], v31 offset:52224
    v_exp_f32 v103, v103
    v_exp_f32 v104, v104
    v_exp_f32 v105, v105
    v_exp_f32 v106, v106
    v_smfmac_f32_32x32x32_bf16 v[48:63], v[164:167], v[88:95], v17
    s_waitcnt lgkmcnt(2)
    v_exp_f32 v107, v107
    v_exp_f32 v108, v108
    v_exp_f32 v109, v109
    v_exp_f32 v110, v110
    v_exp_f32 v111, v111
    v_mfma_f32_32x32x8_bf16 v[64:79], v[148:149], v[136:137], 0
    v_exp_f32 v112, v112
    v_exp_f32 v113, v113
    v_exp_f32 v114, v114
    v_exp_f32 v115, v115
    v_mfma_f32_32x32x16_bf16 v[64:79], v[140:143], v[128:131], v[64:79]
    s_waitcnt lgkmcnt(0)
    ds_read2st64_b64 v[144:147], v28 offset0:246 offset1:247
    v_exp_f32 v116, v116
    v_exp_f32 v117, v117
    v_exp_f32 v118, v118
    v_smfmac_f32_32x32x32_bf16 v[32:47], v[168:171], v[96:103], v17
    v_exp_f32 v119, v119
    v_exp_f32 v120, v120
    v_exp_f32 v121, v121
    v_exp_f32 v122, v122
    v_smfmac_f32_32x32x32_bf16 v[32:47], v[172:175], v[104:111], v17
    v_exp_f32 v123, v123
    v_exp_f32 v124, v124
    v_exp_f32 v125, v125
    v_exp_f32 v126, v126
    v_exp_f32 v127, v127
    v_mfma_f32_32x32x8_bf16 v[80:95], v[148:149], v[138:139], 0
    v_exp_f32 v64, v64
    v_exp_f32 v65, v65
    v_exp_f32 v66, v66
    v_exp_f32 v67, v67
    v_mfma_f32_32x32x16_bf16 v[80:95], v[140:143], v[132:135], v[80:95]
    ds_read_b128 v[160:163], v30 offset:55296
    v_exp_f32 v68, v68
    v_exp_f32 v69, v69
    v_exp_f32 v70, v70
    v_smfmac_f32_32x32x32_bf16 v[48:63], v[168:171], v[112:119], v17
    ds_read_b128 v[164:167], v31 offset:55296
    v_exp_f32 v71, v71
    v_exp_f32 v72, v72
    v_exp_f32 v73, v73
    v_exp_f32 v74, v74
    v_smfmac_f32_32x32x32_bf16 v[48:63], v[172:175], v[120:127], v17
    s_waitcnt lgkmcnt(2)
    v_exp_f32 v75, v75
    v_exp_f32 v76, v76
    v_exp_f32 v77, v77
    v_exp_f32 v78, v78
    v_exp_f32 v79, v79
    v_mfma_f32_32x32x8_bf16 v[96:111], v[150:151], v[136:137], 0
    v_exp_f32 v80, v80
    v_exp_f32 v81, v81
    v_exp_f32 v82, v82
    v_exp_f32 v83, v83
    v_mfma_f32_32x32x16_bf16 v[96:111], v[144:147], v[128:131], v[96:111]
    s_waitcnt lgkmcnt(0)
    ds_read2st64_b64 v[140:143], v28 offset0:252 offset1:253
    v_exp_f32 v84, v84
    v_exp_f32 v85, v85
    v_exp_f32 v86, v86
    v_smfmac_f32_32x32x32_bf16 v[32:47], v[160:163], v[64:71], v17
    v_add_u32 v29, 129024, v29
    ds_read2st64_b64 v[152:155], v29 offset0:0 offset1:6
    v_exp_f32 v87, v87
    v_exp_f32 v88, v88
    v_exp_f32 v89, v89
    v_exp_f32 v90, v90
    v_smfmac_f32_32x32x32_bf16 v[32:47], v[164:167], v[72:79], v17
    v_exp_f32 v91, v91
    v_exp_f32 v92, v92
    v_exp_f32 v93, v93
    v_exp_f32 v94, v94
    v_exp_f32 v95, v95
    v_mfma_f32_32x32x8_bf16 v[112:127], v[150:151], v[138:139], 0
    v_exp_f32 v96, v96
    v_exp_f32 v97, v97
    v_exp_f32 v98, v98
    v_exp_f32 v99, v99
    v_mfma_f32_32x32x16_bf16 v[112:127], v[144:147], v[132:135], v[112:127]
    ds_read_b128 v[168:171], v30 offset:58368
    v_exp_f32 v100, v100
    v_exp_f32 v101, v101
    v_exp_f32 v102, v102
    v_smfmac_f32_32x32x32_bf16 v[48:63], v[160:163], v[80:87], v17
    ds_read_b128 v[172:175], v31 offset:58368
    v_exp_f32 v103, v103
    v_exp_f32 v104, v104
    v_exp_f32 v105, v105
    v_exp_f32 v106, v106
    v_smfmac_f32_32x32x32_bf16 v[48:63], v[164:167], v[88:95], v17
    s_waitcnt lgkmcnt(2)
    v_exp_f32 v107, v107
    v_exp_f32 v108, v108
    v_exp_f32 v109, v109
    v_exp_f32 v110, v110
    v_exp_f32 v111, v111
    v_mfma_f32_32x32x8_bf16 v[64:79], v[152:153], v[136:137], 0
    v_exp_f32 v112, v112
    v_exp_f32 v113, v113
    v_exp_f32 v114, v114
    v_exp_f32 v115, v115
    v_mfma_f32_32x32x16_bf16 v[64:79], v[140:143], v[128:131], v[64:79]
    s_waitcnt lgkmcnt(0)
    v_add_u32 v28, 132096, v28
    ds_read2st64_b64 v[144:147], v28 offset0:0 offset1:1
    v_exp_f32 v116, v116
    v_exp_f32 v117, v117
    v_exp_f32 v118, v118
    v_smfmac_f32_32x32x32_bf16 v[32:47], v[168:171], v[96:103], v17
    v_exp_f32 v119, v119
    v_exp_f32 v120, v120
    v_exp_f32 v121, v121
    v_exp_f32 v122, v122
    v_smfmac_f32_32x32x32_bf16 v[32:47], v[172:175], v[104:111], v17
    v_exp_f32 v123, v123
    v_exp_f32 v124, v124
    v_exp_f32 v125, v125
    v_exp_f32 v126, v126
    v_exp_f32 v127, v127
    v_mfma_f32_32x32x8_bf16 v[80:95], v[152:153], v[138:139], 0
    v_exp_f32 v64, v64
    v_exp_f32 v65, v65
    v_exp_f32 v66, v66
    v_exp_f32 v67, v67
    v_mfma_f32_32x32x16_bf16 v[80:95], v[140:143], v[132:135], v[80:95]
    ds_read_b128 v[160:163], v30 offset:61440
    v_exp_f32 v68, v68
    v_exp_f32 v69, v69
    v_exp_f32 v70, v70
    v_smfmac_f32_32x32x32_bf16 v[48:63], v[168:171], v[112:119], v17
    ds_read_b128 v[164:167], v31 offset:61440
    v_exp_f32 v71, v71
    v_exp_f32 v72, v72
    v_exp_f32 v73, v73
    v_exp_f32 v74, v74
    v_smfmac_f32_32x32x32_bf16 v[48:63], v[172:175], v[120:127], v17
    s_waitcnt lgkmcnt(2)
    v_exp_f32 v75, v75
    v_exp_f32 v76, v76
    v_exp_f32 v77, v77
    v_exp_f32 v78, v78
    v_exp_f32 v79, v79
    v_mfma_f32_32x32x8_bf16 v[96:111], v[154:155], v[136:137], 0
    v_exp_f32 v80, v80
    v_exp_f32 v81, v81
    v_exp_f32 v82, v82
    v_exp_f32 v83, v83
    v_mfma_f32_32x32x16_bf16 v[96:111], v[144:147], v[128:131], v[96:111]
    s_waitcnt lgkmcnt(0)
    ds_read2st64_b64 v[140:143], v28 offset0:6 offset1:7
    v_exp_f32 v84, v84
    v_exp_f32 v85, v85
    v_exp_f32 v86, v86
    v_smfmac_f32_32x32x32_bf16 v[32:47], v[160:163], v[64:71], v17
    ds_read2st64_b64 v[148:151], v29 offset0:12 offset1:18
    v_exp_f32 v87, v87
    v_exp_f32 v88, v88
    v_exp_f32 v89, v89
    v_exp_f32 v90, v90
    v_smfmac_f32_32x32x32_bf16 v[32:47], v[164:167], v[72:79], v17
    v_exp_f32 v91, v91
    v_exp_f32 v92, v92
    v_exp_f32 v93, v93
    v_exp_f32 v94, v94
    v_exp_f32 v95, v95
    v_mfma_f32_32x32x8_bf16 v[112:127], v[154:155], v[138:139], 0
    v_exp_f32 v96, v96
    v_exp_f32 v97, v97
    v_exp_f32 v98, v98
    v_exp_f32 v99, v99
    v_mfma_f32_32x32x16_bf16 v[112:127], v[144:147], v[132:135], v[112:127]
    ds_read_b128 v[168:171], v30 offset:64512
    v_exp_f32 v100, v100
    v_exp_f32 v101, v101
    v_exp_f32 v102, v102
    v_smfmac_f32_32x32x32_bf16 v[48:63], v[160:163], v[80:87], v17
    ds_read_b128 v[172:175], v31 offset:64512
    v_exp_f32 v103, v103
    v_exp_f32 v104, v104
    v_exp_f32 v105, v105
    v_exp_f32 v106, v106
    v_smfmac_f32_32x32x32_bf16 v[48:63], v[164:167], v[88:95], v17
    s_waitcnt lgkmcnt(2)
    v_exp_f32 v107, v107
    v_exp_f32 v108, v108
    v_exp_f32 v109, v109
    v_exp_f32 v110, v110
    v_exp_f32 v111, v111
    v_mfma_f32_32x32x8_bf16 v[64:79], v[148:149], v[136:137], 0
    v_exp_f32 v112, v112
    v_exp_f32 v113, v113
    v_exp_f32 v114, v114
    v_exp_f32 v115, v115
    v_mfma_f32_32x32x16_bf16 v[64:79], v[140:143], v[128:131], v[64:79]
    s_waitcnt lgkmcnt(0)
    ds_read2st64_b64 v[144:147], v28 offset0:12 offset1:13
    v_exp_f32 v116, v116
    v_exp_f32 v117, v117
    v_exp_f32 v118, v118
    v_smfmac_f32_32x32x32_bf16 v[32:47], v[168:171], v[96:103], v17
    v_exp_f32 v119, v119
    v_exp_f32 v120, v120
    v_exp_f32 v121, v121
    v_exp_f32 v122, v122
    v_smfmac_f32_32x32x32_bf16 v[32:47], v[172:175], v[104:111], v17
    v_exp_f32 v123, v123
    v_exp_f32 v124, v124
    v_exp_f32 v125, v125
    v_exp_f32 v126, v126
    v_exp_f32 v127, v127
    v_mfma_f32_32x32x8_bf16 v[80:95], v[148:149], v[138:139], 0
    v_exp_f32 v64, v64
    v_exp_f32 v65, v65
    v_exp_f32 v66, v66
    v_exp_f32 v67, v67
    v_mfma_f32_32x32x16_bf16 v[80:95], v[140:143], v[132:135], v[80:95]
    v_add_u32 v30, 67584, v30
    ds_read_b128 v[160:163], v30 offset:0
    v_exp_f32 v68, v68
    v_exp_f32 v69, v69
    v_exp_f32 v70, v70
    v_smfmac_f32_32x32x32_bf16 v[48:63], v[168:171], v[112:119], v17
    v_add_u32 v31, 67584, v31
    ds_read_b128 v[164:167], v31 offset:0
    v_exp_f32 v71, v71
    v_exp_f32 v72, v72
    v_exp_f32 v73, v73
    v_exp_f32 v74, v74
    v_smfmac_f32_32x32x32_bf16 v[48:63], v[172:175], v[120:127], v17
    s_waitcnt lgkmcnt(2)
    v_exp_f32 v75, v75
    v_exp_f32 v76, v76
    v_exp_f32 v77, v77
    v_exp_f32 v78, v78
    v_exp_f32 v79, v79
    v_mfma_f32_32x32x8_bf16 v[96:111], v[150:151], v[136:137], 0
    v_exp_f32 v80, v80
    v_exp_f32 v81, v81
    v_exp_f32 v82, v82
    v_exp_f32 v83, v83
    v_mfma_f32_32x32x16_bf16 v[96:111], v[144:147], v[128:131], v[96:111]
    s_waitcnt lgkmcnt(0)
    ds_read2st64_b64 v[140:143], v28 offset0:18 offset1:19
    v_exp_f32 v84, v84
    v_exp_f32 v85, v85
    v_exp_f32 v86, v86
    v_smfmac_f32_32x32x32_bf16 v[32:47], v[160:163], v[64:71], v17
    ds_read2st64_b64 v[152:155], v29 offset0:24 offset1:30
    v_exp_f32 v87, v87
    v_exp_f32 v88, v88
    v_exp_f32 v89, v89
    v_exp_f32 v90, v90
    v_smfmac_f32_32x32x32_bf16 v[32:47], v[164:167], v[72:79], v17
    v_exp_f32 v91, v91
    v_exp_f32 v92, v92
    v_exp_f32 v93, v93
    v_exp_f32 v94, v94
    v_exp_f32 v95, v95
    v_mfma_f32_32x32x8_bf16 v[112:127], v[150:151], v[138:139], 0
    v_exp_f32 v96, v96
    v_exp_f32 v97, v97
    v_exp_f32 v98, v98
    v_exp_f32 v99, v99
    v_mfma_f32_32x32x16_bf16 v[112:127], v[144:147], v[132:135], v[112:127]
    ds_read_b128 v[168:171], v30 offset:3072
    v_exp_f32 v100, v100
    v_exp_f32 v101, v101
    v_exp_f32 v102, v102
    v_smfmac_f32_32x32x32_bf16 v[48:63], v[160:163], v[80:87], v17
    ds_read_b128 v[172:175], v31 offset:3072
    v_exp_f32 v103, v103
    v_exp_f32 v104, v104
    v_exp_f32 v105, v105
    v_exp_f32 v106, v106
    v_smfmac_f32_32x32x32_bf16 v[48:63], v[164:167], v[88:95], v17
    s_waitcnt lgkmcnt(2)
    v_exp_f32 v107, v107
    v_exp_f32 v108, v108
    v_exp_f32 v109, v109
    v_exp_f32 v110, v110
    v_exp_f32 v111, v111
    v_mfma_f32_32x32x8_bf16 v[64:79], v[152:153], v[136:137], 0
    v_exp_f32 v112, v112
    v_exp_f32 v113, v113
    v_exp_f32 v114, v114
    v_exp_f32 v115, v115
    v_mfma_f32_32x32x16_bf16 v[64:79], v[140:143], v[128:131], v[64:79]
    s_waitcnt lgkmcnt(0)
    ds_read2st64_b64 v[144:147], v28 offset0:24 offset1:25
    v_exp_f32 v116, v116
    v_exp_f32 v117, v117
    v_exp_f32 v118, v118
    v_smfmac_f32_32x32x32_bf16 v[32:47], v[168:171], v[96:103], v17
    v_exp_f32 v119, v119
    v_exp_f32 v120, v120
    v_exp_f32 v121, v121
    v_exp_f32 v122, v122
    v_smfmac_f32_32x32x32_bf16 v[32:47], v[172:175], v[104:111], v17
    v_exp_f32 v123, v123
    v_exp_f32 v124, v124
    v_exp_f32 v125, v125
    v_exp_f32 v126, v126
    v_exp_f32 v127, v127
    v_mfma_f32_32x32x8_bf16 v[80:95], v[152:153], v[138:139], 0
    v_exp_f32 v64, v64
    v_exp_f32 v65, v65
    v_exp_f32 v66, v66
    v_exp_f32 v67, v67
    v_mfma_f32_32x32x16_bf16 v[80:95], v[140:143], v[132:135], v[80:95]
    ds_read_b128 v[160:163], v30 offset:6144
    v_exp_f32 v68, v68
    v_exp_f32 v69, v69
    v_exp_f32 v70, v70
    v_smfmac_f32_32x32x32_bf16 v[48:63], v[168:171], v[112:119], v17
    ds_read_b128 v[164:167], v31 offset:6144
    v_exp_f32 v71, v71
    v_exp_f32 v72, v72
    v_exp_f32 v73, v73
    v_exp_f32 v74, v74
    v_smfmac_f32_32x32x32_bf16 v[48:63], v[172:175], v[120:127], v17
    s_waitcnt lgkmcnt(2)
    v_exp_f32 v75, v75
    v_exp_f32 v76, v76
    v_exp_f32 v77, v77
    v_exp_f32 v78, v78
    v_exp_f32 v79, v79
    v_mfma_f32_32x32x8_bf16 v[96:111], v[154:155], v[136:137], 0
    v_exp_f32 v80, v80
    v_exp_f32 v81, v81
    v_exp_f32 v82, v82
    v_exp_f32 v83, v83
    v_mfma_f32_32x32x16_bf16 v[96:111], v[144:147], v[128:131], v[96:111]
    s_waitcnt lgkmcnt(0)
    s_barrier
    buffer_load_dword v10, v21, s[20:23], s77 offen offset:0 sc1
    buffer_load_dword v11, v21, s[20:23], s77 offen offset:64 sc1
    v_add_u32 v28, 4294835200, v28
    ds_read2st64_b64 v[140:143], v28 offset0:0 offset1:1
    v_exp_f32 v84, v84
    v_exp_f32 v85, v85
    v_exp_f32 v86, v86
    v_smfmac_f32_32x32x32_bf16 v[32:47], v[160:163], v[64:71], v17
    v_add_u32 v29, 4294838272, v29
    ds_read2st64_b64 v[148:151], v29 offset0:0 offset1:6
    v_exp_f32 v87, v87
    v_exp_f32 v88, v88
    v_exp_f32 v89, v89
    v_exp_f32 v90, v90
    v_smfmac_f32_32x32x32_bf16 v[32:47], v[164:167], v[72:79], v17
    v_exp_f32 v91, v91
    v_exp_f32 v92, v92
    v_exp_f32 v93, v93
    v_exp_f32 v94, v94
    v_exp_f32 v95, v95
    v_mfma_f32_32x32x8_bf16 v[112:127], v[154:155], v[138:139], 0
    v_exp_f32 v96, v96
    v_exp_f32 v97, v97
    v_exp_f32 v98, v98
    v_exp_f32 v99, v99
    v_mfma_f32_32x32x16_bf16 v[112:127], v[144:147], v[132:135], v[112:127]
    ds_read_b128 v[168:171], v30 offset:9216
    v_exp_f32 v100, v100
    v_exp_f32 v101, v101
    v_exp_f32 v102, v102
    v_smfmac_f32_32x32x32_bf16 v[48:63], v[160:163], v[80:87], v17
    ds_read_b128 v[172:175], v31 offset:9216
    v_exp_f32 v103, v103
    v_exp_f32 v104, v104
    v_exp_f32 v105, v105
    v_exp_f32 v106, v106
    v_smfmac_f32_32x32x32_bf16 v[48:63], v[164:167], v[88:95], v17
    s_waitcnt lgkmcnt(2)
    v_exp_f32 v107, v107
    v_exp_f32 v108, v108
    v_exp_f32 v109, v109
    v_exp_f32 v110, v110
    v_exp_f32 v111, v111
    v_mfma_f32_32x32x8_bf16 v[64:79], v[148:149], v[136:137], 0
    v_exp_f32 v112, v112
    v_exp_f32 v113, v113
    v_exp_f32 v114, v114
    v_exp_f32 v115, v115
    v_mfma_f32_32x32x16_bf16 v[64:79], v[140:143], v[128:131], v[64:79]
    s_waitcnt lgkmcnt(0)
    ds_read2st64_b64 v[144:147], v28 offset0:6 offset1:7
    v_exp_f32 v116, v116
    v_exp_f32 v117, v117
    v_exp_f32 v118, v118
    v_smfmac_f32_32x32x32_bf16 v[32:47], v[168:171], v[96:103], v17
    v_exp_f32 v119, v119
    v_exp_f32 v120, v120
    v_exp_f32 v121, v121
    v_exp_f32 v122, v122
    v_smfmac_f32_32x32x32_bf16 v[32:47], v[172:175], v[104:111], v17
    v_exp_f32 v123, v123
    v_exp_f32 v124, v124
    v_exp_f32 v125, v125
    v_exp_f32 v126, v126
    v_exp_f32 v127, v127
    v_mfma_f32_32x32x8_bf16 v[80:95], v[148:149], v[138:139], 0
    v_exp_f32 v64, v64
    v_exp_f32 v65, v65
    v_exp_f32 v66, v66
    v_exp_f32 v67, v67
    v_mfma_f32_32x32x16_bf16 v[80:95], v[140:143], v[132:135], v[80:95]
    v_add_u32 v30, 4294832128, v30
    ds_read_b128 v[160:163], v30 offset:0
    v_exp_f32 v68, v68
    v_exp_f32 v69, v69
    v_exp_f32 v70, v70
    v_smfmac_f32_32x32x32_bf16 v[48:63], v[168:171], v[112:119], v17
    v_add_u32 v31, 4294832128, v31
    ds_read_b128 v[164:167], v31 offset:0
    v_exp_f32 v71, v71
    v_exp_f32 v72, v72
    v_exp_f32 v73, v73
    v_exp_f32 v74, v74
    v_smfmac_f32_32x32x32_bf16 v[48:63], v[172:175], v[120:127], v17
    s_waitcnt lgkmcnt(2)
    v_exp_f32 v75, v75
    v_exp_f32 v76, v76
    v_exp_f32 v77, v77
    v_exp_f32 v78, v78
    v_exp_f32 v79, v79
    v_mfma_f32_32x32x8_bf16 v[96:111], v[150:151], v[136:137], 0
    v_exp_f32 v80, v80
    v_exp_f32 v81, v81
    v_exp_f32 v82, v82
    v_exp_f32 v83, v83
    v_mfma_f32_32x32x16_bf16 v[96:111], v[144:147], v[128:131], v[96:111]
    s_waitcnt lgkmcnt(0)
    ds_read2st64_b64 v[140:143], v28 offset0:12 offset1:13
    v_exp_f32 v84, v84
    v_exp_f32 v85, v85
    v_exp_f32 v86, v86
    v_smfmac_f32_32x32x32_bf16 v[32:47], v[160:163], v[64:71], v17
    ds_read2st64_b64 v[152:155], v29 offset0:12 offset1:18
    v_exp_f32 v87, v87
    v_exp_f32 v88, v88
    v_exp_f32 v89, v89
    v_exp_f32 v90, v90
    v_smfmac_f32_32x32x32_bf16 v[32:47], v[164:167], v[72:79], v17
    v_exp_f32 v91, v91
    v_exp_f32 v92, v92
    v_exp_f32 v93, v93
    v_exp_f32 v94, v94
    v_exp_f32 v95, v95
    v_mfma_f32_32x32x8_bf16 v[112:127], v[150:151], v[138:139], 0
    v_exp_f32 v96, v96
    v_exp_f32 v97, v97
    v_exp_f32 v98, v98
    v_exp_f32 v99, v99
    v_mfma_f32_32x32x16_bf16 v[112:127], v[144:147], v[132:135], v[112:127]
    ds_read_b128 v[168:171], v30 offset:3072
    v_exp_f32 v100, v100
    v_exp_f32 v101, v101
    v_exp_f32 v102, v102
    v_smfmac_f32_32x32x32_bf16 v[48:63], v[160:163], v[80:87], v17
    ds_read_b128 v[172:175], v31 offset:3072
    v_exp_f32 v103, v103
    v_exp_f32 v104, v104
    v_exp_f32 v105, v105
    v_exp_f32 v106, v106
    v_smfmac_f32_32x32x32_bf16 v[48:63], v[164:167], v[88:95], v17
    s_waitcnt lgkmcnt(2)
    v_exp_f32 v107, v107
    v_exp_f32 v108, v108
    v_exp_f32 v109, v109
    v_exp_f32 v110, v110
    v_exp_f32 v111, v111
    v_mfma_f32_32x32x8_bf16 v[64:79], v[152:153], v[136:137], 0
    v_exp_f32 v112, v112
    v_exp_f32 v113, v113
    v_exp_f32 v114, v114
    v_exp_f32 v115, v115
    v_mfma_f32_32x32x16_bf16 v[64:79], v[140:143], v[128:131], v[64:79]
    s_waitcnt lgkmcnt(0)
    ds_read2st64_b64 v[144:147], v28 offset0:18 offset1:19
    v_exp_f32 v116, v116
    v_exp_f32 v117, v117
    v_exp_f32 v118, v118
    v_smfmac_f32_32x32x32_bf16 v[32:47], v[168:171], v[96:103], v17
    v_exp_f32 v119, v119
    v_exp_f32 v120, v120
    v_exp_f32 v121, v121
    v_exp_f32 v122, v122
    v_smfmac_f32_32x32x32_bf16 v[32:47], v[172:175], v[104:111], v17
    v_exp_f32 v123, v123
    v_exp_f32 v124, v124
    v_exp_f32 v125, v125
    v_exp_f32 v126, v126
    v_exp_f32 v127, v127
    v_mfma_f32_32x32x8_bf16 v[80:95], v[152:153], v[138:139], 0
    v_exp_f32 v64, v64
    v_exp_f32 v65, v65
    v_exp_f32 v66, v66
    v_exp_f32 v67, v67
    v_mfma_f32_32x32x16_bf16 v[80:95], v[140:143], v[132:135], v[80:95]
    ds_read_b128 v[160:163], v30 offset:6144
    v_exp_f32 v68, v68
    v_exp_f32 v69, v69
    v_exp_f32 v70, v70
    v_smfmac_f32_32x32x32_bf16 v[48:63], v[168:171], v[112:119], v17
    ds_read_b128 v[164:167], v31 offset:6144
    v_exp_f32 v71, v71
    v_exp_f32 v72, v72
    v_exp_f32 v73, v73
    v_exp_f32 v74, v74
    v_smfmac_f32_32x32x32_bf16 v[48:63], v[172:175], v[120:127], v17
Lpad_at_2:
    s_cbranch_scc1 Lwarm_at
    s_waitcnt lgkmcnt(2)
    v_exp_f32 v75, v75
    v_exp_f32 v76, v76
    v_exp_f32 v77, v77
    v_exp_f32 v78, v78
    v_exp_f32 v79, v79
    v_mfma_f32_32x32x8_bf16 v[96:111], v[154:155], v[136:137], 0
    v_exp_f32 v80, v80
    v_exp_f32 v81, v81
    v_exp_f32 v82, v82
    v_exp_f32 v83, v83
    v_mfma_f32_32x32x16_bf16 v[96:111], v[144:147], v[128:131], v[96:111]
    s_waitcnt lgkmcnt(0)
    ds_read2st64_b64 v[140:143], v28 offset0:24 offset1:25
    v_exp_f32 v84, v84
    v_exp_f32 v85, v85
    v_exp_f32 v86, v86
    v_smfmac_f32_32x32x32_bf16 v[32:47], v[160:163], v[64:71], v17
    ds_read2st64_b64 v[148:151], v29 offset0:24 offset1:30
    v_exp_f32 v87, v87
    v_exp_f32 v88, v88
    v_exp_f32 v89, v89
    v_exp_f32 v90, v90
    v_smfmac_f32_32x32x32_bf16 v[32:47], v[164:167], v[72:79], v17
    v_exp_f32 v91, v91
    v_exp_f32 v92, v92
    v_exp_f32 v93, v93
    v_exp_f32 v94, v94
    v_exp_f32 v95, v95
    v_mfma_f32_32x32x8_bf16 v[112:127], v[154:155], v[138:139], 0
    v_exp_f32 v96, v96
    v_exp_f32 v97, v97
    v_exp_f32 v98, v98
    v_exp_f32 v99, v99
    v_mfma_f32_32x32x16_bf16 v[112:127], v[144:147], v[132:135], v[112:127]
    ds_read_b128 v[168:171], v30 offset:9216
    v_exp_f32 v100, v100
    v_exp_f32 v101, v101
    v_exp_f32 v102, v102
    v_smfmac_f32_32x32x32_bf16 v[48:63], v[160:163], v[80:87], v17
    ds_read_b128 v[172:175], v31 offset:9216
    v_exp_f32 v103, v103
    v_exp_f32 v104, v104
    v_exp_f32 v105, v105
    v_exp_f32 v106, v106
    v_smfmac_f32_32x32x32_bf16 v[48:63], v[164:167], v[88:95], v17
    s_waitcnt lgkmcnt(2)
    v_exp_f32 v107, v107
    v_exp_f32 v108, v108
    v_exp_f32 v109, v109
    v_exp_f32 v110, v110
    v_exp_f32 v111, v111
    v_mfma_f32_32x32x8_bf16 v[64:79], v[148:149], v[136:137], 0
    v_exp_f32 v112, v112
    v_exp_f32 v113, v113
    v_exp_f32 v114, v114
    v_exp_f32 v115, v115
    v_mfma_f32_32x32x16_bf16 v[64:79], v[140:143], v[128:131], v[64:79]
    s_waitcnt lgkmcnt(0)
    ds_read2st64_b64 v[144:147], v28 offset0:30 offset1:31
    v_exp_f32 v116, v116
    v_exp_f32 v117, v117
    v_exp_f32 v118, v118
    v_smfmac_f32_32x32x32_bf16 v[32:47], v[168:171], v[96:103], v17
    v_exp_f32 v119, v119
    v_exp_f32 v120, v120
    v_exp_f32 v121, v121
    v_exp_f32 v122, v122
    v_smfmac_f32_32x32x32_bf16 v[32:47], v[172:175], v[104:111], v17
    v_exp_f32 v123, v123
    v_exp_f32 v124, v124
    v_exp_f32 v125, v125
    v_exp_f32 v126, v126
    v_exp_f32 v127, v127
    v_mfma_f32_32x32x8_bf16 v[80:95], v[148:149], v[138:139], 0
    v_exp_f32 v64, v64
    v_exp_f32 v65, v65
    v_exp_f32 v66, v66
    v_exp_f32 v67, v67
    v_mfma_f32_32x32x16_bf16 v[80:95], v[140:143], v[132:135], v[80:95]
    ds_read_b128 v[160:163], v30 offset:12288
    v_exp_f32 v68, v68
    v_exp_f32 v69, v69
    v_exp_f32 v70, v70
    v_smfmac_f32_32x32x32_bf16 v[48:63], v[168:171], v[112:119], v17
    ds_read_b128 v[164:167], v31 offset:12288
    v_exp_f32 v71, v71
    v_exp_f32 v72, v72
    v_exp_f32 v73, v73
    v_exp_f32 v74, v74
    v_smfmac_f32_32x32x32_bf16 v[48:63], v[172:175], v[120:127], v17
    s_waitcnt lgkmcnt(2)
    v_exp_f32 v75, v75
    v_exp_f32 v76, v76
    v_exp_f32 v77, v77
    v_exp_f32 v78, v78
    v_exp_f32 v79, v79
    v_mfma_f32_32x32x8_bf16 v[96:111], v[150:151], v[136:137], 0
    v_exp_f32 v80, v80
    v_exp_f32 v81, v81
    v_exp_f32 v82, v82
    v_exp_f32 v83, v83
    v_mfma_f32_32x32x16_bf16 v[96:111], v[144:147], v[128:131], v[96:111]
    s_waitcnt lgkmcnt(0)
    ds_read2st64_b64 v[140:143], v28 offset0:36 offset1:37
    v_exp_f32 v84, v84
    v_exp_f32 v85, v85
    v_exp_f32 v86, v86
    v_smfmac_f32_32x32x32_bf16 v[32:47], v[160:163], v[64:71], v17
    ds_read2st64_b64 v[152:155], v29 offset0:36 offset1:42
    v_exp_f32 v87, v87
    v_exp_f32 v88, v88
    v_exp_f32 v89, v89
    v_exp_f32 v90, v90
    v_smfmac_f32_32x32x32_bf16 v[32:47], v[164:167], v[72:79], v17
    v_exp_f32 v91, v91
    v_exp_f32 v92, v92
    v_exp_f32 v93, v93
    v_exp_f32 v94, v94
    v_exp_f32 v95, v95
    v_mfma_f32_32x32x8_bf16 v[112:127], v[150:151], v[138:139], 0
    v_exp_f32 v96, v96
    v_exp_f32 v97, v97
    v_exp_f32 v98, v98
    v_exp_f32 v99, v99
    v_mfma_f32_32x32x16_bf16 v[112:127], v[144:147], v[132:135], v[112:127]
    ds_read_b128 v[168:171], v30 offset:15360
    v_exp_f32 v100, v100
    v_exp_f32 v101, v101
    v_exp_f32 v102, v102
    v_smfmac_f32_32x32x32_bf16 v[48:63], v[160:163], v[80:87], v17
    ds_read_b128 v[172:175], v31 offset:15360
    v_exp_f32 v103, v103
    v_exp_f32 v104, v104
    v_exp_f32 v105, v105
    v_exp_f32 v106, v106
    v_smfmac_f32_32x32x32_bf16 v[48:63], v[164:167], v[88:95], v17
    s_waitcnt lgkmcnt(2)
    v_exp_f32 v107, v107
    v_exp_f32 v108, v108
    v_exp_f32 v109, v109
    v_exp_f32 v110, v110
    v_exp_f32 v111, v111
    v_mfma_f32_32x32x8_bf16 v[64:79], v[152:153], v[136:137], 0
    v_exp_f32 v112, v112
    v_exp_f32 v113, v113
    v_exp_f32 v114, v114
    v_exp_f32 v115, v115
    v_mfma_f32_32x32x16_bf16 v[64:79], v[140:143], v[128:131], v[64:79]
    s_waitcnt lgkmcnt(0)
    ds_read2st64_b64 v[144:147], v28 offset0:42 offset1:43
    v_exp_f32 v116, v116
    v_exp_f32 v117, v117
    v_exp_f32 v118, v118
    v_smfmac_f32_32x32x32_bf16 v[32:47], v[168:171], v[96:103], v17
    v_exp_f32 v119, v119
    v_exp_f32 v120, v120
    v_exp_f32 v121, v121
    v_exp_f32 v122, v122
    v_smfmac_f32_32x32x32_bf16 v[32:47], v[172:175], v[104:111], v17
    v_exp_f32 v123, v123
    v_exp_f32 v124, v124
    v_exp_f32 v125, v125
    v_exp_f32 v126, v126
    v_exp_f32 v127, v127
    v_mfma_f32_32x32x8_bf16 v[80:95], v[152:153], v[138:139], 0
    v_exp_f32 v64, v64
    v_exp_f32 v65, v65
    v_exp_f32 v66, v66
    v_exp_f32 v67, v67
    v_mfma_f32_32x32x16_bf16 v[80:95], v[140:143], v[132:135], v[80:95]
    ds_read_b128 v[160:163], v30 offset:18432
    v_exp_f32 v68, v68
    v_exp_f32 v69, v69
    v_exp_f32 v70, v70
    v_smfmac_f32_32x32x32_bf16 v[48:63], v[168:171], v[112:119], v17
    ds_read_b128 v[164:167], v31 offset:18432
    v_exp_f32 v71, v71
    v_exp_f32 v72, v72
    v_exp_f32 v73, v73
    v_exp_f32 v74, v74
    v_smfmac_f32_32x32x32_bf16 v[48:63], v[172:175], v[120:127], v17
    s_waitcnt lgkmcnt(2)
    v_exp_f32 v75, v75
    v_exp_f32 v76, v76
    v_exp_f32 v77, v77
    v_exp_f32 v78, v78
    v_exp_f32 v79, v79
    v_mfma_f32_32x32x8_bf16 v[96:111], v[154:155], v[136:137], 0
    v_exp_f32 v80, v80
    v_exp_f32 v81, v81
    v_exp_f32 v82, v82
    v_exp_f32 v83, v83
    v_mfma_f32_32x32x16_bf16 v[96:111], v[144:147], v[128:131], v[96:111]
    s_waitcnt lgkmcnt(0)
    ds_read2st64_b64 v[140:143], v28 offset0:48 offset1:49
    v_exp_f32 v84, v84
    v_exp_f32 v85, v85
    v_exp_f32 v86, v86
    v_smfmac_f32_32x32x32_bf16 v[32:47], v[160:163], v[64:71], v17
    ds_read2st64_b64 v[148:151], v29 offset0:48 offset1:54
    v_exp_f32 v87, v87
    v_exp_f32 v88, v88
    v_exp_f32 v89, v89
    v_exp_f32 v90, v90
    v_smfmac_f32_32x32x32_bf16 v[32:47], v[164:167], v[72:79], v17
    v_exp_f32 v91, v91
    v_exp_f32 v92, v92
    v_exp_f32 v93, v93
    v_exp_f32 v94, v94
    v_exp_f32 v95, v95
    v_mfma_f32_32x32x8_bf16 v[112:127], v[154:155], v[138:139], 0
    v_exp_f32 v96, v96
    v_exp_f32 v97, v97
    v_exp_f32 v98, v98
    v_exp_f32 v99, v99
    v_mfma_f32_32x32x16_bf16 v[112:127], v[144:147], v[132:135], v[112:127]
    ds_read_b128 v[168:171], v30 offset:21504
    v_exp_f32 v100, v100
    v_exp_f32 v101, v101
    v_exp_f32 v102, v102
    v_smfmac_f32_32x32x32_bf16 v[48:63], v[160:163], v[80:87], v17
    ds_read_b128 v[172:175], v31 offset:21504
    v_exp_f32 v103, v103
    v_exp_f32 v104, v104
    v_exp_f32 v105, v105
    v_exp_f32 v106, v106
    v_smfmac_f32_32x32x32_bf16 v[48:63], v[164:167], v[88:95], v17
    s_waitcnt lgkmcnt(2)
    v_exp_f32 v107, v107
    v_exp_f32 v108, v108
    v_exp_f32 v109, v109
    v_exp_f32 v110, v110
    v_exp_f32 v111, v111
    v_mfma_f32_32x32x8_bf16 v[64:79], v[148:149], v[136:137], 0
    v_exp_f32 v112, v112
    v_exp_f32 v113, v113
    v_exp_f32 v114, v114
    v_exp_f32 v115, v115
    v_mfma_f32_32x32x16_bf16 v[64:79], v[140:143], v[128:131], v[64:79]
    s_waitcnt lgkmcnt(0)
    ds_read2st64_b64 v[144:147], v28 offset0:54 offset1:55
    v_exp_f32 v116, v116
    v_exp_f32 v117, v117
    v_exp_f32 v118, v118
    v_smfmac_f32_32x32x32_bf16 v[32:47], v[168:171], v[96:103], v17
    v_exp_f32 v119, v119
    v_exp_f32 v120, v120
    v_exp_f32 v121, v121
    v_exp_f32 v122, v122
    v_smfmac_f32_32x32x32_bf16 v[32:47], v[172:175], v[104:111], v17
    v_exp_f32 v123, v123
    v_exp_f32 v124, v124
    v_exp_f32 v125, v125
    v_exp_f32 v126, v126
    v_exp_f32 v127, v127
    v_mfma_f32_32x32x8_bf16 v[80:95], v[148:149], v[138:139], 0
    v_exp_f32 v64, v64
    v_exp_f32 v65, v65
    v_exp_f32 v66, v66
    v_exp_f32 v67, v67
    v_mfma_f32_32x32x16_bf16 v[80:95], v[140:143], v[132:135], v[80:95]
    ds_read_b128 v[160:163], v30 offset:24576
    v_exp_f32 v68, v68
    v_exp_f32 v69, v69
    v_exp_f32 v70, v70
    v_smfmac_f32_32x32x32_bf16 v[48:63], v[168:171], v[112:119], v17
    ds_read_b128 v[164:167], v31 offset:24576
    v_exp_f32 v71, v71
    v_exp_f32 v72, v72
    v_exp_f32 v73, v73
    v_exp_f32 v74, v74
    v_smfmac_f32_32x32x32_bf16 v[48:63], v[172:175], v[120:127], v17
    s_waitcnt lgkmcnt(2)
    v_exp_f32 v75, v75
    v_exp_f32 v76, v76
    v_exp_f32 v77, v77
    v_exp_f32 v78, v78
    v_exp_f32 v79, v79
    v_mfma_f32_32x32x8_bf16 v[96:111], v[150:151], v[136:137], 0
    v_exp_f32 v80, v80
    v_exp_f32 v81, v81
    v_exp_f32 v82, v82
    v_exp_f32 v83, v83
    v_mfma_f32_32x32x16_bf16 v[96:111], v[144:147], v[128:131], v[96:111]
    s_waitcnt lgkmcnt(0)
    ds_read2st64_b64 v[140:143], v28 offset0:60 offset1:61
    v_exp_f32 v84, v84
    v_exp_f32 v85, v85
    v_exp_f32 v86, v86
    v_smfmac_f32_32x32x32_bf16 v[32:47], v[160:163], v[64:71], v17
    ds_read2st64_b64 v[152:155], v29 offset0:60 offset1:66
    v_exp_f32 v87, v87
    v_exp_f32 v88, v88
    v_exp_f32 v89, v89
    v_exp_f32 v90, v90
    v_smfmac_f32_32x32x32_bf16 v[32:47], v[164:167], v[72:79], v17
    v_exp_f32 v91, v91
    v_exp_f32 v92, v92
    v_exp_f32 v93, v93
    v_exp_f32 v94, v94
    v_exp_f32 v95, v95
    v_mfma_f32_32x32x8_bf16 v[112:127], v[150:151], v[138:139], 0
    v_exp_f32 v96, v96
    v_exp_f32 v97, v97
    v_exp_f32 v98, v98
    v_exp_f32 v99, v99
    v_mfma_f32_32x32x16_bf16 v[112:127], v[144:147], v[132:135], v[112:127]
    ds_read_b128 v[168:171], v30 offset:27648
    v_exp_f32 v100, v100
    v_exp_f32 v101, v101
    v_exp_f32 v102, v102
    v_smfmac_f32_32x32x32_bf16 v[48:63], v[160:163], v[80:87], v17
    ds_read_b128 v[172:175], v31 offset:27648
    v_exp_f32 v103, v103
    v_exp_f32 v104, v104
    v_exp_f32 v105, v105
    v_exp_f32 v106, v106
    v_smfmac_f32_32x32x32_bf16 v[48:63], v[164:167], v[88:95], v17
    s_waitcnt lgkmcnt(2)
    v_exp_f32 v107, v107
    v_exp_f32 v108, v108
    v_exp_f32 v109, v109
    v_exp_f32 v110, v110
    v_exp_f32 v111, v111
    v_mfma_f32_32x32x8_bf16 v[64:79], v[152:153], v[136:137], 0
    v_exp_f32 v112, v112
    v_exp_f32 v113, v113
    v_exp_f32 v114, v114
    v_exp_f32 v115, v115
    v_mfma_f32_32x32x16_bf16 v[64:79], v[140:143], v[128:131], v[64:79]
    s_waitcnt lgkmcnt(0)
    ds_read2st64_b64 v[144:147], v28 offset0:66 offset1:67
    v_exp_f32 v116, v116
    v_exp_f32 v117, v117
    v_exp_f32 v118, v118
    v_smfmac_f32_32x32x32_bf16 v[32:47], v[168:171], v[96:103], v17
    v_exp_f32 v119, v119
    v_exp_f32 v120, v120
    v_exp_f32 v121, v121
    v_exp_f32 v122, v122
    v_smfmac_f32_32x32x32_bf16 v[32:47], v[172:175], v[104:111], v17
    v_exp_f32 v123, v123
    v_exp_f32 v124, v124
    v_exp_f32 v125, v125
    v_exp_f32 v126, v126
    v_exp_f32 v127, v127
    v_mfma_f32_32x32x8_bf16 v[80:95], v[152:153], v[138:139], 0
    v_exp_f32 v64, v64
    v_exp_f32 v65, v65
    v_exp_f32 v66, v66
    v_exp_f32 v67, v67
    v_mfma_f32_32x32x16_bf16 v[80:95], v[140:143], v[132:135], v[80:95]
    ds_read_b128 v[160:163], v30 offset:30720
    v_exp_f32 v68, v68
    v_exp_f32 v69, v69
    v_exp_f32 v70, v70
    v_smfmac_f32_32x32x32_bf16 v[48:63], v[168:171], v[112:119], v17
    ds_read_b128 v[164:167], v31 offset:30720
    v_exp_f32 v71, v71
    v_exp_f32 v72, v72
    v_exp_f32 v73, v73
    v_exp_f32 v74, v74
    v_smfmac_f32_32x32x32_bf16 v[48:63], v[172:175], v[120:127], v17
    s_waitcnt lgkmcnt(2)
    v_exp_f32 v75, v75
    v_exp_f32 v76, v76
    v_exp_f32 v77, v77
    v_exp_f32 v78, v78
    v_exp_f32 v79, v79
    v_mfma_f32_32x32x8_bf16 v[96:111], v[154:155], v[136:137], 0
    v_exp_f32 v80, v80
    v_exp_f32 v81, v81
    v_exp_f32 v82, v82
    v_exp_f32 v83, v83
    v_mfma_f32_32x32x16_bf16 v[96:111], v[144:147], v[128:131], v[96:111]
    s_waitcnt lgkmcnt(0)
    ds_read2st64_b64 v[140:143], v28 offset0:72 offset1:73
    v_exp_f32 v84, v84
    v_exp_f32 v85, v85
    v_exp_f32 v86, v86
    v_smfmac_f32_32x32x32_bf16 v[32:47], v[160:163], v[64:71], v17
    ds_read2st64_b64 v[148:151], v29 offset0:72 offset1:78
    v_exp_f32 v87, v87
    v_exp_f32 v88, v88
    v_exp_f32 v89, v89
    v_exp_f32 v90, v90
    v_smfmac_f32_32x32x32_bf16 v[32:47], v[164:167], v[72:79], v17
    v_exp_f32 v91, v91
    v_exp_f32 v92, v92
    v_exp_f32 v93, v93
    v_exp_f32 v94, v94
    v_exp_f32 v95, v95
    v_mfma_f32_32x32x8_bf16 v[112:127], v[154:155], v[138:139], 0
    v_exp_f32 v96, v96
    v_exp_f32 v97, v97
    v_exp_f32 v98, v98
    v_exp_f32 v99, v99
    v_mfma_f32_32x32x16_bf16 v[112:127], v[144:147], v[132:135], v[112:127]
    ds_read_b128 v[168:171], v30 offset:33792
    v_exp_f32 v100, v100
    v_exp_f32 v101, v101
    v_exp_f32 v102, v102
    v_smfmac_f32_32x32x32_bf16 v[48:63], v[160:163], v[80:87], v17
    ds_read_b128 v[172:175], v31 offset:33792
    v_exp_f32 v103, v103
    v_exp_f32 v104, v104
    v_exp_f32 v105, v105
    v_exp_f32 v106, v106
    v_smfmac_f32_32x32x32_bf16 v[48:63], v[164:167], v[88:95], v17
    s_waitcnt lgkmcnt(2)
    v_exp_f32 v107, v107
    v_exp_f32 v108, v108
    v_exp_f32 v109, v109
    v_exp_f32 v110, v110
    v_exp_f32 v111, v111
    v_mfma_f32_32x32x8_bf16 v[64:79], v[148:149], v[136:137], 0
    v_exp_f32 v112, v112
    v_exp_f32 v113, v113
    v_exp_f32 v114, v114
    v_exp_f32 v115, v115
    v_mfma_f32_32x32x16_bf16 v[64:79], v[140:143], v[128:131], v[64:79]
    s_waitcnt lgkmcnt(0)
    ds_read2st64_b64 v[144:147], v28 offset0:78 offset1:79
    v_exp_f32 v116, v116
    v_exp_f32 v117, v117
    v_exp_f32 v118, v118
    v_smfmac_f32_32x32x32_bf16 v[32:47], v[168:171], v[96:103], v17
    v_exp_f32 v119, v119
    v_exp_f32 v120, v120
    v_exp_f32 v121, v121
    v_exp_f32 v122, v122
    v_smfmac_f32_32x32x32_bf16 v[32:47], v[172:175], v[104:111], v17
    v_exp_f32 v123, v123
    v_exp_f32 v124, v124
    v_exp_f32 v125, v125
    v_exp_f32 v126, v126
    v_exp_f32 v127, v127
    v_mfma_f32_32x32x8_bf16 v[80:95], v[148:149], v[138:139], 0
    v_exp_f32 v64, v64
    v_exp_f32 v65, v65
    v_exp_f32 v66, v66
    v_exp_f32 v67, v67
    v_mfma_f32_32x32x16_bf16 v[80:95], v[140:143], v[132:135], v[80:95]
    ds_read_b128 v[160:163], v30 offset:36864
    v_exp_f32 v68, v68
    v_exp_f32 v69, v69
    v_exp_f32 v70, v70
    v_smfmac_f32_32x32x32_bf16 v[48:63], v[168:171], v[112:119], v17
    ds_read_b128 v[164:167], v31 offset:36864
    v_exp_f32 v71, v71
    v_exp_f32 v72, v72
    v_exp_f32 v73, v73
    v_exp_f32 v74, v74
    v_smfmac_f32_32x32x32_bf16 v[48:63], v[172:175], v[120:127], v17
    s_waitcnt lgkmcnt(2)
    v_exp_f32 v75, v75
    v_exp_f32 v76, v76
    v_exp_f32 v77, v77
    v_exp_f32 v78, v78
    v_exp_f32 v79, v79
    v_mfma_f32_32x32x8_bf16 v[96:111], v[150:151], v[136:137], 0
    v_exp_f32 v80, v80
    v_exp_f32 v81, v81
    v_exp_f32 v82, v82
    v_exp_f32 v83, v83
    v_mfma_f32_32x32x16_bf16 v[96:111], v[144:147], v[128:131], v[96:111]
    s_waitcnt lgkmcnt(0)
    ds_read2st64_b64 v[140:143], v28 offset0:84 offset1:85
    v_exp_f32 v84, v84
    v_exp_f32 v85, v85
    v_exp_f32 v86, v86
    v_smfmac_f32_32x32x32_bf16 v[32:47], v[160:163], v[64:71], v17
    ds_read2st64_b64 v[152:155], v29 offset0:84 offset1:90
    v_exp_f32 v87, v87
    v_exp_f32 v88, v88
    v_exp_f32 v89, v89
    v_exp_f32 v90, v90
    v_smfmac_f32_32x32x32_bf16 v[32:47], v[164:167], v[72:79], v17
    v_exp_f32 v91, v91
    v_exp_f32 v92, v92
    v_exp_f32 v93, v93
    v_exp_f32 v94, v94
    v_exp_f32 v95, v95
    v_mfma_f32_32x32x8_bf16 v[112:127], v[150:151], v[138:139], 0
    v_exp_f32 v96, v96
    v_exp_f32 v97, v97
    v_exp_f32 v98, v98
    v_exp_f32 v99, v99
    v_mfma_f32_32x32x16_bf16 v[112:127], v[144:147], v[132:135], v[112:127]
    ds_read_b128 v[168:171], v30 offset:39936
    v_exp_f32 v100, v100
    v_exp_f32 v101, v101
    v_exp_f32 v102, v102
    v_smfmac_f32_32x32x32_bf16 v[48:63], v[160:163], v[80:87], v17
    ds_read_b128 v[172:175], v31 offset:39936
    v_exp_f32 v103, v103
    v_exp_f32 v104, v104
    v_exp_f32 v105, v105
    v_exp_f32 v106, v106
    v_smfmac_f32_32x32x32_bf16 v[48:63], v[164:167], v[88:95], v17
    s_waitcnt lgkmcnt(2)
    v_exp_f32 v107, v107
    v_exp_f32 v108, v108
    v_exp_f32 v109, v109
    v_exp_f32 v110, v110
    v_exp_f32 v111, v111
    v_mfma_f32_32x32x8_bf16 v[64:79], v[152:153], v[136:137], 0
    v_exp_f32 v112, v112
    v_exp_f32 v113, v113
    v_exp_f32 v114, v114
    v_exp_f32 v115, v115
    v_mfma_f32_32x32x16_bf16 v[64:79], v[140:143], v[128:131], v[64:79]
    s_waitcnt lgkmcnt(0)
    ds_read2st64_b64 v[144:147], v28 offset0:90 offset1:91
    v_exp_f32 v116, v116
    v_exp_f32 v117, v117
    v_exp_f32 v118, v118
    v_smfmac_f32_32x32x32_bf16 v[32:47], v[168:171], v[96:103], v17
    v_exp_f32 v119, v119
    v_exp_f32 v120, v120
    v_exp_f32 v121, v121
    v_exp_f32 v122, v122
    v_smfmac_f32_32x32x32_bf16 v[32:47], v[172:175], v[104:111], v17
    v_exp_f32 v123, v123
    v_exp_f32 v124, v124
    v_exp_f32 v125, v125
    v_exp_f32 v126, v126
    v_exp_f32 v127, v127
    v_mfma_f32_32x32x8_bf16 v[80:95], v[152:153], v[138:139], 0
    v_exp_f32 v64, v64
    v_exp_f32 v65, v65
    v_exp_f32 v66, v66
    v_exp_f32 v67, v67
    v_mfma_f32_32x32x16_bf16 v[80:95], v[140:143], v[132:135], v[80:95]
    ds_read_b128 v[160:163], v30 offset:43008
    v_exp_f32 v68, v68
    v_exp_f32 v69, v69
    v_exp_f32 v70, v70
    v_smfmac_f32_32x32x32_bf16 v[48:63], v[168:171], v[112:119], v17
    ds_read_b128 v[164:167], v31 offset:43008
    v_exp_f32 v71, v71
    v_exp_f32 v72, v72
    v_exp_f32 v73, v73
    v_exp_f32 v74, v74
    v_smfmac_f32_32x32x32_bf16 v[48:63], v[172:175], v[120:127], v17
    s_waitcnt lgkmcnt(2)
    v_exp_f32 v75, v75
    v_exp_f32 v76, v76
    v_exp_f32 v77, v77
    v_exp_f32 v78, v78
    v_exp_f32 v79, v79
    v_mfma_f32_32x32x8_bf16 v[96:111], v[154:155], v[136:137], 0
    v_exp_f32 v80, v80
    v_exp_f32 v81, v81
    v_exp_f32 v82, v82
    v_exp_f32 v83, v83
    v_mfma_f32_32x32x16_bf16 v[96:111], v[144:147], v[128:131], v[96:111]
    s_waitcnt lgkmcnt(0)
    v_exp_f32 v84, v84
    v_exp_f32 v85, v85
    v_exp_f32 v86, v86
    v_smfmac_f32_32x32x32_bf16 v[32:47], v[160:163], v[64:71], v17
    v_exp_f32 v87, v87
    v_exp_f32 v88, v88
    v_exp_f32 v89, v89
    v_exp_f32 v90, v90
    v_smfmac_f32_32x32x32_bf16 v[32:47], v[164:167], v[72:79], v17
    v_exp_f32 v91, v91
    v_exp_f32 v92, v92
    v_exp_f32 v93, v93
    v_exp_f32 v94, v94
    v_exp_f32 v95, v95
    v_mfma_f32_32x32x8_bf16 v[112:127], v[154:155], v[138:139], 0
    v_exp_f32 v96, v96
    v_exp_f32 v97, v97
    v_exp_f32 v98, v98
    v_exp_f32 v99, v99
    v_mfma_f32_32x32x16_bf16 v[112:127], v[144:147], v[132:135], v[112:127]
    ds_read_b128 v[168:171], v30 offset:46080
    v_exp_f32 v100, v100
    v_exp_f32 v101, v101
    v_exp_f32 v102, v102
    v_smfmac_f32_32x32x32_bf16 v[48:63], v[160:163], v[80:87], v17
    ds_read_b128 v[172:175], v31 offset:46080
    v_exp_f32 v103, v103
    v_exp_f32 v104, v104
    v_exp_f32 v105, v105
    v_exp_f32 v106, v106
    v_smfmac_f32_32x32x32_bf16 v[48:63], v[164:167], v[88:95], v17
    v_exp_f32 v107, v107
    v_exp_f32 v108, v108
    v_exp_f32 v109, v109
    v_exp_f32 v110, v110
    v_exp_f32 v111, v111
    s_waitcnt lgkmcnt(0)
    v_smfmac_f32_32x32x32_bf16 v[32:47], v[168:171], v[96:103], v17
    s_waitcnt vmcnt(0)
    v_exp_f32 v112, v112
    v_exp_f32 v113, v113
    v_exp_f32 v114, v114
    v_exp_f32 v115, v115
    v_smfmac_f32_32x32x32_bf16 v[32:47], v[172:175], v[104:111], v17
    v_exp_f32 v116, v116
    v_exp_f32 v117, v117
    v_exp_f32 v118, v118
    v_exp_f32 v119, v119
    v_exp_f32 v120, v120
    v_exp_f32 v121, v121
    v_exp_f32 v122, v122
    v_smfmac_f32_32x32x32_bf16 v[48:63], v[168:171], v[112:119], v17
    v_exp_f32 v123, v123
    v_exp_f32 v124, v124
    v_exp_f32 v125, v125
    v_exp_f32 v126, v126
    v_exp_f32 v127, v127
    s_nop 1
    v_smfmac_f32_32x32x32_bf16 v[48:63], v[172:175], v[120:127], v17
    v_mov_b32 v12, v40
    v_mov_b32 v13, v40
    v_maximum3_f32 v8, |v32|, |v33|, 0
    v_maximum3_f32 v8, |v34|, |v35|, v8
    v_permlane32_swap_b32 v12, v13
    v_maximum3_f32 v8, |v36|, |v37|, v8
    v_rcp_f32 v12, v13
    v_maximum3_f32 v8, |v38|, |v39|, v8
    v_maximum3_f32 v8, |v40|, |v41|, v8
    v_maximum3_f32 v8, |v42|, |v43|, v8
    v_mul_f32 v12, v12, v10
    v_pk_mul_f32 v[32:33], v[32:33], v[12:13] op_sel_hi:[1,0]
    v_pk_mul_f32 v[34:35], v[34:35], v[12:13] op_sel_hi:[1,0]
    v_pk_mul_f32 v[36:37], v[36:37], v[12:13] op_sel_hi:[1,0]
    v_pk_mul_f32 v[38:39], v[38:39], v[12:13] op_sel_hi:[1,0]
    v_pk_mul_f32 v[40:41], v[40:41], v[12:13] op_sel_hi:[1,0]
    v_pk_mul_f32 v[42:43], v[42:43], v[12:13] op_sel_hi:[1,0]
    v_cvt_pk_bf16_f32 v32, v32, v33
    v_cvt_pk_bf16_f32 v33, v34, v35
    v_cvt_pk_bf16_f32 v34, v36, v37
    v_cvt_pk_bf16_f32 v35, v38, v39
    v_cvt_pk_bf16_f32 v36, v40, v41
    v_cvt_pk_bf16_f32 v37, v42, v43
    v_mov_b32 v14, v56
    v_mov_b32 v15, v56
    v_maximum3_f32 v8, |v48|, |v49|, v8
    v_maximum3_f32 v8, |v50|, |v51|, v8
    v_permlane32_swap_b32 v14, v15
    v_maximum3_f32 v8, |v52|, |v53|, v8
    v_rcp_f32 v14, v15
    v_maximum3_f32 v8, |v54|, |v55|, v8
    v_maximum3_f32 v8, |v56|, |v57|, v8
    v_maximum3_f32 v8, |v58|, |v59|, v8
    v_mul_f32 v14, v14, v11
    v_min_f32 v2, v13, v15
    v_cmp_nge_f32 vcc, 0x5d800000, v8
    s_mov_b64 s[72:73], vcc
    v_cmp_nle_f32 vcc, 0x30800000, v2
    s_or_b64 vcc, vcc, s[72:73]
    s_cbranch_vccnz Lfallback
Lnorm:
    buffer_store_dwordx4 v[32:35], v4, s[20:23], s97 offen sc1
    v_pk_mul_f32 v[48:49], v[48:49], v[14:15] op_sel_hi:[1,0]
    v_pk_mul_f32 v[50:51], v[50:51], v[14:15] op_sel_hi:[1,0]
    v_pk_mul_f32 v[52:53], v[52:53], v[14:15] op_sel_hi:[1,0]
    v_pk_mul_f32 v[54:55], v[54:55], v[14:15] op_sel_hi:[1,0]
    v_pk_mul_f32 v[56:57], v[56:57], v[14:15] op_sel_hi:[1,0]
    v_pk_mul_f32 v[58:59], v[58:59], v[14:15] op_sel_hi:[1,0]
    v_cvt_pk_bf16_f32 v48, v48, v49
    v_cvt_pk_bf16_f32 v49, v50, v51
    v_cvt_pk_bf16_f32 v50, v52, v53
    v_cvt_pk_bf16_f32 v51, v54, v55
    v_cvt_pk_bf16_f32 v52, v56, v57
    v_cvt_pk_bf16_f32 v53, v58, v59
    buffer_store_dwordx4 v[48:51], v4, s[20:23], s52 offen sc1
    s_mov_b32 exec_hi, 0
    buffer_store_dwordx2 v[36:37], v5, s[20:23], s97 offen sc1
    buffer_store_dwordx2 v[52:53], v5, s[20:23], s52 offen sc1
    s_mov_b32 exec_hi, -1
    s_barrier
    s_endpgm
Lcode_end:
.fill 64, 4, 0xbf800000
.section .rodata,"a"
.p2align 6
.amdhsa_kernel gated_mix__mha_block__dense_activation_squared_relu__prompt_kernel
  .amdhsa_next_free_vgpr 256
  .amdhsa_next_free_sgpr 102
  .amdhsa_accum_offset 256
  .amdhsa_group_segment_fixed_size 0
  .amdhsa_kernarg_size 96
  .amdhsa_user_sgpr_count 2
  .amdhsa_user_sgpr_kernarg_segment_ptr 1
  .amdhsa_system_sgpr_workgroup_id_x 1
.end_amdhsa_kernel
```
